```python
import torch

def _softmax(x, axis=-1):
    return torch.softmax(x, dim=axis)

def _gelu(x):
    return torch.nn.functional.gelu(x, approximate='tanh')

def _silu(x):
    return torch.nn.functional.silu(x)

def _sigmoid(x):
    return torch.sigmoid(x)

def _layernorm(x, axis=-1, eps=1e-05):
    m = x.mean(dim=axis, keepdim=True)
    v = x.var(dim=axis, keepdim=True, unbiased=False)
    return (x - m) / torch.sqrt(v + eps)

def _scatter_add(tgt, idx, src, axis=0):
    return tgt.clone().index_add_(axis, idx, src)

def _segment_sum(src, seg, n):
    out = torch.zeros((n,) + src.shape[1:], dtype=src.dtype)
    return out.index_add_(0, seg, src)

def _pad(x, pw):
    flat = tuple((v for pair in reversed(pw) for v in pair))
    return torch.nn.functional.pad(x, flat)
kernel_name = 'parallel_sum__memory_aug_recurrent_mem_tr__mixer_token_mlp__prompt'

def setup_inputs():

    _w = lambda a: (lambda t: t.to(torch.bfloat16) if t.is_floating_point() else t)(torch.as_tensor(a))

    def _A_setup():
        B, S, Dm = (1, 2048, 576)
        H, Dh = (32, 128)
        M, seg = (8, 32)
        seg = min(seg, S)
        S = S // seg * seg
        return {'x': _w((lambda *s: torch.randn(*s, dtype=torch.bfloat16) * 0.05)(B, S, Dm)), 'mem0': _w((lambda *s: torch.randn(*s, dtype=torch.bfloat16) * 0.2)(B, M, Dm)), 'Wq': _w((lambda *s: torch.randn(*s, dtype=torch.bfloat16) * 1.6)(Dm, H, Dh) * Dm ** (-0.5)), 'Wk': _w((lambda *s: torch.randn(*s, dtype=torch.bfloat16) * 1.6)(Dm, H, Dh) * Dm ** (-0.5)), 'Wv': _w((lambda *s: torch.randn(*s, dtype=torch.bfloat16) * 0.2)(Dm, H, Dh) * Dm ** (-0.5)), 'Wo': _w((lambda *s: torch.randn(*s, dtype=torch.bfloat16) * 0.2)(H, Dh, Dm) * (H * Dh) ** (-0.5)), 'seg_len': seg}
    _A_in = _A_setup()

    def _B_setup():
        B, S, D, F = (1, 2048, 576, 4608)
        return {'x': _w((lambda *s: torch.randn(*s, dtype=torch.bfloat16) * 0.05)(B, S, D)), 'w1': _w((lambda *s: torch.randn(*s, dtype=torch.bfloat16) * 0.4)(S, F) * S ** (-0.5)), 'b1': _w((lambda *s: torch.randn(*s, dtype=torch.bfloat16) * 3.2)(F) * 0.02), 'w2': _w((lambda *s: torch.randn(*s, dtype=torch.bfloat16) * 0.2)(F, S) * F ** (-0.5)), 'b2': _w((lambda *s: torch.randn(*s, dtype=torch.bfloat16) * 0.4)(S) * 0.02)}
    _B_in = _B_setup()
    return {'A_x': _A_in['x'], 'A_mem0': _A_in['mem0'], 'A_Wq': _A_in['Wq'], 'A_Wk': _A_in['Wk'], 'A_Wv': _A_in['Wv'], 'A_Wo': _A_in['Wo'], 'A_seg_len': _A_in['seg_len'], 'B_x': _B_in['x'], 'B_w1': _B_in['w1'], 'B_b1': _B_in['b1'], 'B_w2': _B_in['w2'], 'B_b2': _B_in['b2']}

def reference(A_x, A_mem0, A_Wq, A_Wk, A_Wv, A_Wo, A_seg_len, B_x, B_w1, B_b1, B_w2, B_b2):

    def _A_ref(x, mem0, Wq, Wk, Wv, Wo, seg_len):
        B, S, Dm = x.shape
        H, Dh = (Wq.shape[1], Wq.shape[2])
        M = mem0.shape[1]
        scale = Dh ** (-0.5)
        n_seg = S // seg_len
        L = M + seg_len
        idx = torch.arange(L)
        mask = (idx[:, None] < M) | (idx[:, None] >= idx[None, :])
        mem = mem0
        outs = []
        for s in range(n_seg):
            xs = x[:, s * seg_len:(s + 1) * seg_len, :].clone()
            h = torch.concatenate([mem, xs], axis=1)
            q = torch.einsum('btd,dhe->bhte', h, Wq)
            k = torch.einsum('btd,dhe->bhte', h, Wk)
            v = torch.einsum('btd,dhe->bhte', h, Wv)
            scores = torch.einsum('bhqe,bhke->bhqk', q, k) * scale
            scores = torch.where(mask[None, None], scores, -1000000000.0)
            p = _softmax(scores, axis=-1)
            o = torch.einsum('bhqk,bhke->bhqe', p, v)
            o = torch.einsum('bhte,hed->btd', o, Wo)
            mem = o[:, :M, :].clone()
            outs.append(o[:, M:, :])
        return torch.concatenate(outs, axis=1)

    def _B_ref(x, w1, b1, w2, b2):
        B, S, D = x.shape
        h = _layernorm(x, axis=-1)
        u = torch.einsum('bsd,sf->bdf', h, w1) + b1
        u = _gelu(u)
        y = torch.einsum('bdf,fs->bds', u, w2) + b2
        return (lambda x, *d: x.permute(*d))(y, 0, 2, 1)
    x = A_x
    xn = _layernorm(x, axis=-1)
    return x + _A_ref(xn, A_mem0, A_Wq, A_Wk, A_Wv, A_Wo, A_seg_len) + _B_ref(xn, B_w1, B_b1, B_w2, B_b2)
```

```asm
; @launch grid=(256,1,1) block=(256,1,1) lds=163840
.amdgcn_target "amdgcn-amd-amdhsa--gfx950"
.text
.globl parallel_sum__memory_aug_recurrent_mem_tr__mixer_token_mlp__prompt_kernel
.p2align 8
.type parallel_sum__memory_aug_recurrent_mem_tr__mixer_token_mlp__prompt_kernel,@function
parallel_sum__memory_aug_recurrent_mem_tr__mixer_token_mlp__prompt_kernel:
  s_cmp_ge_u32 s2, 256
  s_cbranch_scc1 END
  s_load_dwordx16 s[64:79], s[0:1], 0
  s_load_dwordx8 s[80:87], s[0:1], 64
  s_load_dwordx4 s[88:91], s[0:1], 96
  s_load_dwordx2 s[92:93], s[0:1], 112
  s_getreg_b32 s3, hwreg(HW_REG_XCC_ID, 0, 4)
  v_lshrrev_b32 v1, 6, v0
  v_and_b32 v0, 63, v0
  s_nop 0
  v_readfirstlane_b32 s94, v1
  s_waitcnt lgkmcnt(0)
  s_mov_b32 s28, s90
  s_mov_b32 s29, s91
  s_mov_b32 s30, 0x100
  s_mov_b32 s31, 0x00020000
  s_cmp_eq_u32 s94, 0
  s_cbranch_scc0 ROLE_WAIT
  s_and_b32 s3, s3, 7
  s_mov_b64 exec, 1
  v_mov_b32 v2, 1
  s_lshl_b32 s4, s3, 2
  s_add_u32 s4, s4, 96
  v_mov_b32 v3, s4
  buffer_atomic_add v2, v3, s[28:31], 0 offen sc0
  s_waitcnt vmcnt(0)
  v_readfirstlane_b32 s4, v2
  s_lshl_b32 s5, s3, 5
  s_add_u32 s5, s5, s4
  s_cmp_lt_u32 s4, 32
  s_cbranch_scc1 ROLE_PUB
  v_mov_b32 v2, 1
  v_mov_b32 v3, 128
  buffer_atomic_add v2, v3, s[28:31], 0 offen sc0
  s_waitcnt vmcnt(0)
  v_readfirstlane_b32 s6, v2
  s_mov_b64 exec, 0xff
  v_lshlrev_b32 v3, 2, v0
  v_add_u32 v3, 96, v3
  s_mov_b32 s96, 0
ROLE_OVF:
  buffer_load_dword v2, v3, s[28:31], 0 offen sc1
  s_waitcnt vmcnt(0)
  s_mov_b32 s7, 0
  v_readlane_b32 s8, v2, 0
  v_readlane_b32 s9, v2, 1
  v_readlane_b32 s10, v2, 2
  v_readlane_b32 s11, v2, 3
  v_readlane_b32 s12, v2, 4
  v_readlane_b32 s13, v2, 5
  v_readlane_b32 s14, v2, 6
  v_readlane_b32 s15, v2, 7
  s_add_u32 s7, s7, s8
  s_add_u32 s7, s7, s9
  s_add_u32 s7, s7, s10
  s_add_u32 s7, s7, s11
  s_add_u32 s7, s7, s12
  s_add_u32 s7, s7, s13
  s_add_u32 s7, s7, s14
  s_add_u32 s7, s7, s15
  s_cmp_eq_u32 s7, 256
  s_cbranch_scc1 ROLE_OVF_OK
  s_sleep 8
  s_add_u32 s96, s96, 1
  s_cmp_lt_u32 s96, 60000
  s_cbranch_scc1 ROLE_OVF
  s_mov_b32 s5, 0xffff
  s_branch ROLE_PUB1
ROLE_OVF_OK:
  s_mov_b32 s5, 0xffff
  s_min_u32 s7, s8, 32
  s_sub_u32 s16, 32, s7
  s_cmp_lt_u32 s6, s16
  s_cbranch_scc0 ROLE_OVF_N0
  s_add_u32 s5, s7, s6
  s_add_u32 s5, s5, 0
  s_branch ROLE_OVF_DONE
ROLE_OVF_N0:
  s_sub_u32 s6, s6, s16
  s_min_u32 s7, s9, 32
  s_sub_u32 s16, 32, s7
  s_cmp_lt_u32 s6, s16
  s_cbranch_scc0 ROLE_OVF_N1
  s_add_u32 s5, s7, s6
  s_add_u32 s5, s5, 32
  s_branch ROLE_OVF_DONE
ROLE_OVF_N1:
  s_sub_u32 s6, s6, s16
  s_min_u32 s7, s10, 32
  s_sub_u32 s16, 32, s7
  s_cmp_lt_u32 s6, s16
  s_cbranch_scc0 ROLE_OVF_N2
  s_add_u32 s5, s7, s6
  s_add_u32 s5, s5, 64
  s_branch ROLE_OVF_DONE
ROLE_OVF_N2:
  s_sub_u32 s6, s6, s16
  s_min_u32 s7, s11, 32
  s_sub_u32 s16, 32, s7
  s_cmp_lt_u32 s6, s16
  s_cbranch_scc0 ROLE_OVF_N3
  s_add_u32 s5, s7, s6
  s_add_u32 s5, s5, 96
  s_branch ROLE_OVF_DONE
ROLE_OVF_N3:
  s_sub_u32 s6, s6, s16
  s_min_u32 s7, s12, 32
  s_sub_u32 s16, 32, s7
  s_cmp_lt_u32 s6, s16
  s_cbranch_scc0 ROLE_OVF_N4
  s_add_u32 s5, s7, s6
  s_add_u32 s5, s5, 128
  s_branch ROLE_OVF_DONE
ROLE_OVF_N4:
  s_sub_u32 s6, s6, s16
  s_min_u32 s7, s13, 32
  s_sub_u32 s16, 32, s7
  s_cmp_lt_u32 s6, s16
  s_cbranch_scc0 ROLE_OVF_N5
  s_add_u32 s5, s7, s6
  s_add_u32 s5, s5, 160
  s_branch ROLE_OVF_DONE
ROLE_OVF_N5:
  s_sub_u32 s6, s6, s16
  s_min_u32 s7, s14, 32
  s_sub_u32 s16, 32, s7
  s_cmp_lt_u32 s6, s16
  s_cbranch_scc0 ROLE_OVF_N6
  s_add_u32 s5, s7, s6
  s_add_u32 s5, s5, 192
  s_branch ROLE_OVF_DONE
ROLE_OVF_N6:
  s_sub_u32 s6, s6, s16
  s_min_u32 s7, s15, 32
  s_sub_u32 s16, 32, s7
  s_cmp_lt_u32 s6, s16
  s_cbranch_scc0 ROLE_OVF_N7
  s_add_u32 s5, s7, s6
  s_add_u32 s5, s5, 224
  s_branch ROLE_OVF_DONE
ROLE_OVF_N7:
  s_sub_u32 s6, s6, s16
ROLE_OVF_DONE:
  s_cmp_lt_u32 s5, 32
  s_cbranch_scc0 ROLE_PUB1
  s_mov_b64 exec, 1
  v_mov_b32 v2, 1
  v_mov_b32 v3, 8
  buffer_atomic_or v2, v3, s[28:31], 0 offen
  s_waitcnt vmcnt(0)
ROLE_PUB1:
  s_mov_b64 exec, 1
ROLE_PUB:
  v_mov_b32 v2, s5
  v_mov_b32 v3, 0
  ds_write_b32 v3, v2
  s_waitcnt lgkmcnt(0)
  s_mov_b64 exec, -1
ROLE_WAIT:
  s_barrier
  v_mov_b32 v3, 0
  ds_read_b32 v2, v3
  s_waitcnt lgkmcnt(0)
  v_readfirstlane_b32 s95, v2
  s_barrier
  s_cmp_lt_u32 s95, 32
  s_cbranch_scc1 ROLE_CHAIN
  s_cmp_lt_u32 s95, 256
  s_cbranch_scc0 END
  s_sub_u32 s95, s95, 32
  s_branch ROLE_WORKER
ROLE_WORKER:
  s_mov_b32 s8, s70
  s_mov_b32 s9, s71
  s_mov_b32 s10, 0x480000
  s_mov_b32 s11, 0x00020000
  s_mov_b32 s12, s72
  s_mov_b32 s13, s73
  s_mov_b32 s14, 0x480000
  s_mov_b32 s15, 0x00020000
  s_mov_b32 s16, s68
  s_mov_b32 s17, s69
  s_mov_b32 s18, 0x480000
  s_mov_b32 s19, 0x00020000
  s_mov_b32 s20, s74
  s_mov_b32 s21, s75
  s_mov_b32 s22, 0x480000
  s_mov_b32 s23, 0x00020000
  s_sub_u32 s32, s95, 64
  s_lshl_b32 s32, s32, 2
  s_add_u32 s32, s32, s94
  s_lshl_b32 s32, s32, 13
  s_cmp_lt_u32 s32, 4718592
  s_cbranch_scc0 W_PRE_DONE
  v_lshlrev_b32 v200, 7, v0
  buffer_load_dword v201, v200, s[8:11], s32 offen
  buffer_load_dword v202, v200, s[12:15], s32 offen
  buffer_load_dword v203, v200, s[16:19], s32 offen
  buffer_load_dword v204, v200, s[20:23], s32 offen
W_PRE_DONE:
  s_cmp_lt_u32 s95, 64
  s_cbranch_scc0 W_LN_DONE
  s_mov_b32 s8, s64
  s_mov_b32 s9, s65
  s_mov_b32 s10, 0x240000
  s_mov_b32 s11, 0x00020000
  s_add_u32 s12, s92, 0x100000
  s_addc_u32 s13, s93, 0
  s_mov_b32 s14, 0x240000
  s_mov_b32 s15, 0x00020000
  s_add_u32 s16, s92, 0x400000
  s_addc_u32 s17, s93, 0
  s_mov_b32 s18, 0x240000
  s_mov_b32 s19, 0x00020000
  v_lshrrev_b32 v1, 3, v0
  v_mul_u32_u24 v1, 1152, v1
  v_and_b32 v2, 7, v0
  v_lshl_add_u32 v1, v2, 4, v1
  s_lshl_b32 s32, s95, 2
  s_add_u32 s32, s32, s94
  s_mul_i32 s32, s32, 9216
  buffer_load_dwordx4 v[16:19], v1, s[8:11], s32 offen offset:0
  buffer_load_dwordx4 v[20:23], v1, s[8:11], s32 offen offset:128
  buffer_load_dwordx4 v[24:27], v1, s[8:11], s32 offen offset:256
  buffer_load_dwordx4 v[28:31], v1, s[8:11], s32 offen offset:384
  buffer_load_dwordx4 v[32:35], v1, s[8:11], s32 offen offset:512
  buffer_load_dwordx4 v[36:39], v1, s[8:11], s32 offen offset:640
  buffer_load_dwordx4 v[40:43], v1, s[8:11], s32 offen offset:768
  buffer_load_dwordx4 v[44:47], v1, s[8:11], s32 offen offset:896
  buffer_load_dwordx4 v[48:51], v1, s[8:11], s32 offen offset:1024
  s_waitcnt vmcnt(0)
  v_lshlrev_b32 v64, 16, v16
  v_and_b32 v65, 0xffff0000, v16
  v_lshlrev_b32 v66, 16, v17
  v_and_b32 v67, 0xffff0000, v17
  v_lshlrev_b32 v68, 16, v18
  v_and_b32 v69, 0xffff0000, v18
  v_lshlrev_b32 v70, 16, v19
  v_and_b32 v71, 0xffff0000, v19
  v_lshlrev_b32 v72, 16, v20
  v_and_b32 v73, 0xffff0000, v20
  v_lshlrev_b32 v74, 16, v21
  v_and_b32 v75, 0xffff0000, v21
  v_lshlrev_b32 v76, 16, v22
  v_and_b32 v77, 0xffff0000, v22
  v_lshlrev_b32 v78, 16, v23
  v_and_b32 v79, 0xffff0000, v23
  v_lshlrev_b32 v80, 16, v24
  v_and_b32 v81, 0xffff0000, v24
  v_lshlrev_b32 v82, 16, v25
  v_and_b32 v83, 0xffff0000, v25
  v_lshlrev_b32 v84, 16, v26
  v_and_b32 v85, 0xffff0000, v26
  v_lshlrev_b32 v86, 16, v27
  v_and_b32 v87, 0xffff0000, v27
  v_lshlrev_b32 v88, 16, v28
  v_and_b32 v89, 0xffff0000, v28
  v_lshlrev_b32 v90, 16, v29
  v_and_b32 v91, 0xffff0000, v29
  v_lshlrev_b32 v92, 16, v30
  v_and_b32 v93, 0xffff0000, v30
  v_lshlrev_b32 v94, 16, v31
  v_and_b32 v95, 0xffff0000, v31
  v_lshlrev_b32 v96, 16, v32
  v_and_b32 v97, 0xffff0000, v32
  v_lshlrev_b32 v98, 16, v33
  v_and_b32 v99, 0xffff0000, v33
  v_lshlrev_b32 v100, 16, v34
  v_and_b32 v101, 0xffff0000, v34
  v_lshlrev_b32 v102, 16, v35
  v_and_b32 v103, 0xffff0000, v35
  v_lshlrev_b32 v104, 16, v36
  v_and_b32 v105, 0xffff0000, v36
  v_lshlrev_b32 v106, 16, v37
  v_and_b32 v107, 0xffff0000, v37
  v_lshlrev_b32 v108, 16, v38
  v_and_b32 v109, 0xffff0000, v38
  v_lshlrev_b32 v110, 16, v39
  v_and_b32 v111, 0xffff0000, v39
  v_lshlrev_b32 v112, 16, v40
  v_and_b32 v113, 0xffff0000, v40
  v_lshlrev_b32 v114, 16, v41
  v_and_b32 v115, 0xffff0000, v41
  v_lshlrev_b32 v116, 16, v42
  v_and_b32 v117, 0xffff0000, v42
  v_lshlrev_b32 v118, 16, v43
  v_and_b32 v119, 0xffff0000, v43
  v_lshlrev_b32 v120, 16, v44
  v_and_b32 v121, 0xffff0000, v44
  v_lshlrev_b32 v122, 16, v45
  v_and_b32 v123, 0xffff0000, v45
  v_lshlrev_b32 v124, 16, v46
  v_and_b32 v125, 0xffff0000, v46
  v_lshlrev_b32 v126, 16, v47
  v_and_b32 v127, 0xffff0000, v47
  v_lshlrev_b32 v128, 16, v48
  v_and_b32 v129, 0xffff0000, v48
  v_lshlrev_b32 v130, 16, v49
  v_and_b32 v131, 0xffff0000, v49
  v_lshlrev_b32 v132, 16, v50
  v_and_b32 v133, 0xffff0000, v50
  v_lshlrev_b32 v134, 16, v51
  v_and_b32 v135, 0xffff0000, v51
  v_add_f32 v4, v64, v65
  v_add_f32 v5, v66, v67
  v_add_f32 v4, v4, v68
  v_add_f32 v5, v5, v69
  v_add_f32 v4, v4, v70
  v_add_f32 v5, v5, v71
  v_add_f32 v4, v4, v72
  v_add_f32 v5, v5, v73
  v_add_f32 v4, v4, v74
  v_add_f32 v5, v5, v75
  v_add_f32 v4, v4, v76
  v_add_f32 v5, v5, v77
  v_add_f32 v4, v4, v78
  v_add_f32 v5, v5, v79
  v_add_f32 v4, v4, v80
  v_add_f32 v5, v5, v81
  v_add_f32 v4, v4, v82
  v_add_f32 v5, v5, v83
  v_add_f32 v4, v4, v84
  v_add_f32 v5, v5, v85
  v_add_f32 v4, v4, v86
  v_add_f32 v5, v5, v87
  v_add_f32 v4, v4, v88
  v_add_f32 v5, v5, v89
  v_add_f32 v4, v4, v90
  v_add_f32 v5, v5, v91
  v_add_f32 v4, v4, v92
  v_add_f32 v5, v5, v93
  v_add_f32 v4, v4, v94
  v_add_f32 v5, v5, v95
  v_add_f32 v4, v4, v96
  v_add_f32 v5, v5, v97
  v_add_f32 v4, v4, v98
  v_add_f32 v5, v5, v99
  v_add_f32 v4, v4, v100
  v_add_f32 v5, v5, v101
  v_add_f32 v4, v4, v102
  v_add_f32 v5, v5, v103
  v_add_f32 v4, v4, v104
  v_add_f32 v5, v5, v105
  v_add_f32 v4, v4, v106
  v_add_f32 v5, v5, v107
  v_add_f32 v4, v4, v108
  v_add_f32 v5, v5, v109
  v_add_f32 v4, v4, v110
  v_add_f32 v5, v5, v111
  v_add_f32 v4, v4, v112
  v_add_f32 v5, v5, v113
  v_add_f32 v4, v4, v114
  v_add_f32 v5, v5, v115
  v_add_f32 v4, v4, v116
  v_add_f32 v5, v5, v117
  v_add_f32 v4, v4, v118
  v_add_f32 v5, v5, v119
  v_add_f32 v4, v4, v120
  v_add_f32 v5, v5, v121
  v_add_f32 v4, v4, v122
  v_add_f32 v5, v5, v123
  v_add_f32 v4, v4, v124
  v_add_f32 v5, v5, v125
  v_add_f32 v4, v4, v126
  v_add_f32 v5, v5, v127
  v_add_f32 v4, v4, v128
  v_add_f32 v5, v5, v129
  v_add_f32 v4, v4, v130
  v_add_f32 v5, v5, v131
  v_add_f32 v4, v4, v132
  v_add_f32 v5, v5, v133
  v_add_f32 v4, v4, v134
  v_add_f32 v5, v5, v135
  v_add_f32 v4, v4, v5
  s_nop 1
  v_add_f32_dpp v4, v4, v4 quad_perm:[1,0,3,2] row_mask:0xf bank_mask:0xf
  s_nop 1
  v_add_f32_dpp v4, v4, v4 quad_perm:[2,3,0,1] row_mask:0xf bank_mask:0xf
  s_nop 1
  v_add_f32_dpp v4, v4, v4 row_half_mirror row_mask:0xf bank_mask:0xf
  v_mul_f32 v4, 0x3ae38e39, v4
  v_sub_f32 v64, v64, v4
  v_sub_f32 v65, v65, v4
  v_sub_f32 v66, v66, v4
  v_sub_f32 v67, v67, v4
  v_sub_f32 v68, v68, v4
  v_sub_f32 v69, v69, v4
  v_sub_f32 v70, v70, v4
  v_sub_f32 v71, v71, v4
  v_sub_f32 v72, v72, v4
  v_sub_f32 v73, v73, v4
  v_sub_f32 v74, v74, v4
  v_sub_f32 v75, v75, v4
  v_sub_f32 v76, v76, v4
  v_sub_f32 v77, v77, v4
  v_sub_f32 v78, v78, v4
  v_sub_f32 v79, v79, v4
  v_sub_f32 v80, v80, v4
  v_sub_f32 v81, v81, v4
  v_sub_f32 v82, v82, v4
  v_sub_f32 v83, v83, v4
  v_sub_f32 v84, v84, v4
  v_sub_f32 v85, v85, v4
  v_sub_f32 v86, v86, v4
  v_sub_f32 v87, v87, v4
  v_sub_f32 v88, v88, v4
  v_sub_f32 v89, v89, v4
  v_sub_f32 v90, v90, v4
  v_sub_f32 v91, v91, v4
  v_sub_f32 v92, v92, v4
  v_sub_f32 v93, v93, v4
  v_sub_f32 v94, v94, v4
  v_sub_f32 v95, v95, v4
  v_sub_f32 v96, v96, v4
  v_sub_f32 v97, v97, v4
  v_sub_f32 v98, v98, v4
  v_sub_f32 v99, v99, v4
  v_sub_f32 v100, v100, v4
  v_sub_f32 v101, v101, v4
  v_sub_f32 v102, v102, v4
  v_sub_f32 v103, v103, v4
  v_sub_f32 v104, v104, v4
  v_sub_f32 v105, v105, v4
  v_sub_f32 v106, v106, v4
  v_sub_f32 v107, v107, v4
  v_sub_f32 v108, v108, v4
  v_sub_f32 v109, v109, v4
  v_sub_f32 v110, v110, v4
  v_sub_f32 v111, v111, v4
  v_sub_f32 v112, v112, v4
  v_sub_f32 v113, v113, v4
  v_sub_f32 v114, v114, v4
  v_sub_f32 v115, v115, v4
  v_sub_f32 v116, v116, v4
  v_sub_f32 v117, v117, v4
  v_sub_f32 v118, v118, v4
  v_sub_f32 v119, v119, v4
  v_sub_f32 v120, v120, v4
  v_sub_f32 v121, v121, v4
  v_sub_f32 v122, v122, v4
  v_sub_f32 v123, v123, v4
  v_sub_f32 v124, v124, v4
  v_sub_f32 v125, v125, v4
  v_sub_f32 v126, v126, v4
  v_sub_f32 v127, v127, v4
  v_sub_f32 v128, v128, v4
  v_sub_f32 v129, v129, v4
  v_sub_f32 v130, v130, v4
  v_sub_f32 v131, v131, v4
  v_sub_f32 v132, v132, v4
  v_sub_f32 v133, v133, v4
  v_sub_f32 v134, v134, v4
  v_sub_f32 v135, v135, v4
  v_mul_f32 v5, v64, v64
  v_mul_f32 v6, v65, v65
  v_fmac_f32 v5, v66, v66
  v_fmac_f32 v6, v67, v67
  v_fmac_f32 v5, v68, v68
  v_fmac_f32 v6, v69, v69
  v_fmac_f32 v5, v70, v70
  v_fmac_f32 v6, v71, v71
  v_fmac_f32 v5, v72, v72
  v_fmac_f32 v6, v73, v73
  v_fmac_f32 v5, v74, v74
  v_fmac_f32 v6, v75, v75
  v_fmac_f32 v5, v76, v76
  v_fmac_f32 v6, v77, v77
  v_fmac_f32 v5, v78, v78
  v_fmac_f32 v6, v79, v79
  v_fmac_f32 v5, v80, v80
  v_fmac_f32 v6, v81, v81
  v_fmac_f32 v5, v82, v82
  v_fmac_f32 v6, v83, v83
  v_fmac_f32 v5, v84, v84
  v_fmac_f32 v6, v85, v85
  v_fmac_f32 v5, v86, v86
  v_fmac_f32 v6, v87, v87
  v_fmac_f32 v5, v88, v88
  v_fmac_f32 v6, v89, v89
  v_fmac_f32 v5, v90, v90
  v_fmac_f32 v6, v91, v91
  v_fmac_f32 v5, v92, v92
  v_fmac_f32 v6, v93, v93
  v_fmac_f32 v5, v94, v94
  v_fmac_f32 v6, v95, v95
  v_fmac_f32 v5, v96, v96
  v_fmac_f32 v6, v97, v97
  v_fmac_f32 v5, v98, v98
  v_fmac_f32 v6, v99, v99
  v_fmac_f32 v5, v100, v100
  v_fmac_f32 v6, v101, v101
  v_fmac_f32 v5, v102, v102
  v_fmac_f32 v6, v103, v103
  v_fmac_f32 v5, v104, v104
  v_fmac_f32 v6, v105, v105
  v_fmac_f32 v5, v106, v106
  v_fmac_f32 v6, v107, v107
  v_fmac_f32 v5, v108, v108
  v_fmac_f32 v6, v109, v109
  v_fmac_f32 v5, v110, v110
  v_fmac_f32 v6, v111, v111
  v_fmac_f32 v5, v112, v112
  v_fmac_f32 v6, v113, v113
  v_fmac_f32 v5, v114, v114
  v_fmac_f32 v6, v115, v115
  v_fmac_f32 v5, v116, v116
  v_fmac_f32 v6, v117, v117
  v_fmac_f32 v5, v118, v118
  v_fmac_f32 v6, v119, v119
  v_fmac_f32 v5, v120, v120
  v_fmac_f32 v6, v121, v121
  v_fmac_f32 v5, v122, v122
  v_fmac_f32 v6, v123, v123
  v_fmac_f32 v5, v124, v124
  v_fmac_f32 v6, v125, v125
  v_fmac_f32 v5, v126, v126
  v_fmac_f32 v6, v127, v127
  v_fmac_f32 v5, v128, v128
  v_fmac_f32 v6, v129, v129
  v_fmac_f32 v5, v130, v130
  v_fmac_f32 v6, v131, v131
  v_fmac_f32 v5, v132, v132
  v_fmac_f32 v6, v133, v133
  v_fmac_f32 v5, v134, v134
  v_fmac_f32 v6, v135, v135
  v_add_f32 v5, v5, v6
  s_nop 1
  v_add_f32_dpp v5, v5, v5 quad_perm:[1,0,3,2] row_mask:0xf bank_mask:0xf
  s_nop 1
  v_add_f32_dpp v5, v5, v5 quad_perm:[2,3,0,1] row_mask:0xf bank_mask:0xf
  s_nop 1
  v_add_f32_dpp v5, v5, v5 row_half_mirror row_mask:0xf bank_mask:0xf
  v_mov_b32 v6, 0x3727c5ac
  v_fmac_f32 v6, 0x3ae38e39, v5
  v_rsq_f32 v6, v6
  s_nop 0
  v_mul_f32 v64, v64, v6
  v_mul_f32 v65, v65, v6
  v_cvt_pk_bf16_f32 v16, v64, v65
  v_mul_f32 v66, v66, v6
  v_mul_f32 v67, v67, v6
  v_cvt_pk_bf16_f32 v17, v66, v67
  v_mul_f32 v68, v68, v6
  v_mul_f32 v69, v69, v6
  v_cvt_pk_bf16_f32 v18, v68, v69
  v_mul_f32 v70, v70, v6
  v_mul_f32 v71, v71, v6
  v_cvt_pk_bf16_f32 v19, v70, v71
  v_mul_f32 v72, v72, v6
  v_mul_f32 v73, v73, v6
  v_cvt_pk_bf16_f32 v20, v72, v73
  v_mul_f32 v74, v74, v6
  v_mul_f32 v75, v75, v6
  v_cvt_pk_bf16_f32 v21, v74, v75
  v_mul_f32 v76, v76, v6
  v_mul_f32 v77, v77, v6
  v_cvt_pk_bf16_f32 v22, v76, v77
  v_mul_f32 v78, v78, v6
  v_mul_f32 v79, v79, v6
  v_cvt_pk_bf16_f32 v23, v78, v79
  v_mul_f32 v80, v80, v6
  v_mul_f32 v81, v81, v6
  v_cvt_pk_bf16_f32 v24, v80, v81
  v_mul_f32 v82, v82, v6
  v_mul_f32 v83, v83, v6
  v_cvt_pk_bf16_f32 v25, v82, v83
  v_mul_f32 v84, v84, v6
  v_mul_f32 v85, v85, v6
  v_cvt_pk_bf16_f32 v26, v84, v85
  v_mul_f32 v86, v86, v6
  v_mul_f32 v87, v87, v6
  v_cvt_pk_bf16_f32 v27, v86, v87
  v_mul_f32 v88, v88, v6
  v_mul_f32 v89, v89, v6
  v_cvt_pk_bf16_f32 v28, v88, v89
  v_mul_f32 v90, v90, v6
  v_mul_f32 v91, v91, v6
  v_cvt_pk_bf16_f32 v29, v90, v91
  v_mul_f32 v92, v92, v6
  v_mul_f32 v93, v93, v6
  v_cvt_pk_bf16_f32 v30, v92, v93
  v_mul_f32 v94, v94, v6
  v_mul_f32 v95, v95, v6
  v_cvt_pk_bf16_f32 v31, v94, v95
  v_mul_f32 v96, v96, v6
  v_mul_f32 v97, v97, v6
  v_cvt_pk_bf16_f32 v32, v96, v97
  v_mul_f32 v98, v98, v6
  v_mul_f32 v99, v99, v6
  v_cvt_pk_bf16_f32 v33, v98, v99
  v_mul_f32 v100, v100, v6
  v_mul_f32 v101, v101, v6
  v_cvt_pk_bf16_f32 v34, v100, v101
  v_mul_f32 v102, v102, v6
  v_mul_f32 v103, v103, v6
  v_cvt_pk_bf16_f32 v35, v102, v103
  v_mul_f32 v104, v104, v6
  v_mul_f32 v105, v105, v6
  v_cvt_pk_bf16_f32 v36, v104, v105
  v_mul_f32 v106, v106, v6
  v_mul_f32 v107, v107, v6
  v_cvt_pk_bf16_f32 v37, v106, v107
  v_mul_f32 v108, v108, v6
  v_mul_f32 v109, v109, v6
  v_cvt_pk_bf16_f32 v38, v108, v109
  v_mul_f32 v110, v110, v6
  v_mul_f32 v111, v111, v6
  v_cvt_pk_bf16_f32 v39, v110, v111
  v_mul_f32 v112, v112, v6
  v_mul_f32 v113, v113, v6
  v_cvt_pk_bf16_f32 v40, v112, v113
  v_mul_f32 v114, v114, v6
  v_mul_f32 v115, v115, v6
  v_cvt_pk_bf16_f32 v41, v114, v115
  v_mul_f32 v116, v116, v6
  v_mul_f32 v117, v117, v6
  v_cvt_pk_bf16_f32 v42, v116, v117
  v_mul_f32 v118, v118, v6
  v_mul_f32 v119, v119, v6
  v_cvt_pk_bf16_f32 v43, v118, v119
  v_mul_f32 v120, v120, v6
  v_mul_f32 v121, v121, v6
  v_cvt_pk_bf16_f32 v44, v120, v121
  v_mul_f32 v122, v122, v6
  v_mul_f32 v123, v123, v6
  v_cvt_pk_bf16_f32 v45, v122, v123
  v_mul_f32 v124, v124, v6
  v_mul_f32 v125, v125, v6
  v_cvt_pk_bf16_f32 v46, v124, v125
  v_mul_f32 v126, v126, v6
  v_mul_f32 v127, v127, v6
  v_cvt_pk_bf16_f32 v47, v126, v127
  v_mul_f32 v128, v128, v6
  v_mul_f32 v129, v129, v6
  v_cvt_pk_bf16_f32 v48, v128, v129
  v_mul_f32 v130, v130, v6
  v_mul_f32 v131, v131, v6
  v_cvt_pk_bf16_f32 v49, v130, v131
  v_mul_f32 v132, v132, v6
  v_mul_f32 v133, v133, v6
  v_cvt_pk_bf16_f32 v50, v132, v133
  v_mul_f32 v134, v134, v6
  v_mul_f32 v135, v135, v6
  v_cvt_pk_bf16_f32 v51, v134, v135
  buffer_store_dwordx4 v[16:19], v1, s[12:15], s32 offen offset:0 sc1
  buffer_store_dwordx4 v[20:23], v1, s[12:15], s32 offen offset:128 sc1
  buffer_store_dwordx4 v[24:27], v1, s[12:15], s32 offen offset:256 sc1
  buffer_store_dwordx4 v[28:31], v1, s[12:15], s32 offen offset:384 sc1
  buffer_store_dwordx4 v[32:35], v1, s[12:15], s32 offen offset:512 sc1
  buffer_store_dwordx4 v[36:39], v1, s[12:15], s32 offen offset:640 sc1
  buffer_store_dwordx4 v[40:43], v1, s[12:15], s32 offen offset:768 sc1
  buffer_store_dwordx4 v[44:47], v1, s[12:15], s32 offen offset:896 sc1
  buffer_store_dwordx4 v[48:51], v1, s[12:15], s32 offen offset:1024 sc1
  s_nop 1
  v_lshlrev_b32 v64, 16, v16
  v_and_b32 v65, 0xffff0000, v16
  v_lshlrev_b32 v66, 16, v17
  v_and_b32 v67, 0xffff0000, v17
  v_lshlrev_b32 v68, 16, v18
  v_and_b32 v69, 0xffff0000, v18
  v_lshlrev_b32 v70, 16, v19
  v_and_b32 v71, 0xffff0000, v19
  v_lshlrev_b32 v72, 16, v20
  v_and_b32 v73, 0xffff0000, v20
  v_lshlrev_b32 v74, 16, v21
  v_and_b32 v75, 0xffff0000, v21
  v_lshlrev_b32 v76, 16, v22
  v_and_b32 v77, 0xffff0000, v22
  v_lshlrev_b32 v78, 16, v23
  v_and_b32 v79, 0xffff0000, v23
  v_lshlrev_b32 v80, 16, v24
  v_and_b32 v81, 0xffff0000, v24
  v_lshlrev_b32 v82, 16, v25
  v_and_b32 v83, 0xffff0000, v25
  v_lshlrev_b32 v84, 16, v26
  v_and_b32 v85, 0xffff0000, v26
  v_lshlrev_b32 v86, 16, v27
  v_and_b32 v87, 0xffff0000, v27
  v_lshlrev_b32 v88, 16, v28
  v_and_b32 v89, 0xffff0000, v28
  v_lshlrev_b32 v90, 16, v29
  v_and_b32 v91, 0xffff0000, v29
  v_lshlrev_b32 v92, 16, v30
  v_and_b32 v93, 0xffff0000, v30
  v_lshlrev_b32 v94, 16, v31
  v_and_b32 v95, 0xffff0000, v31
  v_lshlrev_b32 v96, 16, v32
  v_and_b32 v97, 0xffff0000, v32
  v_lshlrev_b32 v98, 16, v33
  v_and_b32 v99, 0xffff0000, v33
  v_lshlrev_b32 v100, 16, v34
  v_and_b32 v101, 0xffff0000, v34
  v_lshlrev_b32 v102, 16, v35
  v_and_b32 v103, 0xffff0000, v35
  v_lshlrev_b32 v104, 16, v36
  v_and_b32 v105, 0xffff0000, v36
  v_lshlrev_b32 v106, 16, v37
  v_and_b32 v107, 0xffff0000, v37
  v_lshlrev_b32 v108, 16, v38
  v_and_b32 v109, 0xffff0000, v38
  v_lshlrev_b32 v110, 16, v39
  v_and_b32 v111, 0xffff0000, v39
  v_lshlrev_b32 v112, 16, v40
  v_and_b32 v113, 0xffff0000, v40
  v_lshlrev_b32 v114, 16, v41
  v_and_b32 v115, 0xffff0000, v41
  v_lshlrev_b32 v116, 16, v42
  v_and_b32 v117, 0xffff0000, v42
  v_lshlrev_b32 v118, 16, v43
  v_and_b32 v119, 0xffff0000, v43
  v_lshlrev_b32 v120, 16, v44
  v_and_b32 v121, 0xffff0000, v44
  v_lshlrev_b32 v122, 16, v45
  v_and_b32 v123, 0xffff0000, v45
  v_lshlrev_b32 v124, 16, v46
  v_and_b32 v125, 0xffff0000, v46
  v_lshlrev_b32 v126, 16, v47
  v_and_b32 v127, 0xffff0000, v47
  v_lshlrev_b32 v128, 16, v48
  v_and_b32 v129, 0xffff0000, v48
  v_lshlrev_b32 v130, 16, v49
  v_and_b32 v131, 0xffff0000, v49
  v_lshlrev_b32 v132, 16, v50
  v_and_b32 v133, 0xffff0000, v50
  v_lshlrev_b32 v134, 16, v51
  v_and_b32 v135, 0xffff0000, v51
  v_add_f32 v4, v64, v65
  v_add_f32 v5, v66, v67
  v_add_f32 v4, v4, v68
  v_add_f32 v5, v5, v69
  v_add_f32 v4, v4, v70
  v_add_f32 v5, v5, v71
  v_add_f32 v4, v4, v72
  v_add_f32 v5, v5, v73
  v_add_f32 v4, v4, v74
  v_add_f32 v5, v5, v75
  v_add_f32 v4, v4, v76
  v_add_f32 v5, v5, v77
  v_add_f32 v4, v4, v78
  v_add_f32 v5, v5, v79
  v_add_f32 v4, v4, v80
  v_add_f32 v5, v5, v81
  v_add_f32 v4, v4, v82
  v_add_f32 v5, v5, v83
  v_add_f32 v4, v4, v84
  v_add_f32 v5, v5, v85
  v_add_f32 v4, v4, v86
  v_add_f32 v5, v5, v87
  v_add_f32 v4, v4, v88
  v_add_f32 v5, v5, v89
  v_add_f32 v4, v4, v90
  v_add_f32 v5, v5, v91
  v_add_f32 v4, v4, v92
  v_add_f32 v5, v5, v93
  v_add_f32 v4, v4, v94
  v_add_f32 v5, v5, v95
  v_add_f32 v4, v4, v96
  v_add_f32 v5, v5, v97
  v_add_f32 v4, v4, v98
  v_add_f32 v5, v5, v99
  v_add_f32 v4, v4, v100
  v_add_f32 v5, v5, v101
  v_add_f32 v4, v4, v102
  v_add_f32 v5, v5, v103
  v_add_f32 v4, v4, v104
  v_add_f32 v5, v5, v105
  v_add_f32 v4, v4, v106
  v_add_f32 v5, v5, v107
  v_add_f32 v4, v4, v108
  v_add_f32 v5, v5, v109
  v_add_f32 v4, v4, v110
  v_add_f32 v5, v5, v111
  v_add_f32 v4, v4, v112
  v_add_f32 v5, v5, v113
  v_add_f32 v4, v4, v114
  v_add_f32 v5, v5, v115
  v_add_f32 v4, v4, v116
  v_add_f32 v5, v5, v117
  v_add_f32 v4, v4, v118
  v_add_f32 v5, v5, v119
  v_add_f32 v4, v4, v120
  v_add_f32 v5, v5, v121
  v_add_f32 v4, v4, v122
  v_add_f32 v5, v5, v123
  v_add_f32 v4, v4, v124
  v_add_f32 v5, v5, v125
  v_add_f32 v4, v4, v126
  v_add_f32 v5, v5, v127
  v_add_f32 v4, v4, v128
  v_add_f32 v5, v5, v129
  v_add_f32 v4, v4, v130
  v_add_f32 v5, v5, v131
  v_add_f32 v4, v4, v132
  v_add_f32 v5, v5, v133
  v_add_f32 v4, v4, v134
  v_add_f32 v5, v5, v135
  v_add_f32 v4, v4, v5
  s_nop 1
  v_add_f32_dpp v4, v4, v4 quad_perm:[1,0,3,2] row_mask:0xf bank_mask:0xf
  s_nop 1
  v_add_f32_dpp v4, v4, v4 quad_perm:[2,3,0,1] row_mask:0xf bank_mask:0xf
  s_nop 1
  v_add_f32_dpp v4, v4, v4 row_half_mirror row_mask:0xf bank_mask:0xf
  v_mul_f32 v4, 0x3ae38e39, v4
  v_sub_f32 v64, v64, v4
  v_sub_f32 v65, v65, v4
  v_sub_f32 v66, v66, v4
  v_sub_f32 v67, v67, v4
  v_sub_f32 v68, v68, v4
  v_sub_f32 v69, v69, v4
  v_sub_f32 v70, v70, v4
  v_sub_f32 v71, v71, v4
  v_sub_f32 v72, v72, v4
  v_sub_f32 v73, v73, v4
  v_sub_f32 v74, v74, v4
  v_sub_f32 v75, v75, v4
  v_sub_f32 v76, v76, v4
  v_sub_f32 v77, v77, v4
  v_sub_f32 v78, v78, v4
  v_sub_f32 v79, v79, v4
  v_sub_f32 v80, v80, v4
  v_sub_f32 v81, v81, v4
  v_sub_f32 v82, v82, v4
  v_sub_f32 v83, v83, v4
  v_sub_f32 v84, v84, v4
  v_sub_f32 v85, v85, v4
  v_sub_f32 v86, v86, v4
  v_sub_f32 v87, v87, v4
  v_sub_f32 v88, v88, v4
  v_sub_f32 v89, v89, v4
  v_sub_f32 v90, v90, v4
  v_sub_f32 v91, v91, v4
  v_sub_f32 v92, v92, v4
  v_sub_f32 v93, v93, v4
  v_sub_f32 v94, v94, v4
  v_sub_f32 v95, v95, v4
  v_sub_f32 v96, v96, v4
  v_sub_f32 v97, v97, v4
  v_sub_f32 v98, v98, v4
  v_sub_f32 v99, v99, v4
  v_sub_f32 v100, v100, v4
  v_sub_f32 v101, v101, v4
  v_sub_f32 v102, v102, v4
  v_sub_f32 v103, v103, v4
  v_sub_f32 v104, v104, v4
  v_sub_f32 v105, v105, v4
  v_sub_f32 v106, v106, v4
  v_sub_f32 v107, v107, v4
  v_sub_f32 v108, v108, v4
  v_sub_f32 v109, v109, v4
  v_sub_f32 v110, v110, v4
  v_sub_f32 v111, v111, v4
  v_sub_f32 v112, v112, v4
  v_sub_f32 v113, v113, v4
  v_sub_f32 v114, v114, v4
  v_sub_f32 v115, v115, v4
  v_sub_f32 v116, v116, v4
  v_sub_f32 v117, v117, v4
  v_sub_f32 v118, v118, v4
  v_sub_f32 v119, v119, v4
  v_sub_f32 v120, v120, v4
  v_sub_f32 v121, v121, v4
  v_sub_f32 v122, v122, v4
  v_sub_f32 v123, v123, v4
  v_sub_f32 v124, v124, v4
  v_sub_f32 v125, v125, v4
  v_sub_f32 v126, v126, v4
  v_sub_f32 v127, v127, v4
  v_sub_f32 v128, v128, v4
  v_sub_f32 v129, v129, v4
  v_sub_f32 v130, v130, v4
  v_sub_f32 v131, v131, v4
  v_sub_f32 v132, v132, v4
  v_sub_f32 v133, v133, v4
  v_sub_f32 v134, v134, v4
  v_sub_f32 v135, v135, v4
  v_mul_f32 v5, v64, v64
  v_mul_f32 v6, v65, v65
  v_fmac_f32 v5, v66, v66
  v_fmac_f32 v6, v67, v67
  v_fmac_f32 v5, v68, v68
  v_fmac_f32 v6, v69, v69
  v_fmac_f32 v5, v70, v70
  v_fmac_f32 v6, v71, v71
  v_fmac_f32 v5, v72, v72
  v_fmac_f32 v6, v73, v73
  v_fmac_f32 v5, v74, v74
  v_fmac_f32 v6, v75, v75
  v_fmac_f32 v5, v76, v76
  v_fmac_f32 v6, v77, v77
  v_fmac_f32 v5, v78, v78
  v_fmac_f32 v6, v79, v79
  v_fmac_f32 v5, v80, v80
  v_fmac_f32 v6, v81, v81
  v_fmac_f32 v5, v82, v82
  v_fmac_f32 v6, v83, v83
  v_fmac_f32 v5, v84, v84
  v_fmac_f32 v6, v85, v85
  v_fmac_f32 v5, v86, v86
  v_fmac_f32 v6, v87, v87
  v_fmac_f32 v5, v88, v88
  v_fmac_f32 v6, v89, v89
  v_fmac_f32 v5, v90, v90
  v_fmac_f32 v6, v91, v91
  v_fmac_f32 v5, v92, v92
  v_fmac_f32 v6, v93, v93
  v_fmac_f32 v5, v94, v94
  v_fmac_f32 v6, v95, v95
  v_fmac_f32 v5, v96, v96
  v_fmac_f32 v6, v97, v97
  v_fmac_f32 v5, v98, v98
  v_fmac_f32 v6, v99, v99
  v_fmac_f32 v5, v100, v100
  v_fmac_f32 v6, v101, v101
  v_fmac_f32 v5, v102, v102
  v_fmac_f32 v6, v103, v103
  v_fmac_f32 v5, v104, v104
  v_fmac_f32 v6, v105, v105
  v_fmac_f32 v5, v106, v106
  v_fmac_f32 v6, v107, v107
  v_fmac_f32 v5, v108, v108
  v_fmac_f32 v6, v109, v109
  v_fmac_f32 v5, v110, v110
  v_fmac_f32 v6, v111, v111
  v_fmac_f32 v5, v112, v112
  v_fmac_f32 v6, v113, v113
  v_fmac_f32 v5, v114, v114
  v_fmac_f32 v6, v115, v115
  v_fmac_f32 v5, v116, v116
  v_fmac_f32 v6, v117, v117
  v_fmac_f32 v5, v118, v118
  v_fmac_f32 v6, v119, v119
  v_fmac_f32 v5, v120, v120
  v_fmac_f32 v6, v121, v121
  v_fmac_f32 v5, v122, v122
  v_fmac_f32 v6, v123, v123
  v_fmac_f32 v5, v124, v124
  v_fmac_f32 v6, v125, v125
  v_fmac_f32 v5, v126, v126
  v_fmac_f32 v6, v127, v127
  v_fmac_f32 v5, v128, v128
  v_fmac_f32 v6, v129, v129
  v_fmac_f32 v5, v130, v130
  v_fmac_f32 v6, v131, v131
  v_fmac_f32 v5, v132, v132
  v_fmac_f32 v6, v133, v133
  v_fmac_f32 v5, v134, v134
  v_fmac_f32 v6, v135, v135
  v_add_f32 v5, v5, v6
  s_nop 1
  v_add_f32_dpp v5, v5, v5 quad_perm:[1,0,3,2] row_mask:0xf bank_mask:0xf
  s_nop 1
  v_add_f32_dpp v5, v5, v5 quad_perm:[2,3,0,1] row_mask:0xf bank_mask:0xf
  s_nop 1
  v_add_f32_dpp v5, v5, v5 row_half_mirror row_mask:0xf bank_mask:0xf
  v_mov_b32 v6, 0x3727c5ac
  v_fmac_f32 v6, 0x3ae38e39, v5
  v_rsq_f32 v6, v6
  s_nop 0
  v_mul_f32 v64, v64, v6
  v_mul_f32 v65, v65, v6
  v_cvt_pk_bf16_f32 v16, v64, v65
  v_mul_f32 v66, v66, v6
  v_mul_f32 v67, v67, v6
  v_cvt_pk_bf16_f32 v17, v66, v67
  v_mul_f32 v68, v68, v6
  v_mul_f32 v69, v69, v6
  v_cvt_pk_bf16_f32 v18, v68, v69
  v_mul_f32 v70, v70, v6
  v_mul_f32 v71, v71, v6
  v_cvt_pk_bf16_f32 v19, v70, v71
  v_mul_f32 v72, v72, v6
  v_mul_f32 v73, v73, v6
  v_cvt_pk_bf16_f32 v20, v72, v73
  v_mul_f32 v74, v74, v6
  v_mul_f32 v75, v75, v6
  v_cvt_pk_bf16_f32 v21, v74, v75
  v_mul_f32 v76, v76, v6
  v_mul_f32 v77, v77, v6
  v_cvt_pk_bf16_f32 v22, v76, v77
  v_mul_f32 v78, v78, v6
  v_mul_f32 v79, v79, v6
  v_cvt_pk_bf16_f32 v23, v78, v79
  v_mul_f32 v80, v80, v6
  v_mul_f32 v81, v81, v6
  v_cvt_pk_bf16_f32 v24, v80, v81
  v_mul_f32 v82, v82, v6
  v_mul_f32 v83, v83, v6
  v_cvt_pk_bf16_f32 v25, v82, v83
  v_mul_f32 v84, v84, v6
  v_mul_f32 v85, v85, v6
  v_cvt_pk_bf16_f32 v26, v84, v85
  v_mul_f32 v86, v86, v6
  v_mul_f32 v87, v87, v6
  v_cvt_pk_bf16_f32 v27, v86, v87
  v_mul_f32 v88, v88, v6
  v_mul_f32 v89, v89, v6
  v_cvt_pk_bf16_f32 v28, v88, v89
  v_mul_f32 v90, v90, v6
  v_mul_f32 v91, v91, v6
  v_cvt_pk_bf16_f32 v29, v90, v91
  v_mul_f32 v92, v92, v6
  v_mul_f32 v93, v93, v6
  v_cvt_pk_bf16_f32 v30, v92, v93
  v_mul_f32 v94, v94, v6
  v_mul_f32 v95, v95, v6
  v_cvt_pk_bf16_f32 v31, v94, v95
  v_mul_f32 v96, v96, v6
  v_mul_f32 v97, v97, v6
  v_cvt_pk_bf16_f32 v32, v96, v97
  v_mul_f32 v98, v98, v6
  v_mul_f32 v99, v99, v6
  v_cvt_pk_bf16_f32 v33, v98, v99
  v_mul_f32 v100, v100, v6
  v_mul_f32 v101, v101, v6
  v_cvt_pk_bf16_f32 v34, v100, v101
  v_mul_f32 v102, v102, v6
  v_mul_f32 v103, v103, v6
  v_cvt_pk_bf16_f32 v35, v102, v103
  v_mul_f32 v104, v104, v6
  v_mul_f32 v105, v105, v6
  v_cvt_pk_bf16_f32 v36, v104, v105
  v_mul_f32 v106, v106, v6
  v_mul_f32 v107, v107, v6
  v_cvt_pk_bf16_f32 v37, v106, v107
  v_mul_f32 v108, v108, v6
  v_mul_f32 v109, v109, v6
  v_cvt_pk_bf16_f32 v38, v108, v109
  v_mul_f32 v110, v110, v6
  v_mul_f32 v111, v111, v6
  v_cvt_pk_bf16_f32 v39, v110, v111
  v_mul_f32 v112, v112, v6
  v_mul_f32 v113, v113, v6
  v_cvt_pk_bf16_f32 v40, v112, v113
  v_mul_f32 v114, v114, v6
  v_mul_f32 v115, v115, v6
  v_cvt_pk_bf16_f32 v41, v114, v115
  v_mul_f32 v116, v116, v6
  v_mul_f32 v117, v117, v6
  v_cvt_pk_bf16_f32 v42, v116, v117
  v_mul_f32 v118, v118, v6
  v_mul_f32 v119, v119, v6
  v_cvt_pk_bf16_f32 v43, v118, v119
  v_mul_f32 v120, v120, v6
  v_mul_f32 v121, v121, v6
  v_cvt_pk_bf16_f32 v44, v120, v121
  v_mul_f32 v122, v122, v6
  v_mul_f32 v123, v123, v6
  v_cvt_pk_bf16_f32 v45, v122, v123
  v_mul_f32 v124, v124, v6
  v_mul_f32 v125, v125, v6
  v_cvt_pk_bf16_f32 v46, v124, v125
  v_mul_f32 v126, v126, v6
  v_mul_f32 v127, v127, v6
  v_cvt_pk_bf16_f32 v47, v126, v127
  v_mul_f32 v128, v128, v6
  v_mul_f32 v129, v129, v6
  v_cvt_pk_bf16_f32 v48, v128, v129
  v_mul_f32 v130, v130, v6
  v_mul_f32 v131, v131, v6
  v_cvt_pk_bf16_f32 v49, v130, v131
  v_mul_f32 v132, v132, v6
  v_mul_f32 v133, v133, v6
  v_cvt_pk_bf16_f32 v50, v132, v133
  v_mul_f32 v134, v134, v6
  v_mul_f32 v135, v135, v6
  v_cvt_pk_bf16_f32 v51, v134, v135
  buffer_store_dwordx4 v[16:19], v1, s[16:19], s32 offen offset:0 sc1
  buffer_store_dwordx4 v[20:23], v1, s[16:19], s32 offen offset:128 sc1
  buffer_store_dwordx4 v[24:27], v1, s[16:19], s32 offen offset:256 sc1
  buffer_store_dwordx4 v[28:31], v1, s[16:19], s32 offen offset:384 sc1
  buffer_store_dwordx4 v[32:35], v1, s[16:19], s32 offen offset:512 sc1
  buffer_store_dwordx4 v[36:39], v1, s[16:19], s32 offen offset:640 sc1
  buffer_store_dwordx4 v[40:43], v1, s[16:19], s32 offen offset:768 sc1
  buffer_store_dwordx4 v[44:47], v1, s[16:19], s32 offen offset:896 sc1
  buffer_store_dwordx4 v[48:51], v1, s[16:19], s32 offen offset:1024 sc1
  s_waitcnt vmcnt(0)
  s_barrier
  s_cmp_eq_u32 s94, 0
  s_cbranch_scc0 W_LN_DONE
  s_mov_b64 exec, 1
  v_mov_b32 v2, 1
  s_add_u32 s32, s95, 32
  v_mov_b32 v3, s32
  buffer_store_byte v2, v3, s[28:31], 0 offen sc1
  s_mov_b64 exec, -1
W_LN_DONE:
  s_mul_hi_u32 s36, s95, 613566757
  s_mul_i32 s37, s36, 7
  s_sub_u32 s37, s95, s37
  v_lshrrev_b32 v12, 4, v0
  v_and_b32 v13, 15, v0
  v_lshlrev_b32 v14, 1, v12
  v_xor_b32 v14, v14, v13
  v_lshlrev_b32 v15, 13, v12
  v_lshl_add_u32 v1, v14, 4, v15
  v_xor_b32 v14, 8, v14
  v_lshl_add_u32 v2, v14, 4, v15
  v_lshrrev_b32 v14, 2, v13
  v_lshrrev_b32 v15, 1, v12
  v_lshl_or_b32 v16, v15, 3, v14
  v_lshl_or_b32 v17, v15, 2, v14
  v_and_b32 v18, 1, v12
  s_lshl_b32 s32, s94, 1
  v_or_b32 v18, s32, v18
  v_xor_b32 v18, v18, v17
  v_lshlrev_b32 v18, 5, v18
  v_lshl_add_u32 v18, v16, 8, v18
  v_and_b32 v19, 3, v0
  v_lshl_add_u32 v3, v19, 3, v18
  v_lshrrev_b32 v14, 3, v0
  v_mul_u32_u24 v15, 1152, v14
  v_lshrrev_b32 v14, 1, v14
  v_and_b32 v16, 7, v0
  v_xor_b32 v16, v16, v14
  v_lshl_add_u32 v4, v16, 4, v15
  v_xor_b32 v16, 4, v16
  v_lshl_add_u32 v5, v16, 4, v15
  v_and_b32 v14, 31, v0
  v_lshrrev_b32 v15, 5, v0
  v_bfe_u32 v16, v14, 1, 3
  v_lshlrev_b32 v14, 7, v14
  v_or_b32 v17, 0, v15
  v_xor_b32 v17, v17, v16
  v_lshl_add_u32 v6, v17, 4, v14
  v_add_u32 v112, 36864, v6
  v_or_b32 v17, 2, v15
  v_xor_b32 v17, v17, v16
  v_lshl_add_u32 v7, v17, 4, v14
  v_add_u32 v113, 36864, v7
  v_or_b32 v17, 4, v15
  v_xor_b32 v17, v17, v16
  v_lshl_add_u32 v8, v17, 4, v14
  v_add_u32 v114, 36864, v8
  v_or_b32 v17, 6, v15
  v_xor_b32 v17, v17, v16
  v_lshl_add_u32 v9, v17, 4, v14
  v_add_u32 v115, 36864, v9
  v_bfe_u32 v14, v0, 4, 1
  v_lshlrev_b32 v14, 10, v14
  v_lshrrev_b32 v15, 5, v0
  v_lshl_add_u32 v14, v15, 8, v14
  v_and_b32 v15, 15, v0
  v_lshl_add_u32 v10, v15, 4, v14
  s_mov_b32 s8, s70
  s_mov_b32 s9, s71
  s_mov_b32 s10, 0x480000
  s_mov_b32 s11, 0x00020000
  s_mov_b32 s12, s72
  s_mov_b32 s13, s73
  s_mov_b32 s14, 0x480000
  s_mov_b32 s15, 0x00020000
  s_lshl_b32 s33, s36, 8
  s_lshl_b32 s32, s94, 17
  s_add_u32 s33, s33, s32
  s_lshl_b32 s34, s94, 12
  s_add_u32 s34, s34, 0
  s_barrier
  s_add_u32 m0, s34, 0
  s_add_u32 s32, s33, 0
  buffer_load_dwordx4 v1, s[8:11], s32 offen lds
  s_add_u32 m0, s34, 1024
  s_add_u32 s32, s33, 32768
  buffer_load_dwordx4 v1, s[8:11], s32 offen lds
  s_add_u32 m0, s34, 2048
  s_add_u32 s32, s33, 65536
  buffer_load_dwordx4 v2, s[8:11], s32 offen lds
  s_add_u32 m0, s34, 3072
  s_add_u32 s32, s33, 98304
  buffer_load_dwordx4 v2, s[8:11], s32 offen lds
  s_add_u32 m0, s34, 16384
  s_add_u32 s32, s33, 524288
  buffer_load_dwordx4 v1, s[8:11], s32 offen lds
  s_add_u32 m0, s34, 17408
  s_add_u32 s32, s33, 557056
  buffer_load_dwordx4 v1, s[8:11], s32 offen lds
  s_add_u32 m0, s34, 18432
  s_add_u32 s32, s33, 589824
  buffer_load_dwordx4 v2, s[8:11], s32 offen lds
  s_add_u32 m0, s34, 19456
  s_add_u32 s32, s33, 622592
  buffer_load_dwordx4 v2, s[8:11], s32 offen lds
  s_add_u32 m0, s34, 32768
  s_add_u32 s32, s33, 1048576
  buffer_load_dwordx4 v1, s[8:11], s32 offen lds
  s_add_u32 m0, s34, 33792
  s_add_u32 s32, s33, 1081344
  buffer_load_dwordx4 v1, s[8:11], s32 offen lds
  s_add_u32 m0, s34, 34816
  s_add_u32 s32, s33, 1114112
  buffer_load_dwordx4 v2, s[8:11], s32 offen lds
  s_add_u32 m0, s34, 35840
  s_add_u32 s32, s33, 1146880
  buffer_load_dwordx4 v2, s[8:11], s32 offen lds
  s_add_u32 m0, s34, 49152
  s_add_u32 s32, s33, 1572864
  buffer_load_dwordx4 v1, s[8:11], s32 offen lds
  s_add_u32 m0, s34, 50176
  s_add_u32 s32, s33, 1605632
  buffer_load_dwordx4 v1, s[8:11], s32 offen lds
  s_add_u32 m0, s34, 51200
  s_add_u32 s32, s33, 1638400
  buffer_load_dwordx4 v2, s[8:11], s32 offen lds
  s_add_u32 m0, s34, 52224
  s_add_u32 s32, s33, 1671168
  buffer_load_dwordx4 v2, s[8:11], s32 offen lds
  s_add_u32 m0, s34, 65536
  s_add_u32 s32, s33, 2097152
  buffer_load_dwordx4 v1, s[8:11], s32 offen lds
  s_add_u32 m0, s34, 66560
  s_add_u32 s32, s33, 2129920
  buffer_load_dwordx4 v1, s[8:11], s32 offen lds
  s_add_u32 m0, s34, 67584
  s_add_u32 s32, s33, 2162688
  buffer_load_dwordx4 v2, s[8:11], s32 offen lds
  s_add_u32 m0, s34, 68608
  s_add_u32 s32, s33, 2195456
  buffer_load_dwordx4 v2, s[8:11], s32 offen lds
  s_add_u32 m0, s34, 81920
  s_add_u32 s32, s33, 2621440
  buffer_load_dwordx4 v1, s[8:11], s32 offen lds
  s_add_u32 m0, s34, 82944
  s_add_u32 s32, s33, 2654208
  buffer_load_dwordx4 v1, s[8:11], s32 offen lds
  s_add_u32 m0, s34, 83968
  s_add_u32 s32, s33, 2686976
  buffer_load_dwordx4 v2, s[8:11], s32 offen lds
  s_add_u32 m0, s34, 84992
  s_add_u32 s32, s33, 2719744
  buffer_load_dwordx4 v2, s[8:11], s32 offen lds
  s_add_u32 m0, s34, 98304
  s_add_u32 s32, s33, 3145728
  buffer_load_dwordx4 v1, s[8:11], s32 offen lds
  s_add_u32 m0, s34, 99328
  s_add_u32 s32, s33, 3178496
  buffer_load_dwordx4 v1, s[8:11], s32 offen lds
  s_add_u32 m0, s34, 100352
  s_add_u32 s32, s33, 3211264
  buffer_load_dwordx4 v2, s[8:11], s32 offen lds
  s_add_u32 m0, s34, 101376
  s_add_u32 s32, s33, 3244032
  buffer_load_dwordx4 v2, s[8:11], s32 offen lds
  s_add_u32 m0, s34, 114688
  s_add_u32 s32, s33, 3670016
  buffer_load_dwordx4 v1, s[8:11], s32 offen lds
  s_add_u32 m0, s34, 115712
  s_add_u32 s32, s33, 3702784
  buffer_load_dwordx4 v1, s[8:11], s32 offen lds
  s_add_u32 m0, s34, 116736
  s_add_u32 s32, s33, 3735552
  buffer_load_dwordx4 v2, s[8:11], s32 offen lds
  s_add_u32 m0, s34, 117760
  s_add_u32 s32, s33, 3768320
  buffer_load_dwordx4 v2, s[8:11], s32 offen lds
  s_add_u32 m0, s34, 131072
  s_add_u32 s32, s33, 4194304
  buffer_load_dwordx4 v1, s[8:11], s32 offen lds
  s_add_u32 m0, s34, 132096
  s_add_u32 s32, s33, 4227072
  buffer_load_dwordx4 v1, s[8:11], s32 offen lds
  s_add_u32 m0, s34, 133120
  s_add_u32 s32, s33, 4259840
  buffer_load_dwordx4 v2, s[8:11], s32 offen lds
  s_add_u32 m0, s34, 134144
  s_add_u32 s32, s33, 4292608
  buffer_load_dwordx4 v2, s[8:11], s32 offen lds
  s_waitcnt vmcnt(32)
  s_barrier
  v_add_u32 v11, 0, v3
  ds_read_b64_tr_b16 a[0:1], v11 offset:0
  ds_read_b64_tr_b16 a[2:3], v11 offset:1024
  ds_read_b64_tr_b16 a[4:5], v11 offset:4096
  ds_read_b64_tr_b16 a[6:7], v11 offset:5120
  ds_read_b64_tr_b16 a[8:9], v11 offset:8192
  ds_read_b64_tr_b16 a[10:11], v11 offset:9216
  ds_read_b64_tr_b16 a[12:13], v11 offset:12288
  ds_read_b64_tr_b16 a[14:15], v11 offset:13312
  s_waitcnt lgkmcnt(0)
  s_waitcnt vmcnt(28)
  s_barrier
  s_add_u32 m0, s34, 0
  s_add_u32 s32, s33, 0
  buffer_load_dwordx4 v1, s[12:15], s32 offen lds
  s_add_u32 m0, s34, 1024
  s_add_u32 s32, s33, 32768
  buffer_load_dwordx4 v1, s[12:15], s32 offen lds
  s_add_u32 m0, s34, 2048
  s_add_u32 s32, s33, 65536
  buffer_load_dwordx4 v2, s[12:15], s32 offen lds
  s_add_u32 m0, s34, 3072
  s_add_u32 s32, s33, 98304
  buffer_load_dwordx4 v2, s[12:15], s32 offen lds
  v_add_u32 v11, 16384, v3
  ds_read_b64_tr_b16 a[16:17], v11 offset:0
  ds_read_b64_tr_b16 a[18:19], v11 offset:1024
  ds_read_b64_tr_b16 a[20:21], v11 offset:4096
  ds_read_b64_tr_b16 a[22:23], v11 offset:5120
  ds_read_b64_tr_b16 a[24:25], v11 offset:8192
  ds_read_b64_tr_b16 a[26:27], v11 offset:9216
  ds_read_b64_tr_b16 a[28:29], v11 offset:12288
  ds_read_b64_tr_b16 a[30:31], v11 offset:13312
  s_waitcnt lgkmcnt(0)
  s_waitcnt vmcnt(28)
  s_barrier
  s_add_u32 m0, s34, 16384
  s_add_u32 s32, s33, 524288
  buffer_load_dwordx4 v1, s[12:15], s32 offen lds
  s_add_u32 m0, s34, 17408
  s_add_u32 s32, s33, 557056
  buffer_load_dwordx4 v1, s[12:15], s32 offen lds
  s_add_u32 m0, s34, 18432
  s_add_u32 s32, s33, 589824
  buffer_load_dwordx4 v2, s[12:15], s32 offen lds
  s_add_u32 m0, s34, 19456
  s_add_u32 s32, s33, 622592
  buffer_load_dwordx4 v2, s[12:15], s32 offen lds
  v_add_u32 v11, 32768, v3
  ds_read_b64_tr_b16 a[32:33], v11 offset:0
  ds_read_b64_tr_b16 a[34:35], v11 offset:1024
  ds_read_b64_tr_b16 a[36:37], v11 offset:4096
  ds_read_b64_tr_b16 a[38:39], v11 offset:5120
  ds_read_b64_tr_b16 a[40:41], v11 offset:8192
  ds_read_b64_tr_b16 a[42:43], v11 offset:9216
  ds_read_b64_tr_b16 a[44:45], v11 offset:12288
  ds_read_b64_tr_b16 a[46:47], v11 offset:13312
  s_waitcnt lgkmcnt(0)
  s_waitcnt vmcnt(28)
  s_barrier
  s_add_u32 m0, s34, 32768
  s_add_u32 s32, s33, 1048576
  buffer_load_dwordx4 v1, s[12:15], s32 offen lds
  s_add_u32 m0, s34, 33792
  s_add_u32 s32, s33, 1081344
  buffer_load_dwordx4 v1, s[12:15], s32 offen lds
  s_add_u32 m0, s34, 34816
  s_add_u32 s32, s33, 1114112
  buffer_load_dwordx4 v2, s[12:15], s32 offen lds
  s_add_u32 m0, s34, 35840
  s_add_u32 s32, s33, 1146880
  buffer_load_dwordx4 v2, s[12:15], s32 offen lds
  v_add_u32 v11, 49152, v3
  ds_read_b64_tr_b16 a[48:49], v11 offset:0
  ds_read_b64_tr_b16 a[50:51], v11 offset:1024
  ds_read_b64_tr_b16 a[52:53], v11 offset:4096
  ds_read_b64_tr_b16 a[54:55], v11 offset:5120
  ds_read_b64_tr_b16 a[56:57], v11 offset:8192
  ds_read_b64_tr_b16 a[58:59], v11 offset:9216
  ds_read_b64_tr_b16 a[60:61], v11 offset:12288
  ds_read_b64_tr_b16 a[62:63], v11 offset:13312
  s_waitcnt lgkmcnt(0)
  s_waitcnt vmcnt(28)
  s_barrier
  s_add_u32 m0, s34, 49152
  s_add_u32 s32, s33, 1572864
  buffer_load_dwordx4 v1, s[12:15], s32 offen lds
  s_add_u32 m0, s34, 50176
  s_add_u32 s32, s33, 1605632
  buffer_load_dwordx4 v1, s[12:15], s32 offen lds
  s_add_u32 m0, s34, 51200
  s_add_u32 s32, s33, 1638400
  buffer_load_dwordx4 v2, s[12:15], s32 offen lds
  s_add_u32 m0, s34, 52224
  s_add_u32 s32, s33, 1671168
  buffer_load_dwordx4 v2, s[12:15], s32 offen lds
  v_add_u32 v11, 65536, v3
  ds_read_b64_tr_b16 a[64:65], v11 offset:0
  ds_read_b64_tr_b16 a[66:67], v11 offset:1024
  ds_read_b64_tr_b16 a[68:69], v11 offset:4096
  ds_read_b64_tr_b16 a[70:71], v11 offset:5120
  ds_read_b64_tr_b16 a[72:73], v11 offset:8192
  ds_read_b64_tr_b16 a[74:75], v11 offset:9216
  ds_read_b64_tr_b16 a[76:77], v11 offset:12288
  ds_read_b64_tr_b16 a[78:79], v11 offset:13312
  s_waitcnt lgkmcnt(0)
  s_waitcnt vmcnt(28)
  s_barrier
  s_add_u32 m0, s34, 65536
  s_add_u32 s32, s33, 2097152
  buffer_load_dwordx4 v1, s[12:15], s32 offen lds
  s_add_u32 m0, s34, 66560
  s_add_u32 s32, s33, 2129920
  buffer_load_dwordx4 v1, s[12:15], s32 offen lds
  s_add_u32 m0, s34, 67584
  s_add_u32 s32, s33, 2162688
  buffer_load_dwordx4 v2, s[12:15], s32 offen lds
  s_add_u32 m0, s34, 68608
  s_add_u32 s32, s33, 2195456
  buffer_load_dwordx4 v2, s[12:15], s32 offen lds
  v_add_u32 v11, 81920, v3
  ds_read_b64_tr_b16 a[80:81], v11 offset:0
  ds_read_b64_tr_b16 a[82:83], v11 offset:1024
  ds_read_b64_tr_b16 a[84:85], v11 offset:4096
  ds_read_b64_tr_b16 a[86:87], v11 offset:5120
  ds_read_b64_tr_b16 a[88:89], v11 offset:8192
  ds_read_b64_tr_b16 a[90:91], v11 offset:9216
  ds_read_b64_tr_b16 a[92:93], v11 offset:12288
  ds_read_b64_tr_b16 a[94:95], v11 offset:13312
  s_waitcnt lgkmcnt(0)
  s_waitcnt vmcnt(28)
  s_barrier
  s_add_u32 m0, s34, 81920
  s_add_u32 s32, s33, 2621440
  buffer_load_dwordx4 v1, s[12:15], s32 offen lds
  s_add_u32 m0, s34, 82944
  s_add_u32 s32, s33, 2654208
  buffer_load_dwordx4 v1, s[12:15], s32 offen lds
  s_add_u32 m0, s34, 83968
  s_add_u32 s32, s33, 2686976
  buffer_load_dwordx4 v2, s[12:15], s32 offen lds
  s_add_u32 m0, s34, 84992
  s_add_u32 s32, s33, 2719744
  buffer_load_dwordx4 v2, s[12:15], s32 offen lds
  v_add_u32 v11, 98304, v3
  ds_read_b64_tr_b16 a[96:97], v11 offset:0
  ds_read_b64_tr_b16 a[98:99], v11 offset:1024
  ds_read_b64_tr_b16 a[100:101], v11 offset:4096
  ds_read_b64_tr_b16 a[102:103], v11 offset:5120
  ds_read_b64_tr_b16 a[104:105], v11 offset:8192
  ds_read_b64_tr_b16 a[106:107], v11 offset:9216
  ds_read_b64_tr_b16 a[108:109], v11 offset:12288
  ds_read_b64_tr_b16 a[110:111], v11 offset:13312
  s_waitcnt lgkmcnt(0)
  s_waitcnt vmcnt(28)
  s_barrier
  s_add_u32 m0, s34, 98304
  s_add_u32 s32, s33, 3145728
  buffer_load_dwordx4 v1, s[12:15], s32 offen lds
  s_add_u32 m0, s34, 99328
  s_add_u32 s32, s33, 3178496
  buffer_load_dwordx4 v1, s[12:15], s32 offen lds
  s_add_u32 m0, s34, 100352
  s_add_u32 s32, s33, 3211264
  buffer_load_dwordx4 v2, s[12:15], s32 offen lds
  s_add_u32 m0, s34, 101376
  s_add_u32 s32, s33, 3244032
  buffer_load_dwordx4 v2, s[12:15], s32 offen lds
  v_add_u32 v11, 114688, v3
  ds_read_b64_tr_b16 a[112:113], v11 offset:0
  ds_read_b64_tr_b16 a[114:115], v11 offset:1024
  ds_read_b64_tr_b16 a[116:117], v11 offset:4096
  ds_read_b64_tr_b16 a[118:119], v11 offset:5120
  ds_read_b64_tr_b16 a[120:121], v11 offset:8192
  ds_read_b64_tr_b16 a[122:123], v11 offset:9216
  ds_read_b64_tr_b16 a[124:125], v11 offset:12288
  ds_read_b64_tr_b16 a[126:127], v11 offset:13312
  s_waitcnt lgkmcnt(0)
  s_waitcnt vmcnt(28)
  s_barrier
  s_add_u32 m0, s34, 114688
  s_add_u32 s32, s33, 3670016
  buffer_load_dwordx4 v1, s[12:15], s32 offen lds
  s_add_u32 m0, s34, 115712
  s_add_u32 s32, s33, 3702784
  buffer_load_dwordx4 v1, s[12:15], s32 offen lds
  s_add_u32 m0, s34, 116736
  s_add_u32 s32, s33, 3735552
  buffer_load_dwordx4 v2, s[12:15], s32 offen lds
  s_add_u32 m0, s34, 117760
  s_add_u32 s32, s33, 3768320
  buffer_load_dwordx4 v2, s[12:15], s32 offen lds
  v_add_u32 v11, 131072, v3
  ds_read_b64_tr_b16 a[128:129], v11 offset:0
  ds_read_b64_tr_b16 a[130:131], v11 offset:1024
  ds_read_b64_tr_b16 a[132:133], v11 offset:4096
  ds_read_b64_tr_b16 a[134:135], v11 offset:5120
  ds_read_b64_tr_b16 a[136:137], v11 offset:8192
  ds_read_b64_tr_b16 a[138:139], v11 offset:9216
  ds_read_b64_tr_b16 a[140:141], v11 offset:12288
  ds_read_b64_tr_b16 a[142:143], v11 offset:13312
  s_waitcnt lgkmcnt(0)
  s_waitcnt vmcnt(28)
  s_barrier
  s_add_u32 m0, s34, 131072
  s_add_u32 s32, s33, 4194304
  buffer_load_dwordx4 v1, s[12:15], s32 offen lds
  s_add_u32 m0, s34, 132096
  s_add_u32 s32, s33, 4227072
  buffer_load_dwordx4 v1, s[12:15], s32 offen lds
  s_add_u32 m0, s34, 133120
  s_add_u32 s32, s33, 4259840
  buffer_load_dwordx4 v2, s[12:15], s32 offen lds
  s_add_u32 m0, s34, 134144
  s_add_u32 s32, s33, 4292608
  buffer_load_dwordx4 v2, s[12:15], s32 offen lds
  v_add_u32 v11, 0, v3
  ds_read_b64_tr_b16 a[144:145], v11 offset:0
  ds_read_b64_tr_b16 a[146:147], v11 offset:1024
  ds_read_b64_tr_b16 a[148:149], v11 offset:4096
  ds_read_b64_tr_b16 a[150:151], v11 offset:5120
  ds_read_b64_tr_b16 a[152:153], v11 offset:8192
  ds_read_b64_tr_b16 a[154:155], v11 offset:9216
  ds_read_b64_tr_b16 a[156:157], v11 offset:12288
  ds_read_b64_tr_b16 a[158:159], v11 offset:13312
  s_waitcnt lgkmcnt(0)
  s_waitcnt vmcnt(28)
  s_barrier
  v_add_u32 v11, 16384, v3
  ds_read_b64_tr_b16 a[160:161], v11 offset:0
  ds_read_b64_tr_b16 a[162:163], v11 offset:1024
  ds_read_b64_tr_b16 a[164:165], v11 offset:4096
  ds_read_b64_tr_b16 a[166:167], v11 offset:5120
  ds_read_b64_tr_b16 a[168:169], v11 offset:8192
  ds_read_b64_tr_b16 a[170:171], v11 offset:9216
  ds_read_b64_tr_b16 a[172:173], v11 offset:12288
  ds_read_b64_tr_b16 a[174:175], v11 offset:13312
  s_waitcnt lgkmcnt(0)
  s_waitcnt vmcnt(24)
  s_barrier
  v_add_u32 v11, 32768, v3
  ds_read_b64_tr_b16 a[176:177], v11 offset:0
  ds_read_b64_tr_b16 a[178:179], v11 offset:1024
  ds_read_b64_tr_b16 a[180:181], v11 offset:4096
  ds_read_b64_tr_b16 a[182:183], v11 offset:5120
  ds_read_b64_tr_b16 a[184:185], v11 offset:8192
  ds_read_b64_tr_b16 a[186:187], v11 offset:9216
  ds_read_b64_tr_b16 a[188:189], v11 offset:12288
  ds_read_b64_tr_b16 a[190:191], v11 offset:13312
  s_waitcnt lgkmcnt(0)
  s_waitcnt vmcnt(20)
  s_barrier
  v_add_u32 v11, 49152, v3
  ds_read_b64_tr_b16 a[192:193], v11 offset:0
  ds_read_b64_tr_b16 a[194:195], v11 offset:1024
  ds_read_b64_tr_b16 a[196:197], v11 offset:4096
  ds_read_b64_tr_b16 a[198:199], v11 offset:5120
  ds_read_b64_tr_b16 a[200:201], v11 offset:8192
  ds_read_b64_tr_b16 a[202:203], v11 offset:9216
  ds_read_b64_tr_b16 a[204:205], v11 offset:12288
  ds_read_b64_tr_b16 a[206:207], v11 offset:13312
  s_waitcnt lgkmcnt(0)
  s_waitcnt vmcnt(16)
  s_barrier
  v_add_u32 v11, 65536, v3
  ds_read_b64_tr_b16 a[208:209], v11 offset:0
  ds_read_b64_tr_b16 a[210:211], v11 offset:1024
  ds_read_b64_tr_b16 a[212:213], v11 offset:4096
  ds_read_b64_tr_b16 a[214:215], v11 offset:5120
  ds_read_b64_tr_b16 a[216:217], v11 offset:8192
  ds_read_b64_tr_b16 a[218:219], v11 offset:9216
  ds_read_b64_tr_b16 a[220:221], v11 offset:12288
  ds_read_b64_tr_b16 a[222:223], v11 offset:13312
  s_waitcnt lgkmcnt(0)
  s_waitcnt vmcnt(12)
  s_barrier
  v_add_u32 v11, 81920, v3
  ds_read_b64_tr_b16 a[224:225], v11 offset:0
  ds_read_b64_tr_b16 a[226:227], v11 offset:1024
  ds_read_b64_tr_b16 a[228:229], v11 offset:4096
  ds_read_b64_tr_b16 a[230:231], v11 offset:5120
  ds_read_b64_tr_b16 a[232:233], v11 offset:8192
  ds_read_b64_tr_b16 a[234:235], v11 offset:9216
  ds_read_b64_tr_b16 a[236:237], v11 offset:12288
  ds_read_b64_tr_b16 a[238:239], v11 offset:13312
  s_waitcnt lgkmcnt(0)
  s_waitcnt vmcnt(8)
  s_barrier
  v_add_u32 v11, 98304, v3
  ds_read_b64_tr_b16 a[240:241], v11 offset:0
  ds_read_b64_tr_b16 a[242:243], v11 offset:1024
  ds_read_b64_tr_b16 a[244:245], v11 offset:4096
  ds_read_b64_tr_b16 a[246:247], v11 offset:5120
  ds_read_b64_tr_b16 a[248:249], v11 offset:8192
  ds_read_b64_tr_b16 a[250:251], v11 offset:9216
  ds_read_b64_tr_b16 a[252:253], v11 offset:12288
  ds_read_b64_tr_b16 a[254:255], v11 offset:13312
  s_waitcnt lgkmcnt(0)
  s_waitcnt vmcnt(4)
  s_barrier
  v_add_u32 v11, 114688, v3
  ds_read_b64_tr_b16 v[64:65], v11 offset:0
  ds_read_b64_tr_b16 v[66:67], v11 offset:1024
  ds_read_b64_tr_b16 v[68:69], v11 offset:4096
  ds_read_b64_tr_b16 v[70:71], v11 offset:5120
  ds_read_b64_tr_b16 v[72:73], v11 offset:8192
  ds_read_b64_tr_b16 v[74:75], v11 offset:9216
  ds_read_b64_tr_b16 v[76:77], v11 offset:12288
  ds_read_b64_tr_b16 v[78:79], v11 offset:13312
  s_waitcnt lgkmcnt(0)
  s_waitcnt vmcnt(0)
  s_barrier
  v_add_u32 v11, 131072, v3
  ds_read_b64_tr_b16 v[80:81], v11 offset:0
  ds_read_b64_tr_b16 v[82:83], v11 offset:1024
  ds_read_b64_tr_b16 v[84:85], v11 offset:4096
  ds_read_b64_tr_b16 v[86:87], v11 offset:5120
  ds_read_b64_tr_b16 v[88:89], v11 offset:8192
  ds_read_b64_tr_b16 v[90:91], v11 offset:9216
  ds_read_b64_tr_b16 v[92:93], v11 offset:12288
  ds_read_b64_tr_b16 v[94:95], v11 offset:13312
  s_waitcnt lgkmcnt(0)
  s_barrier
  s_add_u32 s8, s92, 0x100000
  s_addc_u32 s9, s93, 0
  s_mov_b32 s10, 0x240000
  s_mov_b32 s11, 0x00020000
  s_add_u32 s16, s92, 0x800000
  s_addc_u32 s17, s93, 0
  s_mov_b32 s18, 0x1000000
  s_mov_b32 s19, 0x00020000
  s_add_u32 s20, s92, 0x1800000
  s_addc_u32 s21, s93, 0
  s_mov_b32 s22, 0x1000000
  s_mov_b32 s23, 0x00020000
  s_add_u32 s24, s92, 0x60000
  s_addc_u32 s25, s93, 0
  s_mov_b32 s26, 0x5600
  s_mov_b32 s27, 0x00020000
  v_mov_b32 v12, 12
  s_mov_b32 s96, 0
W_CI_1:
  buffer_load_dword v13, v12, s[28:31], 0 offen sc1
  s_waitcnt vmcnt(0)
  v_readfirstlane_b32 s3, v13
  s_nop 0
  s_cmp_eq_u32 s3, 32
  s_cbranch_scc1 W_CI_1_ok
  s_sleep 4
  s_add_u32 s96, s96, 1
  s_cmp_lt_u32 s96, 60000
  s_cbranch_scc1 W_CI_1
  s_branch W_FAIL
W_CI_1_ok:
  v_and_b32 v12, 15, v0
  v_lshlrev_b32 v12, 2, v12
  v_add_u32 v12, 32, v12
  s_mov_b32 s96, 0
LNW_3:
  buffer_load_dword v13, v12, s[28:31], 0 offen sc1
  s_waitcnt vmcnt(0)
  v_cmp_ne_u32 vcc, 0x01010101, v13
  s_nop 0
  s_cbranch_vccz LNW_3_ok
  s_sleep 2
  s_add_u32 s96, s96, 1
  s_cmp_lt_u32 s96, 60000
  s_cbranch_scc1 LNW_3
  s_branch W_FAIL
LNW_3_ok:
  s_mul_i32 s38, s37, 36864
  s_mul_i32 s32, s94, 9216
  s_add_u32 s38, s38, s32
  s_lshl_b32 s33, s94, 10
  s_and_b32 s34, s94, 1
  s_cmp_eq_u32 s34, 0
  v_mov_b32 v12, v5
  s_cselect_b64 vcc, -1, 0
  v_cndmask_b32 v12, v12, v4, vcc
  s_add_u32 m0, s33, 0
  s_nop 0
  buffer_load_dwordx4 v12, s[8:11], s38 offen offset:0 sc1 lds
  s_add_u32 m0, s33, 3968
  s_nop 0
  buffer_load_dwordx4 v12, s[8:11], s38 offen offset:128 sc1 lds
  s_add_u32 m0, s33, 7936
  s_nop 0
  buffer_load_dwordx4 v12, s[8:11], s38 offen offset:256 sc1 lds
  s_add_u32 m0, s33, 11904
  s_nop 0
  buffer_load_dwordx4 v12, s[8:11], s38 offen offset:384 sc1 lds
  s_add_u32 m0, s33, 15872
  s_nop 0
  buffer_load_dwordx4 v12, s[8:11], s38 offen offset:512 sc1 lds
  s_add_u32 m0, s33, 19840
  s_nop 0
  buffer_load_dwordx4 v12, s[8:11], s38 offen offset:640 sc1 lds
  s_add_u32 m0, s33, 23808
  s_nop 0
  buffer_load_dwordx4 v12, s[8:11], s38 offen offset:768 sc1 lds
  s_add_u32 m0, s33, 27776
  s_nop 0
  buffer_load_dwordx4 v12, s[8:11], s38 offen offset:896 sc1 lds
  s_add_u32 m0, s33, 31744
  s_nop 0
  buffer_load_dwordx4 v12, s[8:11], s38 offen offset:1024 sc1 lds
  s_mov_b32 s40, -1
  s_mov_b32 s41, -1
G1KV_2:
  s_cmp_lt_i32 s40, 0
  s_cbranch_scc1 G1KV_2_w00
  s_waitcnt vmcnt(4)
  s_branch G1KV_2_w10
G1KV_2_w00:
  s_waitcnt vmcnt(0)
G1KV_2_w10:
  s_barrier
  s_add_u32 s39, s37, 7
  s_cmp_lt_u32 s39, 64
  s_cbranch_scc0 G1KV_2_go0
  s_mul_i32 s38, s39, 36864
  s_mul_i32 s32, s94, 9216
  s_add_u32 s38, s38, s32
  s_lshl_b32 s33, s94, 10
  s_and_b32 s34, s94, 1
  s_cmp_eq_u32 s34, 0
  v_mov_b32 v12, v5
  s_cselect_b64 vcc, -1, 0
  v_cndmask_b32 v12, v12, v4, vcc
  s_add_u32 m0, s33, 36864
  s_nop 0
  buffer_load_dwordx4 v12, s[8:11], s38 offen offset:0 sc1 lds
  s_add_u32 m0, s33, 40832
  s_nop 0
  buffer_load_dwordx4 v12, s[8:11], s38 offen offset:128 sc1 lds
  s_add_u32 m0, s33, 44800
  s_nop 0
  buffer_load_dwordx4 v12, s[8:11], s38 offen offset:256 sc1 lds
  s_add_u32 m0, s33, 48768
  s_nop 0
  buffer_load_dwordx4 v12, s[8:11], s38 offen offset:384 sc1 lds
  s_add_u32 m0, s33, 52736
  s_nop 0
  buffer_load_dwordx4 v12, s[8:11], s38 offen offset:512 sc1 lds
  s_add_u32 m0, s33, 56704
  s_nop 0
  buffer_load_dwordx4 v12, s[8:11], s38 offen offset:640 sc1 lds
  s_add_u32 m0, s33, 60672
  s_nop 0
  buffer_load_dwordx4 v12, s[8:11], s38 offen offset:768 sc1 lds
  s_add_u32 m0, s33, 64640
  s_nop 0
  buffer_load_dwordx4 v12, s[8:11], s38 offen offset:896 sc1 lds
  s_add_u32 m0, s33, 68608
  s_nop 0
  buffer_load_dwordx4 v12, s[8:11], s38 offen offset:1024 sc1 lds
G1KV_2_go0:
  s_cmp_lt_i32 s41, 0
  s_cbranch_scc1 G1KV_2_nf0
  s_cmp_eq_u32 s94, 0
  s_cbranch_scc0 G1KV_2_nf0
  s_lshl_b32 s32, s36, 8
  s_lshl_b32 s33, s41, 2
  s_add_u32 s32, s32, s33
  s_mov_b64 exec, 1
  v_mov_b32 v12, 1
  v_mov_b32 v13, 0
  buffer_store_dword v12, v13, s[24:27], s32 offen offset:0 sc1
  s_mov_b64 exec, -1
G1KV_2_nf0:
  ds_read_b128 v[48:51], v6 offset:0
  ds_read_b128 v[52:55], v7 offset:0
  ds_read_b128 v[56:59], v8 offset:0
  ds_read_b128 v[60:63], v9 offset:0
  s_waitcnt lgkmcnt(3)
  v_mfma_f32_32x32x16_bf16 v[16:31], a[0:3], v[48:51], 0
  v_mfma_f32_32x32x16_bf16 v[32:47], v[48:51], a[144:147], 0
  ds_read_b128 v[48:51], v6 offset:4096
  s_waitcnt lgkmcnt(3)
  v_mfma_f32_32x32x16_bf16 v[16:31], a[4:7], v[52:55], v[16:31]
  v_mfma_f32_32x32x16_bf16 v[32:47], v[52:55], a[148:151], v[32:47]
  ds_read_b128 v[52:55], v7 offset:4096
  s_waitcnt lgkmcnt(3)
  v_mfma_f32_32x32x16_bf16 v[16:31], a[8:11], v[56:59], v[16:31]
  v_mfma_f32_32x32x16_bf16 v[32:47], v[56:59], a[152:155], v[32:47]
  ds_read_b128 v[56:59], v8 offset:4096
  s_waitcnt lgkmcnt(3)
  v_mfma_f32_32x32x16_bf16 v[16:31], a[12:15], v[60:63], v[16:31]
  v_mfma_f32_32x32x16_bf16 v[32:47], v[60:63], a[156:159], v[32:47]
  ds_read_b128 v[60:63], v9 offset:4096
  s_waitcnt lgkmcnt(3)
  v_mfma_f32_32x32x16_bf16 v[16:31], a[16:19], v[48:51], v[16:31]
  v_mfma_f32_32x32x16_bf16 v[32:47], v[48:51], a[160:163], v[32:47]
  ds_read_b128 v[48:51], v6 offset:8192
  s_waitcnt lgkmcnt(3)
  v_mfma_f32_32x32x16_bf16 v[16:31], a[20:23], v[52:55], v[16:31]
  v_mfma_f32_32x32x16_bf16 v[32:47], v[52:55], a[164:167], v[32:47]
  ds_read_b128 v[52:55], v7 offset:8192
  s_waitcnt lgkmcnt(3)
  v_mfma_f32_32x32x16_bf16 v[16:31], a[24:27], v[56:59], v[16:31]
  v_mfma_f32_32x32x16_bf16 v[32:47], v[56:59], a[168:171], v[32:47]
  ds_read_b128 v[56:59], v8 offset:8192
  s_waitcnt lgkmcnt(3)
  v_mfma_f32_32x32x16_bf16 v[16:31], a[28:31], v[60:63], v[16:31]
  v_mfma_f32_32x32x16_bf16 v[32:47], v[60:63], a[172:175], v[32:47]
  ds_read_b128 v[60:63], v9 offset:8192
  s_waitcnt lgkmcnt(3)
  v_mfma_f32_32x32x16_bf16 v[16:31], a[32:35], v[48:51], v[16:31]
  v_mfma_f32_32x32x16_bf16 v[32:47], v[48:51], a[176:179], v[32:47]
  ds_read_b128 v[48:51], v6 offset:12288
  s_waitcnt lgkmcnt(3)
  v_mfma_f32_32x32x16_bf16 v[16:31], a[36:39], v[52:55], v[16:31]
  v_mfma_f32_32x32x16_bf16 v[32:47], v[52:55], a[180:183], v[32:47]
  ds_read_b128 v[52:55], v7 offset:12288
  s_waitcnt lgkmcnt(3)
  v_mfma_f32_32x32x16_bf16 v[16:31], a[40:43], v[56:59], v[16:31]
  v_mfma_f32_32x32x16_bf16 v[32:47], v[56:59], a[184:187], v[32:47]
  ds_read_b128 v[56:59], v8 offset:12288
  s_waitcnt lgkmcnt(3)
  v_mfma_f32_32x32x16_bf16 v[16:31], a[44:47], v[60:63], v[16:31]
  v_mfma_f32_32x32x16_bf16 v[32:47], v[60:63], a[188:191], v[32:47]
  ds_read_b128 v[60:63], v9 offset:12288
  s_waitcnt lgkmcnt(3)
  v_mfma_f32_32x32x16_bf16 v[16:31], a[48:51], v[48:51], v[16:31]
  v_mfma_f32_32x32x16_bf16 v[32:47], v[48:51], a[192:195], v[32:47]
  ds_read_b128 v[48:51], v6 offset:16384
  s_waitcnt lgkmcnt(3)
  v_mfma_f32_32x32x16_bf16 v[16:31], a[52:55], v[52:55], v[16:31]
  v_mfma_f32_32x32x16_bf16 v[32:47], v[52:55], a[196:199], v[32:47]
  ds_read_b128 v[52:55], v7 offset:16384
  s_waitcnt lgkmcnt(3)
  v_mfma_f32_32x32x16_bf16 v[16:31], a[56:59], v[56:59], v[16:31]
  v_mfma_f32_32x32x16_bf16 v[32:47], v[56:59], a[200:203], v[32:47]
  ds_read_b128 v[56:59], v8 offset:16384
  s_waitcnt lgkmcnt(3)
  v_mfma_f32_32x32x16_bf16 v[16:31], a[60:63], v[60:63], v[16:31]
  v_mfma_f32_32x32x16_bf16 v[32:47], v[60:63], a[204:207], v[32:47]
  ds_read_b128 v[60:63], v9 offset:16384
  s_waitcnt lgkmcnt(3)
  v_mfma_f32_32x32x16_bf16 v[16:31], a[64:67], v[48:51], v[16:31]
  v_mfma_f32_32x32x16_bf16 v[32:47], v[48:51], a[208:211], v[32:47]
  ds_read_b128 v[48:51], v6 offset:20480
  s_waitcnt lgkmcnt(3)
  v_mfma_f32_32x32x16_bf16 v[16:31], a[68:71], v[52:55], v[16:31]
  v_mfma_f32_32x32x16_bf16 v[32:47], v[52:55], a[212:215], v[32:47]
  ds_read_b128 v[52:55], v7 offset:20480
  s_waitcnt lgkmcnt(3)
  v_mfma_f32_32x32x16_bf16 v[16:31], a[72:75], v[56:59], v[16:31]
  v_mfma_f32_32x32x16_bf16 v[32:47], v[56:59], a[216:219], v[32:47]
  ds_read_b128 v[56:59], v8 offset:20480
  s_waitcnt lgkmcnt(3)
  v_mfma_f32_32x32x16_bf16 v[16:31], a[76:79], v[60:63], v[16:31]
  v_mfma_f32_32x32x16_bf16 v[32:47], v[60:63], a[220:223], v[32:47]
  ds_read_b128 v[60:63], v9 offset:20480
  s_waitcnt lgkmcnt(3)
  v_mfma_f32_32x32x16_bf16 v[16:31], a[80:83], v[48:51], v[16:31]
  v_mfma_f32_32x32x16_bf16 v[32:47], v[48:51], a[224:227], v[32:47]
  ds_read_b128 v[48:51], v6 offset:24576
  s_waitcnt lgkmcnt(3)
  v_mfma_f32_32x32x16_bf16 v[16:31], a[84:87], v[52:55], v[16:31]
  v_mfma_f32_32x32x16_bf16 v[32:47], v[52:55], a[228:231], v[32:47]
  ds_read_b128 v[52:55], v7 offset:24576
  s_waitcnt lgkmcnt(3)
  v_mfma_f32_32x32x16_bf16 v[16:31], a[88:91], v[56:59], v[16:31]
  v_mfma_f32_32x32x16_bf16 v[32:47], v[56:59], a[232:235], v[32:47]
  ds_read_b128 v[56:59], v8 offset:24576
  s_waitcnt lgkmcnt(3)
  v_mfma_f32_32x32x16_bf16 v[16:31], a[92:95], v[60:63], v[16:31]
  v_mfma_f32_32x32x16_bf16 v[32:47], v[60:63], a[236:239], v[32:47]
  ds_read_b128 v[60:63], v9 offset:24576
  s_waitcnt lgkmcnt(3)
  v_mfma_f32_32x32x16_bf16 v[16:31], a[96:99], v[48:51], v[16:31]
  v_mfma_f32_32x32x16_bf16 v[32:47], v[48:51], a[240:243], v[32:47]
  ds_read_b128 v[48:51], v6 offset:28672
  s_waitcnt lgkmcnt(3)
  v_mfma_f32_32x32x16_bf16 v[16:31], a[100:103], v[52:55], v[16:31]
  v_mfma_f32_32x32x16_bf16 v[32:47], v[52:55], a[244:247], v[32:47]
  ds_read_b128 v[52:55], v7 offset:28672
  s_waitcnt lgkmcnt(3)
  v_mfma_f32_32x32x16_bf16 v[16:31], a[104:107], v[56:59], v[16:31]
  v_mfma_f32_32x32x16_bf16 v[32:47], v[56:59], a[248:251], v[32:47]
  ds_read_b128 v[56:59], v8 offset:28672
  s_waitcnt lgkmcnt(3)
  v_mfma_f32_32x32x16_bf16 v[16:31], a[108:111], v[60:63], v[16:31]
  v_mfma_f32_32x32x16_bf16 v[32:47], v[60:63], a[252:255], v[32:47]
  ds_read_b128 v[60:63], v9 offset:28672
  s_waitcnt lgkmcnt(3)
  v_mfma_f32_32x32x16_bf16 v[16:31], a[112:115], v[48:51], v[16:31]
  v_mfma_f32_32x32x16_bf16 v[32:47], v[48:51], v[64:67], v[32:47]
  ds_read_b128 v[48:51], v6 offset:32768
  s_waitcnt lgkmcnt(3)
  v_mfma_f32_32x32x16_bf16 v[16:31], a[116:119], v[52:55], v[16:31]
  v_mfma_f32_32x32x16_bf16 v[32:47], v[52:55], v[68:71], v[32:47]
  ds_read_b128 v[52:55], v7 offset:32768
  s_waitcnt lgkmcnt(3)
  v_mfma_f32_32x32x16_bf16 v[16:31], a[120:123], v[56:59], v[16:31]
  v_mfma_f32_32x32x16_bf16 v[32:47], v[56:59], v[72:75], v[32:47]
  ds_read_b128 v[56:59], v8 offset:32768
  s_waitcnt lgkmcnt(3)
  v_mfma_f32_32x32x16_bf16 v[16:31], a[124:127], v[60:63], v[16:31]
  v_mfma_f32_32x32x16_bf16 v[32:47], v[60:63], v[76:79], v[32:47]
  ds_read_b128 v[60:63], v9 offset:32768
  s_waitcnt lgkmcnt(3)
  v_mfma_f32_32x32x16_bf16 v[16:31], a[128:131], v[48:51], v[16:31]
  v_mfma_f32_32x32x16_bf16 v[32:47], v[48:51], v[80:83], v[32:47]
  s_waitcnt lgkmcnt(2)
  v_mfma_f32_32x32x16_bf16 v[16:31], a[132:135], v[52:55], v[16:31]
  v_mfma_f32_32x32x16_bf16 v[32:47], v[52:55], v[84:87], v[32:47]
  s_waitcnt lgkmcnt(1)
  v_mfma_f32_32x32x16_bf16 v[16:31], a[136:139], v[56:59], v[16:31]
  v_mfma_f32_32x32x16_bf16 v[32:47], v[56:59], v[88:91], v[32:47]
  s_waitcnt lgkmcnt(0)
  v_mfma_f32_32x32x16_bf16 v[16:31], a[140:143], v[60:63], v[16:31]
  v_mfma_f32_32x32x16_bf16 v[32:47], v[60:63], v[92:95], v[32:47]
  s_lshl_b32 s32, s37, 18
  s_lshl_b32 s33, s36, 13
  s_add_u32 s32, s32, s33
  s_lshl_b32 s33, s94, 11
  s_add_u32 s32, s32, s33
  s_nop 5
  v_cvt_pk_bf16_f32 v96, v16, v17
  v_cvt_pk_bf16_f32 v97, v18, v19
  v_cvt_pk_bf16_f32 v98, v24, v25
  v_cvt_pk_bf16_f32 v99, v26, v27
  v_cvt_pk_bf16_f32 v100, v20, v21
  v_cvt_pk_bf16_f32 v101, v22, v23
  v_cvt_pk_bf16_f32 v102, v28, v29
  v_cvt_pk_bf16_f32 v103, v30, v31
  buffer_store_dwordx4 v[96:99], v10, s[16:19], s32 offen sc1
  buffer_store_dwordx4 v[100:103], v10, s[16:19], s32 offen offset:512 sc1
  v_cvt_pk_bf16_f32 v104, v32, v33
  v_cvt_pk_bf16_f32 v105, v34, v35
  v_cvt_pk_bf16_f32 v106, v40, v41
  v_cvt_pk_bf16_f32 v107, v42, v43
  v_cvt_pk_bf16_f32 v108, v36, v37
  v_cvt_pk_bf16_f32 v109, v38, v39
  v_cvt_pk_bf16_f32 v110, v44, v45
  v_cvt_pk_bf16_f32 v111, v46, v47
  buffer_store_dwordx4 v[104:107], v10, s[20:23], s32 offen sc1
  buffer_store_dwordx4 v[108:111], v10, s[20:23], s32 offen offset:512 sc1
  s_mov_b32 s41, s40
  s_mov_b32 s40, s37
  s_mov_b32 s37, s39
  s_cmp_lt_u32 s37, 64
  s_cbranch_scc0 G1KV_2_end
  s_cmp_lt_i32 s40, 0
  s_cbranch_scc1 G1KV_2_w01
  s_waitcnt vmcnt(4)
  s_branch G1KV_2_w11
G1KV_2_w01:
  s_waitcnt vmcnt(0)
G1KV_2_w11:
  s_barrier
  s_add_u32 s39, s37, 7
  s_cmp_lt_u32 s39, 64
  s_cbranch_scc0 G1KV_2_go1
  s_mul_i32 s38, s39, 36864
  s_mul_i32 s32, s94, 9216
  s_add_u32 s38, s38, s32
  s_lshl_b32 s33, s94, 10
  s_and_b32 s34, s94, 1
  s_cmp_eq_u32 s34, 0
  v_mov_b32 v12, v5
  s_cselect_b64 vcc, -1, 0
  v_cndmask_b32 v12, v12, v4, vcc
  s_add_u32 m0, s33, 0
  s_nop 0
  buffer_load_dwordx4 v12, s[8:11], s38 offen offset:0 sc1 lds
  s_add_u32 m0, s33, 3968
  s_nop 0
  buffer_load_dwordx4 v12, s[8:11], s38 offen offset:128 sc1 lds
  s_add_u32 m0, s33, 7936
  s_nop 0
  buffer_load_dwordx4 v12, s[8:11], s38 offen offset:256 sc1 lds
  s_add_u32 m0, s33, 11904
  s_nop 0
  buffer_load_dwordx4 v12, s[8:11], s38 offen offset:384 sc1 lds
  s_add_u32 m0, s33, 15872
  s_nop 0
  buffer_load_dwordx4 v12, s[8:11], s38 offen offset:512 sc1 lds
  s_add_u32 m0, s33, 19840
  s_nop 0
  buffer_load_dwordx4 v12, s[8:11], s38 offen offset:640 sc1 lds
  s_add_u32 m0, s33, 23808
  s_nop 0
  buffer_load_dwordx4 v12, s[8:11], s38 offen offset:768 sc1 lds
  s_add_u32 m0, s33, 27776
  s_nop 0
  buffer_load_dwordx4 v12, s[8:11], s38 offen offset:896 sc1 lds
  s_add_u32 m0, s33, 31744
  s_nop 0
  buffer_load_dwordx4 v12, s[8:11], s38 offen offset:1024 sc1 lds
G1KV_2_go1:
  s_cmp_lt_i32 s41, 0
  s_cbranch_scc1 G1KV_2_nf1
  s_cmp_eq_u32 s94, 0
  s_cbranch_scc0 G1KV_2_nf1
  s_lshl_b32 s32, s36, 8
  s_lshl_b32 s33, s41, 2
  s_add_u32 s32, s32, s33
  s_mov_b64 exec, 1
  v_mov_b32 v12, 1
  v_mov_b32 v13, 0
  buffer_store_dword v12, v13, s[24:27], s32 offen offset:0 sc1
  s_mov_b64 exec, -1
G1KV_2_nf1:
  ds_read_b128 v[48:51], v112 offset:0
  ds_read_b128 v[52:55], v113 offset:0
  ds_read_b128 v[56:59], v114 offset:0
  ds_read_b128 v[60:63], v115 offset:0
  s_waitcnt lgkmcnt(3)
  v_mfma_f32_32x32x16_bf16 v[16:31], a[0:3], v[48:51], 0
  v_mfma_f32_32x32x16_bf16 v[32:47], v[48:51], a[144:147], 0
  ds_read_b128 v[48:51], v112 offset:4096
  s_waitcnt lgkmcnt(3)
  v_mfma_f32_32x32x16_bf16 v[16:31], a[4:7], v[52:55], v[16:31]
  v_mfma_f32_32x32x16_bf16 v[32:47], v[52:55], a[148:151], v[32:47]
  ds_read_b128 v[52:55], v113 offset:4096
  s_waitcnt lgkmcnt(3)
  v_mfma_f32_32x32x16_bf16 v[16:31], a[8:11], v[56:59], v[16:31]
  v_mfma_f32_32x32x16_bf16 v[32:47], v[56:59], a[152:155], v[32:47]
  ds_read_b128 v[56:59], v114 offset:4096
  s_waitcnt lgkmcnt(3)
  v_mfma_f32_32x32x16_bf16 v[16:31], a[12:15], v[60:63], v[16:31]
  v_mfma_f32_32x32x16_bf16 v[32:47], v[60:63], a[156:159], v[32:47]
  ds_read_b128 v[60:63], v115 offset:4096
  s_waitcnt lgkmcnt(3)
  v_mfma_f32_32x32x16_bf16 v[16:31], a[16:19], v[48:51], v[16:31]
  v_mfma_f32_32x32x16_bf16 v[32:47], v[48:51], a[160:163], v[32:47]
  ds_read_b128 v[48:51], v112 offset:8192
  s_waitcnt lgkmcnt(3)
  v_mfma_f32_32x32x16_bf16 v[16:31], a[20:23], v[52:55], v[16:31]
  v_mfma_f32_32x32x16_bf16 v[32:47], v[52:55], a[164:167], v[32:47]
  ds_read_b128 v[52:55], v113 offset:8192
  s_waitcnt lgkmcnt(3)
  v_mfma_f32_32x32x16_bf16 v[16:31], a[24:27], v[56:59], v[16:31]
  v_mfma_f32_32x32x16_bf16 v[32:47], v[56:59], a[168:171], v[32:47]
  ds_read_b128 v[56:59], v114 offset:8192
  s_waitcnt lgkmcnt(3)
  v_mfma_f32_32x32x16_bf16 v[16:31], a[28:31], v[60:63], v[16:31]
  v_mfma_f32_32x32x16_bf16 v[32:47], v[60:63], a[172:175], v[32:47]
  ds_read_b128 v[60:63], v115 offset:8192
  s_waitcnt lgkmcnt(3)
  v_mfma_f32_32x32x16_bf16 v[16:31], a[32:35], v[48:51], v[16:31]
  v_mfma_f32_32x32x16_bf16 v[32:47], v[48:51], a[176:179], v[32:47]
  ds_read_b128 v[48:51], v112 offset:12288
  s_waitcnt lgkmcnt(3)
  v_mfma_f32_32x32x16_bf16 v[16:31], a[36:39], v[52:55], v[16:31]
  v_mfma_f32_32x32x16_bf16 v[32:47], v[52:55], a[180:183], v[32:47]
  ds_read_b128 v[52:55], v113 offset:12288
  s_waitcnt lgkmcnt(3)
  v_mfma_f32_32x32x16_bf16 v[16:31], a[40:43], v[56:59], v[16:31]
  v_mfma_f32_32x32x16_bf16 v[32:47], v[56:59], a[184:187], v[32:47]
  ds_read_b128 v[56:59], v114 offset:12288
  s_waitcnt lgkmcnt(3)
  v_mfma_f32_32x32x16_bf16 v[16:31], a[44:47], v[60:63], v[16:31]
  v_mfma_f32_32x32x16_bf16 v[32:47], v[60:63], a[188:191], v[32:47]
  ds_read_b128 v[60:63], v115 offset:12288
  s_waitcnt lgkmcnt(3)
  v_mfma_f32_32x32x16_bf16 v[16:31], a[48:51], v[48:51], v[16:31]
  v_mfma_f32_32x32x16_bf16 v[32:47], v[48:51], a[192:195], v[32:47]
  ds_read_b128 v[48:51], v112 offset:16384
  s_waitcnt lgkmcnt(3)
  v_mfma_f32_32x32x16_bf16 v[16:31], a[52:55], v[52:55], v[16:31]
  v_mfma_f32_32x32x16_bf16 v[32:47], v[52:55], a[196:199], v[32:47]
  ds_read_b128 v[52:55], v113 offset:16384
  s_waitcnt lgkmcnt(3)
  v_mfma_f32_32x32x16_bf16 v[16:31], a[56:59], v[56:59], v[16:31]
  v_mfma_f32_32x32x16_bf16 v[32:47], v[56:59], a[200:203], v[32:47]
  ds_read_b128 v[56:59], v114 offset:16384
  s_waitcnt lgkmcnt(3)
  v_mfma_f32_32x32x16_bf16 v[16:31], a[60:63], v[60:63], v[16:31]
  v_mfma_f32_32x32x16_bf16 v[32:47], v[60:63], a[204:207], v[32:47]
  ds_read_b128 v[60:63], v115 offset:16384
  s_waitcnt lgkmcnt(3)
  v_mfma_f32_32x32x16_bf16 v[16:31], a[64:67], v[48:51], v[16:31]
  v_mfma_f32_32x32x16_bf16 v[32:47], v[48:51], a[208:211], v[32:47]
  ds_read_b128 v[48:51], v112 offset:20480
  s_waitcnt lgkmcnt(3)
  v_mfma_f32_32x32x16_bf16 v[16:31], a[68:71], v[52:55], v[16:31]
  v_mfma_f32_32x32x16_bf16 v[32:47], v[52:55], a[212:215], v[32:47]
  ds_read_b128 v[52:55], v113 offset:20480
  s_waitcnt lgkmcnt(3)
  v_mfma_f32_32x32x16_bf16 v[16:31], a[72:75], v[56:59], v[16:31]
  v_mfma_f32_32x32x16_bf16 v[32:47], v[56:59], a[216:219], v[32:47]
  ds_read_b128 v[56:59], v114 offset:20480
  s_waitcnt lgkmcnt(3)
  v_mfma_f32_32x32x16_bf16 v[16:31], a[76:79], v[60:63], v[16:31]
  v_mfma_f32_32x32x16_bf16 v[32:47], v[60:63], a[220:223], v[32:47]
  ds_read_b128 v[60:63], v115 offset:20480
  s_waitcnt lgkmcnt(3)
  v_mfma_f32_32x32x16_bf16 v[16:31], a[80:83], v[48:51], v[16:31]
  v_mfma_f32_32x32x16_bf16 v[32:47], v[48:51], a[224:227], v[32:47]
  ds_read_b128 v[48:51], v112 offset:24576
  s_waitcnt lgkmcnt(3)
  v_mfma_f32_32x32x16_bf16 v[16:31], a[84:87], v[52:55], v[16:31]
  v_mfma_f32_32x32x16_bf16 v[32:47], v[52:55], a[228:231], v[32:47]
  ds_read_b128 v[52:55], v113 offset:24576
  s_waitcnt lgkmcnt(3)
  v_mfma_f32_32x32x16_bf16 v[16:31], a[88:91], v[56:59], v[16:31]
  v_mfma_f32_32x32x16_bf16 v[32:47], v[56:59], a[232:235], v[32:47]
  ds_read_b128 v[56:59], v114 offset:24576
  s_waitcnt lgkmcnt(3)
  v_mfma_f32_32x32x16_bf16 v[16:31], a[92:95], v[60:63], v[16:31]
  v_mfma_f32_32x32x16_bf16 v[32:47], v[60:63], a[236:239], v[32:47]
  ds_read_b128 v[60:63], v115 offset:24576
  s_waitcnt lgkmcnt(3)
  v_mfma_f32_32x32x16_bf16 v[16:31], a[96:99], v[48:51], v[16:31]
  v_mfma_f32_32x32x16_bf16 v[32:47], v[48:51], a[240:243], v[32:47]
  ds_read_b128 v[48:51], v112 offset:28672
  s_waitcnt lgkmcnt(3)
  v_mfma_f32_32x32x16_bf16 v[16:31], a[100:103], v[52:55], v[16:31]
  v_mfma_f32_32x32x16_bf16 v[32:47], v[52:55], a[244:247], v[32:47]
  ds_read_b128 v[52:55], v113 offset:28672
  s_waitcnt lgkmcnt(3)
  v_mfma_f32_32x32x16_bf16 v[16:31], a[104:107], v[56:59], v[16:31]
  v_mfma_f32_32x32x16_bf16 v[32:47], v[56:59], a[248:251], v[32:47]
  ds_read_b128 v[56:59], v114 offset:28672
  s_waitcnt lgkmcnt(3)
  v_mfma_f32_32x32x16_bf16 v[16:31], a[108:111], v[60:63], v[16:31]
  v_mfma_f32_32x32x16_bf16 v[32:47], v[60:63], a[252:255], v[32:47]
  ds_read_b128 v[60:63], v115 offset:28672
  s_waitcnt lgkmcnt(3)
  v_mfma_f32_32x32x16_bf16 v[16:31], a[112:115], v[48:51], v[16:31]
  v_mfma_f32_32x32x16_bf16 v[32:47], v[48:51], v[64:67], v[32:47]
  ds_read_b128 v[48:51], v112 offset:32768
  s_waitcnt lgkmcnt(3)
  v_mfma_f32_32x32x16_bf16 v[16:31], a[116:119], v[52:55], v[16:31]
  v_mfma_f32_32x32x16_bf16 v[32:47], v[52:55], v[68:71], v[32:47]
  ds_read_b128 v[52:55], v113 offset:32768
  s_waitcnt lgkmcnt(3)
  v_mfma_f32_32x32x16_bf16 v[16:31], a[120:123], v[56:59], v[16:31]
  v_mfma_f32_32x32x16_bf16 v[32:47], v[56:59], v[72:75], v[32:47]
  ds_read_b128 v[56:59], v114 offset:32768
  s_waitcnt lgkmcnt(3)
  v_mfma_f32_32x32x16_bf16 v[16:31], a[124:127], v[60:63], v[16:31]
  v_mfma_f32_32x32x16_bf16 v[32:47], v[60:63], v[76:79], v[32:47]
  ds_read_b128 v[60:63], v115 offset:32768
  s_waitcnt lgkmcnt(3)
  v_mfma_f32_32x32x16_bf16 v[16:31], a[128:131], v[48:51], v[16:31]
  v_mfma_f32_32x32x16_bf16 v[32:47], v[48:51], v[80:83], v[32:47]
  s_waitcnt lgkmcnt(2)
  v_mfma_f32_32x32x16_bf16 v[16:31], a[132:135], v[52:55], v[16:31]
  v_mfma_f32_32x32x16_bf16 v[32:47], v[52:55], v[84:87], v[32:47]
  s_waitcnt lgkmcnt(1)
  v_mfma_f32_32x32x16_bf16 v[16:31], a[136:139], v[56:59], v[16:31]
  v_mfma_f32_32x32x16_bf16 v[32:47], v[56:59], v[88:91], v[32:47]
  s_waitcnt lgkmcnt(0)
  v_mfma_f32_32x32x16_bf16 v[16:31], a[140:143], v[60:63], v[16:31]
  v_mfma_f32_32x32x16_bf16 v[32:47], v[60:63], v[92:95], v[32:47]
  s_lshl_b32 s32, s37, 18
  s_lshl_b32 s33, s36, 13
  s_add_u32 s32, s32, s33
  s_lshl_b32 s33, s94, 11
  s_add_u32 s32, s32, s33
  s_nop 5
  v_cvt_pk_bf16_f32 v96, v16, v17
  v_cvt_pk_bf16_f32 v97, v18, v19
  v_cvt_pk_bf16_f32 v98, v24, v25
  v_cvt_pk_bf16_f32 v99, v26, v27
  v_cvt_pk_bf16_f32 v100, v20, v21
  v_cvt_pk_bf16_f32 v101, v22, v23
  v_cvt_pk_bf16_f32 v102, v28, v29
  v_cvt_pk_bf16_f32 v103, v30, v31
  buffer_store_dwordx4 v[96:99], v10, s[16:19], s32 offen sc1
  buffer_store_dwordx4 v[100:103], v10, s[16:19], s32 offen offset:512 sc1
  v_cvt_pk_bf16_f32 v104, v32, v33
  v_cvt_pk_bf16_f32 v105, v34, v35
  v_cvt_pk_bf16_f32 v106, v40, v41
  v_cvt_pk_bf16_f32 v107, v42, v43
  v_cvt_pk_bf16_f32 v108, v36, v37
  v_cvt_pk_bf16_f32 v109, v38, v39
  v_cvt_pk_bf16_f32 v110, v44, v45
  v_cvt_pk_bf16_f32 v111, v46, v47
  buffer_store_dwordx4 v[104:107], v10, s[20:23], s32 offen sc1
  buffer_store_dwordx4 v[108:111], v10, s[20:23], s32 offen offset:512 sc1
  s_mov_b32 s41, s40
  s_mov_b32 s40, s37
  s_mov_b32 s37, s39
  s_cmp_lt_u32 s37, 64
  s_cbranch_scc0 G1KV_2_end
  s_branch G1KV_2
G1KV_2_end:
  s_waitcnt vmcnt(0)
  s_barrier
  s_cmp_eq_u32 s94, 0
  s_cbranch_scc0 G1KV_2_nfe
  s_mov_b64 exec, 1
  v_mov_b32 v12, 1
  v_mov_b32 v13, 0
  s_lshl_b32 s32, s36, 8
  s_lshl_b32 s33, s40, 2
  s_add_u32 s32, s32, s33
  buffer_store_dword v12, v13, s[24:27], s32 offen offset:0 sc1
  s_cmp_lt_i32 s41, 0
  s_cbranch_scc1 G1KV_2_nf2
  s_lshl_b32 s32, s36, 8
  s_lshl_b32 s33, s41, 2
  s_add_u32 s32, s32, s33
  buffer_store_dword v12, v13, s[24:27], s32 offen offset:0 sc1
G1KV_2_nf2:
  s_mov_b64 exec, -1
G1KV_2_nfe:
  s_mul_hi_u32 s36, s95, 613566757
  s_mul_i32 s37, s36, 7
  s_sub_u32 s37, s95, s37
  v_lshrrev_b32 v12, 4, v0
  v_and_b32 v13, 15, v0
  v_lshlrev_b32 v14, 1, v12
  v_xor_b32 v14, v14, v13
  v_lshlrev_b32 v15, 13, v12
  v_lshl_add_u32 v1, v14, 4, v15
  v_xor_b32 v14, 8, v14
  v_lshl_add_u32 v2, v14, 4, v15
  v_lshrrev_b32 v14, 2, v13
  v_lshrrev_b32 v15, 1, v12
  v_lshl_or_b32 v16, v15, 3, v14
  v_lshl_or_b32 v17, v15, 2, v14
  v_and_b32 v18, 1, v12
  s_lshl_b32 s32, s94, 1
  v_or_b32 v18, s32, v18
  v_xor_b32 v18, v18, v17
  v_lshlrev_b32 v18, 5, v18
  v_lshl_add_u32 v18, v16, 8, v18
  v_and_b32 v19, 3, v0
  v_lshl_add_u32 v3, v19, 3, v18
  v_lshrrev_b32 v14, 3, v0
  v_mul_u32_u24 v15, 1152, v14
  v_lshrrev_b32 v14, 1, v14
  v_and_b32 v16, 7, v0
  v_xor_b32 v16, v16, v14
  v_lshl_add_u32 v4, v16, 4, v15
  v_xor_b32 v16, 4, v16
  v_lshl_add_u32 v5, v16, 4, v15
  v_and_b32 v14, 31, v0
  v_lshrrev_b32 v15, 5, v0
  v_bfe_u32 v16, v14, 1, 3
  v_lshlrev_b32 v14, 7, v14
  v_or_b32 v17, 0, v15
  v_xor_b32 v17, v17, v16
  v_lshl_add_u32 v6, v17, 4, v14
  v_add_u32 v112, 36864, v6
  v_or_b32 v17, 2, v15
  v_xor_b32 v17, v17, v16
  v_lshl_add_u32 v7, v17, 4, v14
  v_add_u32 v113, 36864, v7
  v_or_b32 v17, 4, v15
  v_xor_b32 v17, v17, v16
  v_lshl_add_u32 v8, v17, 4, v14
  v_add_u32 v114, 36864, v8
  v_or_b32 v17, 6, v15
  v_xor_b32 v17, v17, v16
  v_lshl_add_u32 v9, v17, 4, v14
  v_add_u32 v115, 36864, v9
  v_bfe_u32 v14, v0, 4, 1
  v_lshlrev_b32 v14, 10, v14
  v_lshrrev_b32 v15, 5, v0
  v_lshl_add_u32 v14, v15, 8, v14
  v_and_b32 v15, 15, v0
  v_lshl_add_u32 v10, v15, 4, v14
  s_mov_b32 s8, s68
  s_mov_b32 s9, s69
  s_mov_b32 s10, 0x480000
  s_mov_b32 s11, 0x00020000
  s_lshl_b32 s33, s36, 8
  s_lshl_b32 s32, s94, 17
  s_add_u32 s33, s33, s32
  s_lshl_b32 s34, s94, 12
  s_add_u32 s34, s34, 0
  s_barrier
  s_add_u32 m0, s34, 0
  s_add_u32 s32, s33, 0
  buffer_load_dwordx4 v1, s[8:11], s32 offen lds
  s_add_u32 m0, s34, 1024
  s_add_u32 s32, s33, 32768
  buffer_load_dwordx4 v1, s[8:11], s32 offen lds
  s_add_u32 m0, s34, 2048
  s_add_u32 s32, s33, 65536
  buffer_load_dwordx4 v2, s[8:11], s32 offen lds
  s_add_u32 m0, s34, 3072
  s_add_u32 s32, s33, 98304
  buffer_load_dwordx4 v2, s[8:11], s32 offen lds
  s_add_u32 m0, s34, 16384
  s_add_u32 s32, s33, 524288
  buffer_load_dwordx4 v1, s[8:11], s32 offen lds
  s_add_u32 m0, s34, 17408
  s_add_u32 s32, s33, 557056
  buffer_load_dwordx4 v1, s[8:11], s32 offen lds
  s_add_u32 m0, s34, 18432
  s_add_u32 s32, s33, 589824
  buffer_load_dwordx4 v2, s[8:11], s32 offen lds
  s_add_u32 m0, s34, 19456
  s_add_u32 s32, s33, 622592
  buffer_load_dwordx4 v2, s[8:11], s32 offen lds
  s_add_u32 m0, s34, 32768
  s_add_u32 s32, s33, 1048576
  buffer_load_dwordx4 v1, s[8:11], s32 offen lds
  s_add_u32 m0, s34, 33792
  s_add_u32 s32, s33, 1081344
  buffer_load_dwordx4 v1, s[8:11], s32 offen lds
  s_add_u32 m0, s34, 34816
  s_add_u32 s32, s33, 1114112
  buffer_load_dwordx4 v2, s[8:11], s32 offen lds
  s_add_u32 m0, s34, 35840
  s_add_u32 s32, s33, 1146880
  buffer_load_dwordx4 v2, s[8:11], s32 offen lds
  s_add_u32 m0, s34, 49152
  s_add_u32 s32, s33, 1572864
  buffer_load_dwordx4 v1, s[8:11], s32 offen lds
  s_add_u32 m0, s34, 50176
  s_add_u32 s32, s33, 1605632
  buffer_load_dwordx4 v1, s[8:11], s32 offen lds
  s_add_u32 m0, s34, 51200
  s_add_u32 s32, s33, 1638400
  buffer_load_dwordx4 v2, s[8:11], s32 offen lds
  s_add_u32 m0, s34, 52224
  s_add_u32 s32, s33, 1671168
  buffer_load_dwordx4 v2, s[8:11], s32 offen lds
  s_add_u32 m0, s34, 65536
  s_add_u32 s32, s33, 2097152
  buffer_load_dwordx4 v1, s[8:11], s32 offen lds
  s_add_u32 m0, s34, 66560
  s_add_u32 s32, s33, 2129920
  buffer_load_dwordx4 v1, s[8:11], s32 offen lds
  s_add_u32 m0, s34, 67584
  s_add_u32 s32, s33, 2162688
  buffer_load_dwordx4 v2, s[8:11], s32 offen lds
  s_add_u32 m0, s34, 68608
  s_add_u32 s32, s33, 2195456
  buffer_load_dwordx4 v2, s[8:11], s32 offen lds
  s_add_u32 m0, s34, 81920
  s_add_u32 s32, s33, 2621440
  buffer_load_dwordx4 v1, s[8:11], s32 offen lds
  s_add_u32 m0, s34, 82944
  s_add_u32 s32, s33, 2654208
  buffer_load_dwordx4 v1, s[8:11], s32 offen lds
  s_add_u32 m0, s34, 83968
  s_add_u32 s32, s33, 2686976
  buffer_load_dwordx4 v2, s[8:11], s32 offen lds
  s_add_u32 m0, s34, 84992
  s_add_u32 s32, s33, 2719744
  buffer_load_dwordx4 v2, s[8:11], s32 offen lds
  s_add_u32 m0, s34, 98304
  s_add_u32 s32, s33, 3145728
  buffer_load_dwordx4 v1, s[8:11], s32 offen lds
  s_add_u32 m0, s34, 99328
  s_add_u32 s32, s33, 3178496
  buffer_load_dwordx4 v1, s[8:11], s32 offen lds
  s_add_u32 m0, s34, 100352
  s_add_u32 s32, s33, 3211264
  buffer_load_dwordx4 v2, s[8:11], s32 offen lds
  s_add_u32 m0, s34, 101376
  s_add_u32 s32, s33, 3244032
  buffer_load_dwordx4 v2, s[8:11], s32 offen lds
  s_add_u32 m0, s34, 114688
  s_add_u32 s32, s33, 3670016
  buffer_load_dwordx4 v1, s[8:11], s32 offen lds
  s_add_u32 m0, s34, 115712
  s_add_u32 s32, s33, 3702784
  buffer_load_dwordx4 v1, s[8:11], s32 offen lds
  s_add_u32 m0, s34, 116736
  s_add_u32 s32, s33, 3735552
  buffer_load_dwordx4 v2, s[8:11], s32 offen lds
  s_add_u32 m0, s34, 117760
  s_add_u32 s32, s33, 3768320
  buffer_load_dwordx4 v2, s[8:11], s32 offen lds
  s_add_u32 m0, s34, 131072
  s_add_u32 s32, s33, 4194304
  buffer_load_dwordx4 v1, s[8:11], s32 offen lds
  s_add_u32 m0, s34, 132096
  s_add_u32 s32, s33, 4227072
  buffer_load_dwordx4 v1, s[8:11], s32 offen lds
  s_add_u32 m0, s34, 133120
  s_add_u32 s32, s33, 4259840
  buffer_load_dwordx4 v2, s[8:11], s32 offen lds
  s_add_u32 m0, s34, 134144
  s_add_u32 s32, s33, 4292608
  buffer_load_dwordx4 v2, s[8:11], s32 offen lds
  s_waitcnt vmcnt(32)
  s_barrier
  v_add_u32 v11, 0, v3
  ds_read_b64_tr_b16 a[0:1], v11 offset:0
  ds_read_b64_tr_b16 a[2:3], v11 offset:1024
  ds_read_b64_tr_b16 a[4:5], v11 offset:4096
  ds_read_b64_tr_b16 a[6:7], v11 offset:5120
  ds_read_b64_tr_b16 a[8:9], v11 offset:8192
  ds_read_b64_tr_b16 a[10:11], v11 offset:9216
  ds_read_b64_tr_b16 a[12:13], v11 offset:12288
  ds_read_b64_tr_b16 a[14:15], v11 offset:13312
  s_waitcnt lgkmcnt(0)
  s_waitcnt vmcnt(28)
  s_barrier
  v_add_u32 v11, 16384, v3
  ds_read_b64_tr_b16 a[16:17], v11 offset:0
  ds_read_b64_tr_b16 a[18:19], v11 offset:1024
  ds_read_b64_tr_b16 a[20:21], v11 offset:4096
  ds_read_b64_tr_b16 a[22:23], v11 offset:5120
  ds_read_b64_tr_b16 a[24:25], v11 offset:8192
  ds_read_b64_tr_b16 a[26:27], v11 offset:9216
  ds_read_b64_tr_b16 a[28:29], v11 offset:12288
  ds_read_b64_tr_b16 a[30:31], v11 offset:13312
  s_waitcnt lgkmcnt(0)
  s_waitcnt vmcnt(24)
  s_barrier
  v_add_u32 v11, 32768, v3
  ds_read_b64_tr_b16 a[32:33], v11 offset:0
  ds_read_b64_tr_b16 a[34:35], v11 offset:1024
  ds_read_b64_tr_b16 a[36:37], v11 offset:4096
  ds_read_b64_tr_b16 a[38:39], v11 offset:5120
  ds_read_b64_tr_b16 a[40:41], v11 offset:8192
  ds_read_b64_tr_b16 a[42:43], v11 offset:9216
  ds_read_b64_tr_b16 a[44:45], v11 offset:12288
  ds_read_b64_tr_b16 a[46:47], v11 offset:13312
  s_waitcnt lgkmcnt(0)
  s_waitcnt vmcnt(20)
  s_barrier
  v_add_u32 v11, 49152, v3
  ds_read_b64_tr_b16 a[48:49], v11 offset:0
  ds_read_b64_tr_b16 a[50:51], v11 offset:1024
  ds_read_b64_tr_b16 a[52:53], v11 offset:4096
  ds_read_b64_tr_b16 a[54:55], v11 offset:5120
  ds_read_b64_tr_b16 a[56:57], v11 offset:8192
  ds_read_b64_tr_b16 a[58:59], v11 offset:9216
  ds_read_b64_tr_b16 a[60:61], v11 offset:12288
  ds_read_b64_tr_b16 a[62:63], v11 offset:13312
  s_waitcnt lgkmcnt(0)
  s_waitcnt vmcnt(16)
  s_barrier
  v_add_u32 v11, 65536, v3
  ds_read_b64_tr_b16 a[64:65], v11 offset:0
  ds_read_b64_tr_b16 a[66:67], v11 offset:1024
  ds_read_b64_tr_b16 a[68:69], v11 offset:4096
  ds_read_b64_tr_b16 a[70:71], v11 offset:5120
  ds_read_b64_tr_b16 a[72:73], v11 offset:8192
  ds_read_b64_tr_b16 a[74:75], v11 offset:9216
  ds_read_b64_tr_b16 a[76:77], v11 offset:12288
  ds_read_b64_tr_b16 a[78:79], v11 offset:13312
  s_waitcnt lgkmcnt(0)
  s_waitcnt vmcnt(12)
  s_barrier
  v_add_u32 v11, 81920, v3
  ds_read_b64_tr_b16 a[80:81], v11 offset:0
  ds_read_b64_tr_b16 a[82:83], v11 offset:1024
  ds_read_b64_tr_b16 a[84:85], v11 offset:4096
  ds_read_b64_tr_b16 a[86:87], v11 offset:5120
  ds_read_b64_tr_b16 a[88:89], v11 offset:8192
  ds_read_b64_tr_b16 a[90:91], v11 offset:9216
  ds_read_b64_tr_b16 a[92:93], v11 offset:12288
  ds_read_b64_tr_b16 a[94:95], v11 offset:13312
  s_waitcnt lgkmcnt(0)
  s_waitcnt vmcnt(8)
  s_barrier
  v_add_u32 v11, 98304, v3
  ds_read_b64_tr_b16 a[96:97], v11 offset:0
  ds_read_b64_tr_b16 a[98:99], v11 offset:1024
  ds_read_b64_tr_b16 a[100:101], v11 offset:4096
  ds_read_b64_tr_b16 a[102:103], v11 offset:5120
  ds_read_b64_tr_b16 a[104:105], v11 offset:8192
  ds_read_b64_tr_b16 a[106:107], v11 offset:9216
  ds_read_b64_tr_b16 a[108:109], v11 offset:12288
  ds_read_b64_tr_b16 a[110:111], v11 offset:13312
  s_waitcnt lgkmcnt(0)
  s_waitcnt vmcnt(4)
  s_barrier
  v_add_u32 v11, 114688, v3
  ds_read_b64_tr_b16 a[112:113], v11 offset:0
  ds_read_b64_tr_b16 a[114:115], v11 offset:1024
  ds_read_b64_tr_b16 a[116:117], v11 offset:4096
  ds_read_b64_tr_b16 a[118:119], v11 offset:5120
  ds_read_b64_tr_b16 a[120:121], v11 offset:8192
  ds_read_b64_tr_b16 a[122:123], v11 offset:9216
  ds_read_b64_tr_b16 a[124:125], v11 offset:12288
  ds_read_b64_tr_b16 a[126:127], v11 offset:13312
  s_waitcnt lgkmcnt(0)
  s_waitcnt vmcnt(0)
  s_barrier
  v_add_u32 v11, 131072, v3
  ds_read_b64_tr_b16 a[128:129], v11 offset:0
  ds_read_b64_tr_b16 a[130:131], v11 offset:1024
  ds_read_b64_tr_b16 a[132:133], v11 offset:4096
  ds_read_b64_tr_b16 a[134:135], v11 offset:5120
  ds_read_b64_tr_b16 a[136:137], v11 offset:8192
  ds_read_b64_tr_b16 a[138:139], v11 offset:9216
  ds_read_b64_tr_b16 a[140:141], v11 offset:12288
  ds_read_b64_tr_b16 a[142:143], v11 offset:13312
  s_waitcnt lgkmcnt(0)
  s_barrier
  s_add_u32 s8, s92, 0x100000
  s_addc_u32 s9, s93, 0
  s_mov_b32 s10, 0x240000
  s_mov_b32 s11, 0x00020000
  s_add_u32 s16, s92, 0x2800000
  s_addc_u32 s17, s93, 0
  s_mov_b32 s18, 0x1000000
  s_mov_b32 s19, 0x00020000
  s_add_u32 s24, s92, 0x60000
  s_addc_u32 s25, s93, 0
  s_mov_b32 s26, 0x5600
  s_mov_b32 s27, 0x00020000
  s_mul_i32 s38, s37, 36864
  s_mul_i32 s32, s94, 9216
  s_add_u32 s38, s38, s32
  s_lshl_b32 s33, s94, 10
  s_and_b32 s34, s94, 1
  s_cmp_eq_u32 s34, 0
  v_mov_b32 v12, v5
  s_cselect_b64 vcc, -1, 0
  v_cndmask_b32 v12, v12, v4, vcc
  s_add_u32 m0, s33, 0
  s_nop 0
  buffer_load_dwordx4 v12, s[8:11], s38 offen offset:0 sc1 lds
  s_add_u32 m0, s33, 3968
  s_nop 0
  buffer_load_dwordx4 v12, s[8:11], s38 offen offset:128 sc1 lds
  s_add_u32 m0, s33, 7936
  s_nop 0
  buffer_load_dwordx4 v12, s[8:11], s38 offen offset:256 sc1 lds
  s_add_u32 m0, s33, 11904
  s_nop 0
  buffer_load_dwordx4 v12, s[8:11], s38 offen offset:384 sc1 lds
  s_add_u32 m0, s33, 15872
  s_nop 0
  buffer_load_dwordx4 v12, s[8:11], s38 offen offset:512 sc1 lds
  s_add_u32 m0, s33, 19840
  s_nop 0
  buffer_load_dwordx4 v12, s[8:11], s38 offen offset:640 sc1 lds
  s_add_u32 m0, s33, 23808
  s_nop 0
  buffer_load_dwordx4 v12, s[8:11], s38 offen offset:768 sc1 lds
  s_add_u32 m0, s33, 27776
  s_nop 0
  buffer_load_dwordx4 v12, s[8:11], s38 offen offset:896 sc1 lds
  s_add_u32 m0, s33, 31744
  s_nop 0
  buffer_load_dwordx4 v12, s[8:11], s38 offen offset:1024 sc1 lds
  s_mov_b32 s40, -1
  s_mov_b32 s41, -1
G1Q_4:
  s_cmp_lt_i32 s40, 0
  s_cbranch_scc1 G1Q_4_w00
  s_waitcnt vmcnt(2)
  s_branch G1Q_4_w10
G1Q_4_w00:
  s_waitcnt vmcnt(0)
G1Q_4_w10:
  s_barrier
  s_add_u32 s39, s37, 7
  s_cmp_lt_u32 s39, 64
  s_cbranch_scc0 G1Q_4_go0
  s_mul_i32 s38, s39, 36864
  s_mul_i32 s32, s94, 9216
  s_add_u32 s38, s38, s32
  s_lshl_b32 s33, s94, 10
  s_and_b32 s34, s94, 1
  s_cmp_eq_u32 s34, 0
  v_mov_b32 v12, v5
  s_cselect_b64 vcc, -1, 0
  v_cndmask_b32 v12, v12, v4, vcc
  s_add_u32 m0, s33, 36864
  s_nop 0
  buffer_load_dwordx4 v12, s[8:11], s38 offen offset:0 sc1 lds
  s_add_u32 m0, s33, 40832
  s_nop 0
  buffer_load_dwordx4 v12, s[8:11], s38 offen offset:128 sc1 lds
  s_add_u32 m0, s33, 44800
  s_nop 0
  buffer_load_dwordx4 v12, s[8:11], s38 offen offset:256 sc1 lds
  s_add_u32 m0, s33, 48768
  s_nop 0
  buffer_load_dwordx4 v12, s[8:11], s38 offen offset:384 sc1 lds
  s_add_u32 m0, s33, 52736
  s_nop 0
  buffer_load_dwordx4 v12, s[8:11], s38 offen offset:512 sc1 lds
  s_add_u32 m0, s33, 56704
  s_nop 0
  buffer_load_dwordx4 v12, s[8:11], s38 offen offset:640 sc1 lds
  s_add_u32 m0, s33, 60672
  s_nop 0
  buffer_load_dwordx4 v12, s[8:11], s38 offen offset:768 sc1 lds
  s_add_u32 m0, s33, 64640
  s_nop 0
  buffer_load_dwordx4 v12, s[8:11], s38 offen offset:896 sc1 lds
  s_add_u32 m0, s33, 68608
  s_nop 0
  buffer_load_dwordx4 v12, s[8:11], s38 offen offset:1024 sc1 lds
G1Q_4_go0:
  ds_read_b128 v[48:51], v6 offset:0
  ds_read_b128 v[52:55], v7 offset:0
  ds_read_b128 v[56:59], v8 offset:0
  ds_read_b128 v[60:63], v9 offset:0
  s_waitcnt lgkmcnt(3)
  v_mfma_f32_32x32x16_bf16 v[16:31], a[0:3], v[48:51], 0
  ds_read_b128 v[48:51], v6 offset:4096
  s_waitcnt lgkmcnt(3)
  v_mfma_f32_32x32x16_bf16 v[16:31], a[4:7], v[52:55], v[16:31]
  ds_read_b128 v[52:55], v7 offset:4096
  s_waitcnt lgkmcnt(3)
  v_mfma_f32_32x32x16_bf16 v[16:31], a[8:11], v[56:59], v[16:31]
  ds_read_b128 v[56:59], v8 offset:4096
  s_waitcnt lgkmcnt(3)
  v_mfma_f32_32x32x16_bf16 v[16:31], a[12:15], v[60:63], v[16:31]
  ds_read_b128 v[60:63], v9 offset:4096
  s_waitcnt lgkmcnt(3)
  v_mfma_f32_32x32x16_bf16 v[16:31], a[16:19], v[48:51], v[16:31]
  ds_read_b128 v[48:51], v6 offset:8192
  s_waitcnt lgkmcnt(3)
  v_mfma_f32_32x32x16_bf16 v[16:31], a[20:23], v[52:55], v[16:31]
  ds_read_b128 v[52:55], v7 offset:8192
  s_waitcnt lgkmcnt(3)
  v_mfma_f32_32x32x16_bf16 v[16:31], a[24:27], v[56:59], v[16:31]
  ds_read_b128 v[56:59], v8 offset:8192
  s_waitcnt lgkmcnt(3)
  v_mfma_f32_32x32x16_bf16 v[16:31], a[28:31], v[60:63], v[16:31]
  ds_read_b128 v[60:63], v9 offset:8192
  s_waitcnt lgkmcnt(3)
  v_mfma_f32_32x32x16_bf16 v[16:31], a[32:35], v[48:51], v[16:31]
  ds_read_b128 v[48:51], v6 offset:12288
  s_waitcnt lgkmcnt(3)
  v_mfma_f32_32x32x16_bf16 v[16:31], a[36:39], v[52:55], v[16:31]
  ds_read_b128 v[52:55], v7 offset:12288
  s_waitcnt lgkmcnt(3)
  v_mfma_f32_32x32x16_bf16 v[16:31], a[40:43], v[56:59], v[16:31]
  ds_read_b128 v[56:59], v8 offset:12288
  s_waitcnt lgkmcnt(3)
  v_mfma_f32_32x32x16_bf16 v[16:31], a[44:47], v[60:63], v[16:31]
  ds_read_b128 v[60:63], v9 offset:12288
  s_waitcnt lgkmcnt(3)
  v_mfma_f32_32x32x16_bf16 v[16:31], a[48:51], v[48:51], v[16:31]
  ds_read_b128 v[48:51], v6 offset:16384
  s_waitcnt lgkmcnt(3)
  v_mfma_f32_32x32x16_bf16 v[16:31], a[52:55], v[52:55], v[16:31]
  ds_read_b128 v[52:55], v7 offset:16384
  s_waitcnt lgkmcnt(3)
  v_mfma_f32_32x32x16_bf16 v[16:31], a[56:59], v[56:59], v[16:31]
  ds_read_b128 v[56:59], v8 offset:16384
  s_waitcnt lgkmcnt(3)
  v_mfma_f32_32x32x16_bf16 v[16:31], a[60:63], v[60:63], v[16:31]
  ds_read_b128 v[60:63], v9 offset:16384
  s_waitcnt lgkmcnt(3)
  v_mfma_f32_32x32x16_bf16 v[16:31], a[64:67], v[48:51], v[16:31]
  ds_read_b128 v[48:51], v6 offset:20480
  s_waitcnt lgkmcnt(3)
  v_mfma_f32_32x32x16_bf16 v[16:31], a[68:71], v[52:55], v[16:31]
  ds_read_b128 v[52:55], v7 offset:20480
  s_waitcnt lgkmcnt(3)
  v_mfma_f32_32x32x16_bf16 v[16:31], a[72:75], v[56:59], v[16:31]
  ds_read_b128 v[56:59], v8 offset:20480
  s_waitcnt lgkmcnt(3)
  v_mfma_f32_32x32x16_bf16 v[16:31], a[76:79], v[60:63], v[16:31]
  ds_read_b128 v[60:63], v9 offset:20480
  s_waitcnt lgkmcnt(3)
  v_mfma_f32_32x32x16_bf16 v[16:31], a[80:83], v[48:51], v[16:31]
  ds_read_b128 v[48:51], v6 offset:24576
  s_waitcnt lgkmcnt(3)
  v_mfma_f32_32x32x16_bf16 v[16:31], a[84:87], v[52:55], v[16:31]
  ds_read_b128 v[52:55], v7 offset:24576
  s_waitcnt lgkmcnt(3)
  v_mfma_f32_32x32x16_bf16 v[16:31], a[88:91], v[56:59], v[16:31]
  ds_read_b128 v[56:59], v8 offset:24576
  s_waitcnt lgkmcnt(3)
  v_mfma_f32_32x32x16_bf16 v[16:31], a[92:95], v[60:63], v[16:31]
  ds_read_b128 v[60:63], v9 offset:24576
  s_waitcnt lgkmcnt(3)
  v_mfma_f32_32x32x16_bf16 v[16:31], a[96:99], v[48:51], v[16:31]
  ds_read_b128 v[48:51], v6 offset:28672
  s_waitcnt lgkmcnt(3)
  v_mfma_f32_32x32x16_bf16 v[16:31], a[100:103], v[52:55], v[16:31]
  ds_read_b128 v[52:55], v7 offset:28672
  s_waitcnt lgkmcnt(3)
  v_mfma_f32_32x32x16_bf16 v[16:31], a[104:107], v[56:59], v[16:31]
  ds_read_b128 v[56:59], v8 offset:28672
  s_waitcnt lgkmcnt(3)
  v_mfma_f32_32x32x16_bf16 v[16:31], a[108:111], v[60:63], v[16:31]
  ds_read_b128 v[60:63], v9 offset:28672
  s_waitcnt lgkmcnt(3)
  v_mfma_f32_32x32x16_bf16 v[16:31], a[112:115], v[48:51], v[16:31]
  ds_read_b128 v[48:51], v6 offset:32768
  s_waitcnt lgkmcnt(3)
  v_mfma_f32_32x32x16_bf16 v[16:31], a[116:119], v[52:55], v[16:31]
  ds_read_b128 v[52:55], v7 offset:32768
  s_waitcnt lgkmcnt(3)
  v_mfma_f32_32x32x16_bf16 v[16:31], a[120:123], v[56:59], v[16:31]
  ds_read_b128 v[56:59], v8 offset:32768
  s_waitcnt lgkmcnt(3)
  v_mfma_f32_32x32x16_bf16 v[16:31], a[124:127], v[60:63], v[16:31]
  ds_read_b128 v[60:63], v9 offset:32768
  s_waitcnt lgkmcnt(3)
  v_mfma_f32_32x32x16_bf16 v[16:31], a[128:131], v[48:51], v[16:31]
  s_waitcnt lgkmcnt(2)
  v_mfma_f32_32x32x16_bf16 v[16:31], a[132:135], v[52:55], v[16:31]
  s_waitcnt lgkmcnt(1)
  v_mfma_f32_32x32x16_bf16 v[16:31], a[136:139], v[56:59], v[16:31]
  s_waitcnt lgkmcnt(0)
  v_mfma_f32_32x32x16_bf16 v[16:31], a[140:143], v[60:63], v[16:31]
  s_lshl_b32 s32, s37, 18
  s_lshl_b32 s33, s36, 13
  s_add_u32 s32, s32, s33
  s_lshl_b32 s33, s94, 11
  s_add_u32 s32, s32, s33
  s_mov_b32 s33, 0x3e0293ee
  s_nop 5
  v_mul_f32 v16, s33, v16
  v_mul_f32 v17, s33, v17
  v_mul_f32 v18, s33, v18
  v_mul_f32 v19, s33, v19
  v_mul_f32 v20, s33, v20
  v_mul_f32 v21, s33, v21
  v_mul_f32 v22, s33, v22
  v_mul_f32 v23, s33, v23
  v_mul_f32 v24, s33, v24
  v_mul_f32 v25, s33, v25
  v_mul_f32 v26, s33, v26
  v_mul_f32 v27, s33, v27
  v_mul_f32 v28, s33, v28
  v_mul_f32 v29, s33, v29
  v_mul_f32 v30, s33, v30
  v_mul_f32 v31, s33, v31
  v_cvt_pk_bf16_f32 v96, v16, v17
  v_cvt_pk_bf16_f32 v97, v18, v19
  v_cvt_pk_bf16_f32 v98, v24, v25
  v_cvt_pk_bf16_f32 v99, v26, v27
  v_cvt_pk_bf16_f32 v100, v20, v21
  v_cvt_pk_bf16_f32 v101, v22, v23
  v_cvt_pk_bf16_f32 v102, v28, v29
  v_cvt_pk_bf16_f32 v103, v30, v31
  buffer_store_dwordx4 v[96:99], v10, s[16:19], s32 offen sc1
  buffer_store_dwordx4 v[100:103], v10, s[16:19], s32 offen offset:512 sc1
  s_mov_b32 s41, s40
  s_mov_b32 s40, s37
  s_mov_b32 s37, s39
  s_cmp_lt_u32 s37, 64
  s_cbranch_scc0 G1Q_4_end
  s_cmp_lt_i32 s40, 0
  s_cbranch_scc1 G1Q_4_w01
  s_waitcnt vmcnt(2)
  s_branch G1Q_4_w11
G1Q_4_w01:
  s_waitcnt vmcnt(0)
G1Q_4_w11:
  s_barrier
  s_add_u32 s39, s37, 7
  s_cmp_lt_u32 s39, 64
  s_cbranch_scc0 G1Q_4_go1
  s_mul_i32 s38, s39, 36864
  s_mul_i32 s32, s94, 9216
  s_add_u32 s38, s38, s32
  s_lshl_b32 s33, s94, 10
  s_and_b32 s34, s94, 1
  s_cmp_eq_u32 s34, 0
  v_mov_b32 v12, v5
  s_cselect_b64 vcc, -1, 0
  v_cndmask_b32 v12, v12, v4, vcc
  s_add_u32 m0, s33, 0
  s_nop 0
  buffer_load_dwordx4 v12, s[8:11], s38 offen offset:0 sc1 lds
  s_add_u32 m0, s33, 3968
  s_nop 0
  buffer_load_dwordx4 v12, s[8:11], s38 offen offset:128 sc1 lds
  s_add_u32 m0, s33, 7936
  s_nop 0
  buffer_load_dwordx4 v12, s[8:11], s38 offen offset:256 sc1 lds
  s_add_u32 m0, s33, 11904
  s_nop 0
  buffer_load_dwordx4 v12, s[8:11], s38 offen offset:384 sc1 lds
  s_add_u32 m0, s33, 15872
  s_nop 0
  buffer_load_dwordx4 v12, s[8:11], s38 offen offset:512 sc1 lds
  s_add_u32 m0, s33, 19840
  s_nop 0
  buffer_load_dwordx4 v12, s[8:11], s38 offen offset:640 sc1 lds
  s_add_u32 m0, s33, 23808
  s_nop 0
  buffer_load_dwordx4 v12, s[8:11], s38 offen offset:768 sc1 lds
  s_add_u32 m0, s33, 27776
  s_nop 0
  buffer_load_dwordx4 v12, s[8:11], s38 offen offset:896 sc1 lds
  s_add_u32 m0, s33, 31744
  s_nop 0
  buffer_load_dwordx4 v12, s[8:11], s38 offen offset:1024 sc1 lds
G1Q_4_go1:
  ds_read_b128 v[48:51], v112 offset:0
  ds_read_b128 v[52:55], v113 offset:0
  ds_read_b128 v[56:59], v114 offset:0
  ds_read_b128 v[60:63], v115 offset:0
  s_waitcnt lgkmcnt(3)
  v_mfma_f32_32x32x16_bf16 v[16:31], a[0:3], v[48:51], 0
  ds_read_b128 v[48:51], v112 offset:4096
  s_waitcnt lgkmcnt(3)
  v_mfma_f32_32x32x16_bf16 v[16:31], a[4:7], v[52:55], v[16:31]
  ds_read_b128 v[52:55], v113 offset:4096
  s_waitcnt lgkmcnt(3)
  v_mfma_f32_32x32x16_bf16 v[16:31], a[8:11], v[56:59], v[16:31]
  ds_read_b128 v[56:59], v114 offset:4096
  s_waitcnt lgkmcnt(3)
  v_mfma_f32_32x32x16_bf16 v[16:31], a[12:15], v[60:63], v[16:31]
  ds_read_b128 v[60:63], v115 offset:4096
  s_waitcnt lgkmcnt(3)
  v_mfma_f32_32x32x16_bf16 v[16:31], a[16:19], v[48:51], v[16:31]
  ds_read_b128 v[48:51], v112 offset:8192
  s_waitcnt lgkmcnt(3)
  v_mfma_f32_32x32x16_bf16 v[16:31], a[20:23], v[52:55], v[16:31]
  ds_read_b128 v[52:55], v113 offset:8192
  s_waitcnt lgkmcnt(3)
  v_mfma_f32_32x32x16_bf16 v[16:31], a[24:27], v[56:59], v[16:31]
  ds_read_b128 v[56:59], v114 offset:8192
  s_waitcnt lgkmcnt(3)
  v_mfma_f32_32x32x16_bf16 v[16:31], a[28:31], v[60:63], v[16:31]
  ds_read_b128 v[60:63], v115 offset:8192
  s_waitcnt lgkmcnt(3)
  v_mfma_f32_32x32x16_bf16 v[16:31], a[32:35], v[48:51], v[16:31]
  ds_read_b128 v[48:51], v112 offset:12288
  s_waitcnt lgkmcnt(3)
  v_mfma_f32_32x32x16_bf16 v[16:31], a[36:39], v[52:55], v[16:31]
  ds_read_b128 v[52:55], v113 offset:12288
  s_waitcnt lgkmcnt(3)
  v_mfma_f32_32x32x16_bf16 v[16:31], a[40:43], v[56:59], v[16:31]
  ds_read_b128 v[56:59], v114 offset:12288
  s_waitcnt lgkmcnt(3)
  v_mfma_f32_32x32x16_bf16 v[16:31], a[44:47], v[60:63], v[16:31]
  ds_read_b128 v[60:63], v115 offset:12288
  s_waitcnt lgkmcnt(3)
  v_mfma_f32_32x32x16_bf16 v[16:31], a[48:51], v[48:51], v[16:31]
  ds_read_b128 v[48:51], v112 offset:16384
  s_waitcnt lgkmcnt(3)
  v_mfma_f32_32x32x16_bf16 v[16:31], a[52:55], v[52:55], v[16:31]
  ds_read_b128 v[52:55], v113 offset:16384
  s_waitcnt lgkmcnt(3)
  v_mfma_f32_32x32x16_bf16 v[16:31], a[56:59], v[56:59], v[16:31]
  ds_read_b128 v[56:59], v114 offset:16384
  s_waitcnt lgkmcnt(3)
  v_mfma_f32_32x32x16_bf16 v[16:31], a[60:63], v[60:63], v[16:31]
  ds_read_b128 v[60:63], v115 offset:16384
  s_waitcnt lgkmcnt(3)
  v_mfma_f32_32x32x16_bf16 v[16:31], a[64:67], v[48:51], v[16:31]
  ds_read_b128 v[48:51], v112 offset:20480
  s_waitcnt lgkmcnt(3)
  v_mfma_f32_32x32x16_bf16 v[16:31], a[68:71], v[52:55], v[16:31]
  ds_read_b128 v[52:55], v113 offset:20480
  s_waitcnt lgkmcnt(3)
  v_mfma_f32_32x32x16_bf16 v[16:31], a[72:75], v[56:59], v[16:31]
  ds_read_b128 v[56:59], v114 offset:20480
  s_waitcnt lgkmcnt(3)
  v_mfma_f32_32x32x16_bf16 v[16:31], a[76:79], v[60:63], v[16:31]
  ds_read_b128 v[60:63], v115 offset:20480
  s_waitcnt lgkmcnt(3)
  v_mfma_f32_32x32x16_bf16 v[16:31], a[80:83], v[48:51], v[16:31]
  ds_read_b128 v[48:51], v112 offset:24576
  s_waitcnt lgkmcnt(3)
  v_mfma_f32_32x32x16_bf16 v[16:31], a[84:87], v[52:55], v[16:31]
  ds_read_b128 v[52:55], v113 offset:24576
  s_waitcnt lgkmcnt(3)
  v_mfma_f32_32x32x16_bf16 v[16:31], a[88:91], v[56:59], v[16:31]
  ds_read_b128 v[56:59], v114 offset:24576
  s_waitcnt lgkmcnt(3)
  v_mfma_f32_32x32x16_bf16 v[16:31], a[92:95], v[60:63], v[16:31]
  ds_read_b128 v[60:63], v115 offset:24576
  s_waitcnt lgkmcnt(3)
  v_mfma_f32_32x32x16_bf16 v[16:31], a[96:99], v[48:51], v[16:31]
  ds_read_b128 v[48:51], v112 offset:28672
  s_waitcnt lgkmcnt(3)
  v_mfma_f32_32x32x16_bf16 v[16:31], a[100:103], v[52:55], v[16:31]
  ds_read_b128 v[52:55], v113 offset:28672
  s_waitcnt lgkmcnt(3)
  v_mfma_f32_32x32x16_bf16 v[16:31], a[104:107], v[56:59], v[16:31]
  ds_read_b128 v[56:59], v114 offset:28672
  s_waitcnt lgkmcnt(3)
  v_mfma_f32_32x32x16_bf16 v[16:31], a[108:111], v[60:63], v[16:31]
  ds_read_b128 v[60:63], v115 offset:28672
  s_waitcnt lgkmcnt(3)
  v_mfma_f32_32x32x16_bf16 v[16:31], a[112:115], v[48:51], v[16:31]
  ds_read_b128 v[48:51], v112 offset:32768
  s_waitcnt lgkmcnt(3)
  v_mfma_f32_32x32x16_bf16 v[16:31], a[116:119], v[52:55], v[16:31]
  ds_read_b128 v[52:55], v113 offset:32768
  s_waitcnt lgkmcnt(3)
  v_mfma_f32_32x32x16_bf16 v[16:31], a[120:123], v[56:59], v[16:31]
  ds_read_b128 v[56:59], v114 offset:32768
  s_waitcnt lgkmcnt(3)
  v_mfma_f32_32x32x16_bf16 v[16:31], a[124:127], v[60:63], v[16:31]
  ds_read_b128 v[60:63], v115 offset:32768
  s_waitcnt lgkmcnt(3)
  v_mfma_f32_32x32x16_bf16 v[16:31], a[128:131], v[48:51], v[16:31]
  s_waitcnt lgkmcnt(2)
  v_mfma_f32_32x32x16_bf16 v[16:31], a[132:135], v[52:55], v[16:31]
  s_waitcnt lgkmcnt(1)
  v_mfma_f32_32x32x16_bf16 v[16:31], a[136:139], v[56:59], v[16:31]
  s_waitcnt lgkmcnt(0)
  v_mfma_f32_32x32x16_bf16 v[16:31], a[140:143], v[60:63], v[16:31]
  s_lshl_b32 s32, s37, 18
  s_lshl_b32 s33, s36, 13
  s_add_u32 s32, s32, s33
  s_lshl_b32 s33, s94, 11
  s_add_u32 s32, s32, s33
  s_mov_b32 s33, 0x3e0293ee
  s_nop 5
  v_mul_f32 v16, s33, v16
  v_mul_f32 v17, s33, v17
  v_mul_f32 v18, s33, v18
  v_mul_f32 v19, s33, v19
  v_mul_f32 v20, s33, v20
  v_mul_f32 v21, s33, v21
  v_mul_f32 v22, s33, v22
  v_mul_f32 v23, s33, v23
  v_mul_f32 v24, s33, v24
  v_mul_f32 v25, s33, v25
  v_mul_f32 v26, s33, v26
  v_mul_f32 v27, s33, v27
  v_mul_f32 v28, s33, v28
  v_mul_f32 v29, s33, v29
  v_mul_f32 v30, s33, v30
  v_mul_f32 v31, s33, v31
  v_cvt_pk_bf16_f32 v96, v16, v17
  v_cvt_pk_bf16_f32 v97, v18, v19
  v_cvt_pk_bf16_f32 v98, v24, v25
  v_cvt_pk_bf16_f32 v99, v26, v27
  v_cvt_pk_bf16_f32 v100, v20, v21
  v_cvt_pk_bf16_f32 v101, v22, v23
  v_cvt_pk_bf16_f32 v102, v28, v29
  v_cvt_pk_bf16_f32 v103, v30, v31
  buffer_store_dwordx4 v[96:99], v10, s[16:19], s32 offen sc1
  buffer_store_dwordx4 v[100:103], v10, s[16:19], s32 offen offset:512 sc1
  s_mov_b32 s41, s40
  s_mov_b32 s40, s37
  s_mov_b32 s37, s39
  s_cmp_lt_u32 s37, 64
  s_cbranch_scc0 G1Q_4_end
  s_branch G1Q_4
G1Q_4_end:
  s_waitcnt vmcnt(0)
  s_barrier
  s_cmp_lt_u32 s95, 216
  s_cbranch_scc0 G4_DONE
  s_add_u32 s8, s92, 0x400000
  s_addc_u32 s9, s93, 0
  s_mov_b32 s10, 0x240000
  s_mov_b32 s11, 0x00020000
  s_mov_b32 s12, s80
  s_mov_b32 s13, s81
  s_mov_b32 s14, 0x1200000
  s_mov_b32 s15, 0x00020000
  s_add_u32 s16, s92, 0x4800000
  s_addc_u32 s17, s93, 0
  s_mov_b32 s18, 0x510000
  s_mov_b32 s19, 0x00020000
  s_mov_b32 s20, s82
  s_mov_b32 s21, s83
  s_mov_b32 s22, 0x2400
  s_mov_b32 s23, 0x00020000
  s_mul_hi_u32 s37, s95, 715827883
  s_mul_i32 s32, s37, 6
  s_sub_u32 s36, s95, s32
  s_mov_b32 s38, 0
  s_mul_i32 s36, s36, 96
  s_lshl_b32 s37, s37, 7
  v_add_u32 v10, 0, v0
  v_mul_u32_u24 v11, 43691, v10
  v_lshrrev_b32 v11, 19, v11
  v_mul_u32_u24 v12, 12, v11
  v_sub_u32 v12, v10, v12
  v_mul_u32_u24 v11, 1152, v11
  v_lshl_add_u32 v1, v12, 4, v11
  v_add_u32 v10, 64, v0
  v_mul_u32_u24 v11, 43691, v10
  v_lshrrev_b32 v11, 19, v11
  v_mul_u32_u24 v12, 12, v11
  v_sub_u32 v12, v10, v12
  v_mul_u32_u24 v11, 1152, v11
  v_lshl_add_u32 v2, v12, 4, v11
  v_add_u32 v10, 128, v0
  v_mul_u32_u24 v11, 43691, v10
  v_lshrrev_b32 v11, 19, v11
  v_mul_u32_u24 v12, 12, v11
  v_sub_u32 v12, v10, v12
  v_mul_u32_u24 v11, 1152, v11
  v_lshl_add_u32 v3, v12, 4, v11
  v_lshrrev_b32 v10, 4, v0
  v_and_b32 v11, 15, v0
  v_lshlrev_b32 v12, 2, v10
  v_xor_b32 v12, v12, v11
  v_mul_u32_u24 v13, 9216, v10
  v_lshl_add_u32 v4, v12, 4, v13
  v_lshrrev_b32 v12, 2, v11
  v_lshrrev_b32 v13, 1, v10
  v_lshl_or_b32 v13, v13, 3, v12
  v_and_b32 v14, 1, v10
  v_and_b32 v15, 3, v0
  v_mul_u32_u24 v16, 192, v13
  v_lshl_add_u32 v16, v14, 5, v16
  v_lshl_add_u32 v5, v15, 3, v16
  s_lshl_b32 s32, s94, 2
  v_lshlrev_b32 v16, 1, v14
  v_or_b32 v16, s32, v16
  v_lshrrev_b32 v17, 1, v15
  v_or_b32 v16, v16, v17
  v_lshlrev_b32 v17, 2, v12
  v_xor_b32 v16, v16, v17
  v_lshlrev_b32 v16, 4, v16
  v_lshl_add_u32 v16, v13, 8, v16
  v_and_b32 v17, 1, v15
  v_lshl_add_u32 v16, v17, 3, v16
  v_add_u32 v6, 12288, v16
  s_lshl_b32 s32, s94, 4
  s_add_u32 s32, s32, s38
  s_mul_i32 s39, s32, 1152
  s_lshl_b32 s33, s36, 1
  s_add_u32 s39, s39, s33
  s_mul_i32 s40, s32, 9216
  s_lshl_b32 s33, s37, 1
  s_add_u32 s40, s40, s33
  s_mul_i32 s43, s94, 3072
  s_lshl_b32 s44, s94, 12
  s_add_u32 s44, s44, 12288
  v_and_b32 v10, 15, v0
  v_lshlrev_b32 v10, 2, v10
  v_add_u32 v10, 32, v10
  s_mov_b32 s96, 0
G4W_5:
  buffer_load_dword v11, v10, s[28:31], 0 offen sc1
  s_waitcnt vmcnt(0)
  v_cmp_ne_u32 vcc, 0x01010101, v11
  s_nop 0
  s_cbranch_vccz G4W_5_ok
  s_sleep 4
  s_add_u32 s96, s96, 1
  s_cmp_lt_u32 s96, 60000
  s_cbranch_scc1 G4W_5
  s_branch W_FAIL
G4W_5_ok:
  s_barrier
  s_add_u32 m0, s43, 0
  s_nop 0
  buffer_load_dwordx4 v1, s[8:11], s39 offen sc1 lds
  s_add_u32 m0, s43, 1024
  s_nop 0
  buffer_load_dwordx4 v2, s[8:11], s39 offen sc1 lds
  s_add_u32 m0, s43, 2048
  s_nop 0
  buffer_load_dwordx4 v3, s[8:11], s39 offen sc1 lds
  s_add_u32 m0, s44, 0
  s_nop 0
  buffer_load_dwordx4 v4, s[12:15], s40 offen lds
  s_add_u32 m0, s44, 1024
  s_add_u32 s32, s40, 36864
  buffer_load_dwordx4 v4, s[12:15], s32 offen lds
  s_add_u32 m0, s44, 2048
  s_add_u32 s32, s40, 73728
  buffer_load_dwordx4 v4, s[12:15], s32 offen lds
  s_add_u32 m0, s44, 3072
  s_add_u32 s32, s40, 110592
  buffer_load_dwordx4 v4, s[12:15], s32 offen lds
  s_add_u32 s39, s39, 73728
  s_add_u32 s40, s40, 589824
  s_add_u32 m0, s43, 28672
  s_nop 0
  buffer_load_dwordx4 v1, s[8:11], s39 offen sc1 lds
  s_add_u32 m0, s43, 29696
  s_nop 0
  buffer_load_dwordx4 v2, s[8:11], s39 offen sc1 lds
  s_add_u32 m0, s43, 30720
  s_nop 0
  buffer_load_dwordx4 v3, s[8:11], s39 offen sc1 lds
  s_add_u32 m0, s44, 28672
  s_nop 0
  buffer_load_dwordx4 v4, s[12:15], s40 offen lds
  s_add_u32 m0, s44, 29696
  s_add_u32 s32, s40, 36864
  buffer_load_dwordx4 v4, s[12:15], s32 offen lds
  s_add_u32 m0, s44, 30720
  s_add_u32 s32, s40, 73728
  buffer_load_dwordx4 v4, s[12:15], s32 offen lds
  s_add_u32 m0, s44, 31744
  s_add_u32 s32, s40, 110592
  buffer_load_dwordx4 v4, s[12:15], s32 offen lds
  s_add_u32 s39, s39, 73728
  s_add_u32 s40, s40, 589824
  s_add_u32 m0, s43, 57344
  s_nop 0
  buffer_load_dwordx4 v1, s[8:11], s39 offen sc1 lds
  s_add_u32 m0, s43, 58368
  s_nop 0
  buffer_load_dwordx4 v2, s[8:11], s39 offen sc1 lds
  s_add_u32 m0, s43, 59392
  s_nop 0
  buffer_load_dwordx4 v3, s[8:11], s39 offen sc1 lds
  s_add_u32 m0, s44, 57344
  s_nop 0
  buffer_load_dwordx4 v4, s[12:15], s40 offen lds
  s_add_u32 m0, s44, 58368
  s_add_u32 s32, s40, 36864
  buffer_load_dwordx4 v4, s[12:15], s32 offen lds
  s_add_u32 m0, s44, 59392
  s_add_u32 s32, s40, 73728
  buffer_load_dwordx4 v4, s[12:15], s32 offen lds
  s_add_u32 m0, s44, 60416
  s_add_u32 s32, s40, 110592
  buffer_load_dwordx4 v4, s[12:15], s32 offen lds
  s_add_u32 s39, s39, 73728
  s_add_u32 s40, s40, 589824
  v_mov_b64 v[16:17], 0
  v_mov_b64 v[18:19], 0
  v_mov_b64 v[20:21], 0
  v_mov_b64 v[22:23], 0
  v_mov_b64 v[24:25], 0
  v_mov_b64 v[26:27], 0
  v_mov_b64 v[28:29], 0
  v_mov_b64 v[30:31], 0
  v_mov_b64 v[32:33], 0
  v_mov_b64 v[34:35], 0
  v_mov_b64 v[36:37], 0
  v_mov_b64 v[38:39], 0
  v_mov_b64 v[40:41], 0
  v_mov_b64 v[42:43], 0
  v_mov_b64 v[44:45], 0
  v_mov_b64 v[46:47], 0
  v_mov_b64 v[48:49], 0
  v_mov_b64 v[50:51], 0
  v_mov_b64 v[52:53], 0
  v_mov_b64 v[54:55], 0
  v_mov_b64 v[56:57], 0
  v_mov_b64 v[58:59], 0
  v_mov_b64 v[60:61], 0
  v_mov_b64 v[62:63], 0
  s_mov_b32 s41, 0
G4L_6:
  s_add_u32 s33, s41, 3
  s_cmp_lt_u32 s33, 32
  s_cbranch_scc0 G4L_6_t0
  s_waitcnt vmcnt(14)
  s_barrier
  s_add_u32 m0, s43, 86016
  s_nop 0
  buffer_load_dwordx4 v1, s[8:11], s39 offen sc1 lds
  s_add_u32 m0, s43, 87040
  s_nop 0
  buffer_load_dwordx4 v2, s[8:11], s39 offen sc1 lds
  s_add_u32 m0, s43, 88064
  s_nop 0
  buffer_load_dwordx4 v3, s[8:11], s39 offen sc1 lds
  s_add_u32 m0, s44, 86016
  s_nop 0
  buffer_load_dwordx4 v4, s[12:15], s40 offen lds
  s_add_u32 m0, s44, 87040
  s_add_u32 s32, s40, 36864
  buffer_load_dwordx4 v4, s[12:15], s32 offen lds
  s_add_u32 m0, s44, 88064
  s_add_u32 s32, s40, 73728
  buffer_load_dwordx4 v4, s[12:15], s32 offen lds
  s_add_u32 m0, s44, 89088
  s_add_u32 s32, s40, 110592
  buffer_load_dwordx4 v4, s[12:15], s32 offen lds
  s_add_u32 s39, s39, 73728
  s_add_u32 s40, s40, 589824
  s_branch G4L_6_c0
G4L_6_t0:
  s_waitcnt vmcnt(0)
  s_barrier
G4L_6_c0:
  v_add_u32 v7, 0, v5
  v_add_u32 v8, 0, v6
  ds_read_b64_tr_b16 v[76:77], v8 offset:0
  ds_read_b64_tr_b16 v[78:79], v8 offset:1024
  ds_read_b64_tr_b16 v[64:65], v7 offset:0
  ds_read_b64_tr_b16 v[66:67], v7 offset:768
  ds_read_b64_tr_b16 v[68:69], v7 offset:64
  ds_read_b64_tr_b16 v[70:71], v7 offset:832
  ds_read_b64_tr_b16 v[72:73], v7 offset:128
  ds_read_b64_tr_b16 v[74:75], v7 offset:896
  s_waitcnt lgkmcnt(4)
  ds_read_b64_tr_b16 v[92:93], v8 offset:4096
  ds_read_b64_tr_b16 v[94:95], v8 offset:5120
  ds_read_b64_tr_b16 v[80:81], v7 offset:3072
  ds_read_b64_tr_b16 v[82:83], v7 offset:3840
  ds_read_b64_tr_b16 v[84:85], v7 offset:3136
  ds_read_b64_tr_b16 v[86:87], v7 offset:3904
  ds_read_b64_tr_b16 v[88:89], v7 offset:3200
  ds_read_b64_tr_b16 v[90:91], v7 offset:3968
  v_mfma_f32_32x32x16_bf16 v[16:31], v[64:67], v[76:79], v[16:31]
  s_waitcnt lgkmcnt(10)
  v_mfma_f32_32x32x16_bf16 v[32:47], v[68:71], v[76:79], v[32:47]
  s_waitcnt lgkmcnt(8)
  v_mfma_f32_32x32x16_bf16 v[48:63], v[72:75], v[76:79], v[48:63]
  s_waitcnt lgkmcnt(4)
  ds_read_b64_tr_b16 v[76:77], v8 offset:8192
  ds_read_b64_tr_b16 v[78:79], v8 offset:9216
  ds_read_b64_tr_b16 v[64:65], v7 offset:6144
  ds_read_b64_tr_b16 v[66:67], v7 offset:6912
  ds_read_b64_tr_b16 v[68:69], v7 offset:6208
  ds_read_b64_tr_b16 v[70:71], v7 offset:6976
  ds_read_b64_tr_b16 v[72:73], v7 offset:6272
  ds_read_b64_tr_b16 v[74:75], v7 offset:7040
  v_mfma_f32_32x32x16_bf16 v[16:31], v[80:83], v[92:95], v[16:31]
  s_waitcnt lgkmcnt(10)
  v_mfma_f32_32x32x16_bf16 v[32:47], v[84:87], v[92:95], v[32:47]
  s_waitcnt lgkmcnt(8)
  v_mfma_f32_32x32x16_bf16 v[48:63], v[88:91], v[92:95], v[48:63]
  s_waitcnt lgkmcnt(4)
  ds_read_b64_tr_b16 v[92:93], v8 offset:12288
  ds_read_b64_tr_b16 v[94:95], v8 offset:13312
  ds_read_b64_tr_b16 v[80:81], v7 offset:9216
  ds_read_b64_tr_b16 v[82:83], v7 offset:9984
  ds_read_b64_tr_b16 v[84:85], v7 offset:9280
  ds_read_b64_tr_b16 v[86:87], v7 offset:10048
  ds_read_b64_tr_b16 v[88:89], v7 offset:9344
  ds_read_b64_tr_b16 v[90:91], v7 offset:10112
  v_mfma_f32_32x32x16_bf16 v[16:31], v[64:67], v[76:79], v[16:31]
  s_waitcnt lgkmcnt(10)
  v_mfma_f32_32x32x16_bf16 v[32:47], v[68:71], v[76:79], v[32:47]
  s_waitcnt lgkmcnt(8)
  v_mfma_f32_32x32x16_bf16 v[48:63], v[72:75], v[76:79], v[48:63]
  s_waitcnt lgkmcnt(4)
  v_mfma_f32_32x32x16_bf16 v[16:31], v[80:83], v[92:95], v[16:31]
  s_waitcnt lgkmcnt(2)
  v_mfma_f32_32x32x16_bf16 v[32:47], v[84:87], v[92:95], v[32:47]
  s_waitcnt lgkmcnt(0)
  v_mfma_f32_32x32x16_bf16 v[48:63], v[88:91], v[92:95], v[48:63]
  s_add_u32 s33, s41, 4
  s_cmp_lt_u32 s33, 32
  s_cbranch_scc0 G4L_6_t1
  s_waitcnt vmcnt(14)
  s_barrier
  s_add_u32 m0, s43, 0
  s_nop 0
  buffer_load_dwordx4 v1, s[8:11], s39 offen sc1 lds
  s_add_u32 m0, s43, 1024
  s_nop 0
  buffer_load_dwordx4 v2, s[8:11], s39 offen sc1 lds
  s_add_u32 m0, s43, 2048
  s_nop 0
  buffer_load_dwordx4 v3, s[8:11], s39 offen sc1 lds
  s_add_u32 m0, s44, 0
  s_nop 0
  buffer_load_dwordx4 v4, s[12:15], s40 offen lds
  s_add_u32 m0, s44, 1024
  s_add_u32 s32, s40, 36864
  buffer_load_dwordx4 v4, s[12:15], s32 offen lds
  s_add_u32 m0, s44, 2048
  s_add_u32 s32, s40, 73728
  buffer_load_dwordx4 v4, s[12:15], s32 offen lds
  s_add_u32 m0, s44, 3072
  s_add_u32 s32, s40, 110592
  buffer_load_dwordx4 v4, s[12:15], s32 offen lds
  s_add_u32 s39, s39, 73728
  s_add_u32 s40, s40, 589824
  s_branch G4L_6_c1
G4L_6_t1:
  s_waitcnt vmcnt(0)
  s_barrier
G4L_6_c1:
  v_add_u32 v7, 28672, v5
  v_add_u32 v8, 28672, v6
  ds_read_b64_tr_b16 v[76:77], v8 offset:0
  ds_read_b64_tr_b16 v[78:79], v8 offset:1024
  ds_read_b64_tr_b16 v[64:65], v7 offset:0
  ds_read_b64_tr_b16 v[66:67], v7 offset:768
  ds_read_b64_tr_b16 v[68:69], v7 offset:64
  ds_read_b64_tr_b16 v[70:71], v7 offset:832
  ds_read_b64_tr_b16 v[72:73], v7 offset:128
  ds_read_b64_tr_b16 v[74:75], v7 offset:896
  s_waitcnt lgkmcnt(4)
  ds_read_b64_tr_b16 v[92:93], v8 offset:4096
  ds_read_b64_tr_b16 v[94:95], v8 offset:5120
  ds_read_b64_tr_b16 v[80:81], v7 offset:3072
  ds_read_b64_tr_b16 v[82:83], v7 offset:3840
  ds_read_b64_tr_b16 v[84:85], v7 offset:3136
  ds_read_b64_tr_b16 v[86:87], v7 offset:3904
  ds_read_b64_tr_b16 v[88:89], v7 offset:3200
  ds_read_b64_tr_b16 v[90:91], v7 offset:3968
  v_mfma_f32_32x32x16_bf16 v[16:31], v[64:67], v[76:79], v[16:31]
  s_waitcnt lgkmcnt(10)
  v_mfma_f32_32x32x16_bf16 v[32:47], v[68:71], v[76:79], v[32:47]
  s_waitcnt lgkmcnt(8)
  v_mfma_f32_32x32x16_bf16 v[48:63], v[72:75], v[76:79], v[48:63]
  s_waitcnt lgkmcnt(4)
  ds_read_b64_tr_b16 v[76:77], v8 offset:8192
  ds_read_b64_tr_b16 v[78:79], v8 offset:9216
  ds_read_b64_tr_b16 v[64:65], v7 offset:6144
  ds_read_b64_tr_b16 v[66:67], v7 offset:6912
  ds_read_b64_tr_b16 v[68:69], v7 offset:6208
  ds_read_b64_tr_b16 v[70:71], v7 offset:6976
  ds_read_b64_tr_b16 v[72:73], v7 offset:6272
  ds_read_b64_tr_b16 v[74:75], v7 offset:7040
  v_mfma_f32_32x32x16_bf16 v[16:31], v[80:83], v[92:95], v[16:31]
  s_waitcnt lgkmcnt(10)
  v_mfma_f32_32x32x16_bf16 v[32:47], v[84:87], v[92:95], v[32:47]
  s_waitcnt lgkmcnt(8)
  v_mfma_f32_32x32x16_bf16 v[48:63], v[88:91], v[92:95], v[48:63]
  s_waitcnt lgkmcnt(4)
  ds_read_b64_tr_b16 v[92:93], v8 offset:12288
  ds_read_b64_tr_b16 v[94:95], v8 offset:13312
  ds_read_b64_tr_b16 v[80:81], v7 offset:9216
  ds_read_b64_tr_b16 v[82:83], v7 offset:9984
  ds_read_b64_tr_b16 v[84:85], v7 offset:9280
  ds_read_b64_tr_b16 v[86:87], v7 offset:10048
  ds_read_b64_tr_b16 v[88:89], v7 offset:9344
  ds_read_b64_tr_b16 v[90:91], v7 offset:10112
  v_mfma_f32_32x32x16_bf16 v[16:31], v[64:67], v[76:79], v[16:31]
  s_waitcnt lgkmcnt(10)
  v_mfma_f32_32x32x16_bf16 v[32:47], v[68:71], v[76:79], v[32:47]
  s_waitcnt lgkmcnt(8)
  v_mfma_f32_32x32x16_bf16 v[48:63], v[72:75], v[76:79], v[48:63]
  s_waitcnt lgkmcnt(4)
  v_mfma_f32_32x32x16_bf16 v[16:31], v[80:83], v[92:95], v[16:31]
  s_waitcnt lgkmcnt(2)
  v_mfma_f32_32x32x16_bf16 v[32:47], v[84:87], v[92:95], v[32:47]
  s_waitcnt lgkmcnt(0)
  v_mfma_f32_32x32x16_bf16 v[48:63], v[88:91], v[92:95], v[48:63]
  s_add_u32 s33, s41, 5
  s_cmp_lt_u32 s33, 32
  s_cbranch_scc0 G4L_6_t2
  s_waitcnt vmcnt(14)
  s_barrier
  s_add_u32 m0, s43, 28672
  s_nop 0
  buffer_load_dwordx4 v1, s[8:11], s39 offen sc1 lds
  s_add_u32 m0, s43, 29696
  s_nop 0
  buffer_load_dwordx4 v2, s[8:11], s39 offen sc1 lds
  s_add_u32 m0, s43, 30720
  s_nop 0
  buffer_load_dwordx4 v3, s[8:11], s39 offen sc1 lds
  s_add_u32 m0, s44, 28672
  s_nop 0
  buffer_load_dwordx4 v4, s[12:15], s40 offen lds
  s_add_u32 m0, s44, 29696
  s_add_u32 s32, s40, 36864
  buffer_load_dwordx4 v4, s[12:15], s32 offen lds
  s_add_u32 m0, s44, 30720
  s_add_u32 s32, s40, 73728
  buffer_load_dwordx4 v4, s[12:15], s32 offen lds
  s_add_u32 m0, s44, 31744
  s_add_u32 s32, s40, 110592
  buffer_load_dwordx4 v4, s[12:15], s32 offen lds
  s_add_u32 s39, s39, 73728
  s_add_u32 s40, s40, 589824
  s_branch G4L_6_c2
G4L_6_t2:
  s_waitcnt vmcnt(0)
  s_barrier
G4L_6_c2:
  v_add_u32 v7, 57344, v5
  v_add_u32 v8, 57344, v6
  ds_read_b64_tr_b16 v[76:77], v8 offset:0
  ds_read_b64_tr_b16 v[78:79], v8 offset:1024
  ds_read_b64_tr_b16 v[64:65], v7 offset:0
  ds_read_b64_tr_b16 v[66:67], v7 offset:768
  ds_read_b64_tr_b16 v[68:69], v7 offset:64
  ds_read_b64_tr_b16 v[70:71], v7 offset:832
  ds_read_b64_tr_b16 v[72:73], v7 offset:128
  ds_read_b64_tr_b16 v[74:75], v7 offset:896
  s_waitcnt lgkmcnt(4)
  ds_read_b64_tr_b16 v[92:93], v8 offset:4096
  ds_read_b64_tr_b16 v[94:95], v8 offset:5120
  ds_read_b64_tr_b16 v[80:81], v7 offset:3072
  ds_read_b64_tr_b16 v[82:83], v7 offset:3840
  ds_read_b64_tr_b16 v[84:85], v7 offset:3136
  ds_read_b64_tr_b16 v[86:87], v7 offset:3904
  ds_read_b64_tr_b16 v[88:89], v7 offset:3200
  ds_read_b64_tr_b16 v[90:91], v7 offset:3968
  v_mfma_f32_32x32x16_bf16 v[16:31], v[64:67], v[76:79], v[16:31]
  s_waitcnt lgkmcnt(10)
  v_mfma_f32_32x32x16_bf16 v[32:47], v[68:71], v[76:79], v[32:47]
  s_waitcnt lgkmcnt(8)
  v_mfma_f32_32x32x16_bf16 v[48:63], v[72:75], v[76:79], v[48:63]
  s_waitcnt lgkmcnt(4)
  ds_read_b64_tr_b16 v[76:77], v8 offset:8192
  ds_read_b64_tr_b16 v[78:79], v8 offset:9216
  ds_read_b64_tr_b16 v[64:65], v7 offset:6144
  ds_read_b64_tr_b16 v[66:67], v7 offset:6912
  ds_read_b64_tr_b16 v[68:69], v7 offset:6208
  ds_read_b64_tr_b16 v[70:71], v7 offset:6976
  ds_read_b64_tr_b16 v[72:73], v7 offset:6272
  ds_read_b64_tr_b16 v[74:75], v7 offset:7040
  v_mfma_f32_32x32x16_bf16 v[16:31], v[80:83], v[92:95], v[16:31]
  s_waitcnt lgkmcnt(10)
  v_mfma_f32_32x32x16_bf16 v[32:47], v[84:87], v[92:95], v[32:47]
  s_waitcnt lgkmcnt(8)
  v_mfma_f32_32x32x16_bf16 v[48:63], v[88:91], v[92:95], v[48:63]
  s_waitcnt lgkmcnt(4)
  ds_read_b64_tr_b16 v[92:93], v8 offset:12288
  ds_read_b64_tr_b16 v[94:95], v8 offset:13312
  ds_read_b64_tr_b16 v[80:81], v7 offset:9216
  ds_read_b64_tr_b16 v[82:83], v7 offset:9984
  ds_read_b64_tr_b16 v[84:85], v7 offset:9280
  ds_read_b64_tr_b16 v[86:87], v7 offset:10048
  ds_read_b64_tr_b16 v[88:89], v7 offset:9344
  ds_read_b64_tr_b16 v[90:91], v7 offset:10112
  v_mfma_f32_32x32x16_bf16 v[16:31], v[64:67], v[76:79], v[16:31]
  s_waitcnt lgkmcnt(10)
  v_mfma_f32_32x32x16_bf16 v[32:47], v[68:71], v[76:79], v[32:47]
  s_waitcnt lgkmcnt(8)
  v_mfma_f32_32x32x16_bf16 v[48:63], v[72:75], v[76:79], v[48:63]
  s_waitcnt lgkmcnt(4)
  v_mfma_f32_32x32x16_bf16 v[16:31], v[80:83], v[92:95], v[16:31]
  s_waitcnt lgkmcnt(2)
  v_mfma_f32_32x32x16_bf16 v[32:47], v[84:87], v[92:95], v[32:47]
  s_waitcnt lgkmcnt(0)
  v_mfma_f32_32x32x16_bf16 v[48:63], v[88:91], v[92:95], v[48:63]
  s_add_u32 s33, s41, 6
  s_cmp_lt_u32 s33, 32
  s_cbranch_scc0 G4L_6_t3
  s_waitcnt vmcnt(14)
  s_barrier
  s_add_u32 m0, s43, 57344
  s_nop 0
  buffer_load_dwordx4 v1, s[8:11], s39 offen sc1 lds
  s_add_u32 m0, s43, 58368
  s_nop 0
  buffer_load_dwordx4 v2, s[8:11], s39 offen sc1 lds
  s_add_u32 m0, s43, 59392
  s_nop 0
  buffer_load_dwordx4 v3, s[8:11], s39 offen sc1 lds
  s_add_u32 m0, s44, 57344
  s_nop 0
  buffer_load_dwordx4 v4, s[12:15], s40 offen lds
  s_add_u32 m0, s44, 58368
  s_add_u32 s32, s40, 36864
  buffer_load_dwordx4 v4, s[12:15], s32 offen lds
  s_add_u32 m0, s44, 59392
  s_add_u32 s32, s40, 73728
  buffer_load_dwordx4 v4, s[12:15], s32 offen lds
  s_add_u32 m0, s44, 60416
  s_add_u32 s32, s40, 110592
  buffer_load_dwordx4 v4, s[12:15], s32 offen lds
  s_add_u32 s39, s39, 73728
  s_add_u32 s40, s40, 589824
  s_branch G4L_6_c3
G4L_6_t3:
  s_waitcnt vmcnt(0)
  s_barrier
G4L_6_c3:
  v_add_u32 v7, 86016, v5
  v_add_u32 v8, 86016, v6
  ds_read_b64_tr_b16 v[76:77], v8 offset:0
  ds_read_b64_tr_b16 v[78:79], v8 offset:1024
  ds_read_b64_tr_b16 v[64:65], v7 offset:0
  ds_read_b64_tr_b16 v[66:67], v7 offset:768
  ds_read_b64_tr_b16 v[68:69], v7 offset:64
  ds_read_b64_tr_b16 v[70:71], v7 offset:832
  ds_read_b64_tr_b16 v[72:73], v7 offset:128
  ds_read_b64_tr_b16 v[74:75], v7 offset:896
  s_waitcnt lgkmcnt(4)
  ds_read_b64_tr_b16 v[92:93], v8 offset:4096
  ds_read_b64_tr_b16 v[94:95], v8 offset:5120
  ds_read_b64_tr_b16 v[80:81], v7 offset:3072
  ds_read_b64_tr_b16 v[82:83], v7 offset:3840
  ds_read_b64_tr_b16 v[84:85], v7 offset:3136
  ds_read_b64_tr_b16 v[86:87], v7 offset:3904
  ds_read_b64_tr_b16 v[88:89], v7 offset:3200
  ds_read_b64_tr_b16 v[90:91], v7 offset:3968
  v_mfma_f32_32x32x16_bf16 v[16:31], v[64:67], v[76:79], v[16:31]
  s_waitcnt lgkmcnt(10)
  v_mfma_f32_32x32x16_bf16 v[32:47], v[68:71], v[76:79], v[32:47]
  s_waitcnt lgkmcnt(8)
  v_mfma_f32_32x32x16_bf16 v[48:63], v[72:75], v[76:79], v[48:63]
  s_waitcnt lgkmcnt(4)
  ds_read_b64_tr_b16 v[76:77], v8 offset:8192
  ds_read_b64_tr_b16 v[78:79], v8 offset:9216
  ds_read_b64_tr_b16 v[64:65], v7 offset:6144
  ds_read_b64_tr_b16 v[66:67], v7 offset:6912
  ds_read_b64_tr_b16 v[68:69], v7 offset:6208
  ds_read_b64_tr_b16 v[70:71], v7 offset:6976
  ds_read_b64_tr_b16 v[72:73], v7 offset:6272
  ds_read_b64_tr_b16 v[74:75], v7 offset:7040
  v_mfma_f32_32x32x16_bf16 v[16:31], v[80:83], v[92:95], v[16:31]
  s_waitcnt lgkmcnt(10)
  v_mfma_f32_32x32x16_bf16 v[32:47], v[84:87], v[92:95], v[32:47]
  s_waitcnt lgkmcnt(8)
  v_mfma_f32_32x32x16_bf16 v[48:63], v[88:91], v[92:95], v[48:63]
  s_waitcnt lgkmcnt(4)
  ds_read_b64_tr_b16 v[92:93], v8 offset:12288
  ds_read_b64_tr_b16 v[94:95], v8 offset:13312
  ds_read_b64_tr_b16 v[80:81], v7 offset:9216
  ds_read_b64_tr_b16 v[82:83], v7 offset:9984
  ds_read_b64_tr_b16 v[84:85], v7 offset:9280
  ds_read_b64_tr_b16 v[86:87], v7 offset:10048
  ds_read_b64_tr_b16 v[88:89], v7 offset:9344
  ds_read_b64_tr_b16 v[90:91], v7 offset:10112
  v_mfma_f32_32x32x16_bf16 v[16:31], v[64:67], v[76:79], v[16:31]
  s_waitcnt lgkmcnt(10)
  v_mfma_f32_32x32x16_bf16 v[32:47], v[68:71], v[76:79], v[32:47]
  s_waitcnt lgkmcnt(8)
  v_mfma_f32_32x32x16_bf16 v[48:63], v[72:75], v[76:79], v[48:63]
  s_waitcnt lgkmcnt(4)
  v_mfma_f32_32x32x16_bf16 v[16:31], v[80:83], v[92:95], v[16:31]
  s_waitcnt lgkmcnt(2)
  v_mfma_f32_32x32x16_bf16 v[32:47], v[84:87], v[92:95], v[32:47]
  s_waitcnt lgkmcnt(0)
  v_mfma_f32_32x32x16_bf16 v[48:63], v[88:91], v[92:95], v[48:63]
  s_add_u32 s41, s41, 4
  s_cmp_lt_u32 s41, 32
  s_cbranch_scc1 G4L_6
  v_and_b32 v10, 31, v0
  s_lshl_b32 s32, s94, 5
  s_add_u32 s32, s32, s37
  v_add_u32 v10, s32, v10
  v_lshlrev_b32 v11, 1, v10
  buffer_load_ushort v12, v11, s[20:23], 0 offen
  v_mul_u32_u24 v13, 1152, v10
  v_lshrrev_b32 v14, 5, v0
  v_lshl_add_u32 v13, v14, 4, v13
  s_lshl_b32 s32, s36, 1
  s_mov_b32 s33, 0x3d372713
  s_mov_b32 s34, 0xc0135761
  s_waitcnt vmcnt(0)
  v_lshlrev_b32 v12, 16, v12
  v_add_f32 v16, v16, v12
  v_mul_f32 v64, v16, v16
  v_fma_f32 v64, v64, s33, 1.0
  v_mul_f32 v64, v64, v16
  v_mul_f32 v64, s34, v64
  v_exp_f32 v64, v64
  s_nop 0
  v_add_f32 v64, 1.0, v64
  v_rcp_f32 v64, v64
  s_nop 0
  v_mul_f32 v16, v16, v64
  v_add_f32 v17, v17, v12
  v_mul_f32 v64, v17, v17
  v_fma_f32 v64, v64, s33, 1.0
  v_mul_f32 v64, v64, v17
  v_mul_f32 v64, s34, v64
  v_exp_f32 v64, v64
  s_nop 0
  v_add_f32 v64, 1.0, v64
  v_rcp_f32 v64, v64
  s_nop 0
  v_mul_f32 v17, v17, v64
  v_add_f32 v18, v18, v12
  v_mul_f32 v64, v18, v18
  v_fma_f32 v64, v64, s33, 1.0
  v_mul_f32 v64, v64, v18
  v_mul_f32 v64, s34, v64
  v_exp_f32 v64, v64
  s_nop 0
  v_add_f32 v64, 1.0, v64
  v_rcp_f32 v64, v64
  s_nop 0
  v_mul_f32 v18, v18, v64
  v_add_f32 v19, v19, v12
  v_mul_f32 v64, v19, v19
  v_fma_f32 v64, v64, s33, 1.0
  v_mul_f32 v64, v64, v19
  v_mul_f32 v64, s34, v64
  v_exp_f32 v64, v64
  s_nop 0
  v_add_f32 v64, 1.0, v64
  v_rcp_f32 v64, v64
  s_nop 0
  v_mul_f32 v19, v19, v64
  v_add_f32 v20, v20, v12
  v_mul_f32 v64, v20, v20
  v_fma_f32 v64, v64, s33, 1.0
  v_mul_f32 v64, v64, v20
  v_mul_f32 v64, s34, v64
  v_exp_f32 v64, v64
  s_nop 0
  v_add_f32 v64, 1.0, v64
  v_rcp_f32 v64, v64
  s_nop 0
  v_mul_f32 v20, v20, v64
  v_add_f32 v21, v21, v12
  v_mul_f32 v64, v21, v21
  v_fma_f32 v64, v64, s33, 1.0
  v_mul_f32 v64, v64, v21
  v_mul_f32 v64, s34, v64
  v_exp_f32 v64, v64
  s_nop 0
  v_add_f32 v64, 1.0, v64
  v_rcp_f32 v64, v64
  s_nop 0
  v_mul_f32 v21, v21, v64
  v_add_f32 v22, v22, v12
  v_mul_f32 v64, v22, v22
  v_fma_f32 v64, v64, s33, 1.0
  v_mul_f32 v64, v64, v22
  v_mul_f32 v64, s34, v64
  v_exp_f32 v64, v64
  s_nop 0
  v_add_f32 v64, 1.0, v64
  v_rcp_f32 v64, v64
  s_nop 0
  v_mul_f32 v22, v22, v64
  v_add_f32 v23, v23, v12
  v_mul_f32 v64, v23, v23
  v_fma_f32 v64, v64, s33, 1.0
  v_mul_f32 v64, v64, v23
  v_mul_f32 v64, s34, v64
  v_exp_f32 v64, v64
  s_nop 0
  v_add_f32 v64, 1.0, v64
  v_rcp_f32 v64, v64
  s_nop 0
  v_mul_f32 v23, v23, v64
  v_add_f32 v24, v24, v12
  v_mul_f32 v64, v24, v24
  v_fma_f32 v64, v64, s33, 1.0
  v_mul_f32 v64, v64, v24
  v_mul_f32 v64, s34, v64
  v_exp_f32 v64, v64
  s_nop 0
  v_add_f32 v64, 1.0, v64
  v_rcp_f32 v64, v64
  s_nop 0
  v_mul_f32 v24, v24, v64
  v_add_f32 v25, v25, v12
  v_mul_f32 v64, v25, v25
  v_fma_f32 v64, v64, s33, 1.0
  v_mul_f32 v64, v64, v25
  v_mul_f32 v64, s34, v64
  v_exp_f32 v64, v64
  s_nop 0
  v_add_f32 v64, 1.0, v64
  v_rcp_f32 v64, v64
  s_nop 0
  v_mul_f32 v25, v25, v64
  v_add_f32 v26, v26, v12
  v_mul_f32 v64, v26, v26
  v_fma_f32 v64, v64, s33, 1.0
  v_mul_f32 v64, v64, v26
  v_mul_f32 v64, s34, v64
  v_exp_f32 v64, v64
  s_nop 0
  v_add_f32 v64, 1.0, v64
  v_rcp_f32 v64, v64
  s_nop 0
  v_mul_f32 v26, v26, v64
  v_add_f32 v27, v27, v12
  v_mul_f32 v64, v27, v27
  v_fma_f32 v64, v64, s33, 1.0
  v_mul_f32 v64, v64, v27
  v_mul_f32 v64, s34, v64
  v_exp_f32 v64, v64
  s_nop 0
  v_add_f32 v64, 1.0, v64
  v_rcp_f32 v64, v64
  s_nop 0
  v_mul_f32 v27, v27, v64
  v_add_f32 v28, v28, v12
  v_mul_f32 v64, v28, v28
  v_fma_f32 v64, v64, s33, 1.0
  v_mul_f32 v64, v64, v28
  v_mul_f32 v64, s34, v64
  v_exp_f32 v64, v64
  s_nop 0
  v_add_f32 v64, 1.0, v64
  v_rcp_f32 v64, v64
  s_nop 0
  v_mul_f32 v28, v28, v64
  v_add_f32 v29, v29, v12
  v_mul_f32 v64, v29, v29
  v_fma_f32 v64, v64, s33, 1.0
  v_mul_f32 v64, v64, v29
  v_mul_f32 v64, s34, v64
  v_exp_f32 v64, v64
  s_nop 0
  v_add_f32 v64, 1.0, v64
  v_rcp_f32 v64, v64
  s_nop 0
  v_mul_f32 v29, v29, v64
  v_add_f32 v30, v30, v12
  v_mul_f32 v64, v30, v30
  v_fma_f32 v64, v64, s33, 1.0
  v_mul_f32 v64, v64, v30
  v_mul_f32 v64, s34, v64
  v_exp_f32 v64, v64
  s_nop 0
  v_add_f32 v64, 1.0, v64
  v_rcp_f32 v64, v64
  s_nop 0
  v_mul_f32 v30, v30, v64
  v_add_f32 v31, v31, v12
  v_mul_f32 v64, v31, v31
  v_fma_f32 v64, v64, s33, 1.0
  v_mul_f32 v64, v64, v31
  v_mul_f32 v64, s34, v64
  v_exp_f32 v64, v64
  s_nop 0
  v_add_f32 v64, 1.0, v64
  v_rcp_f32 v64, v64
  s_nop 0
  v_mul_f32 v31, v31, v64
  v_cvt_pk_bf16_f32 v68, v16, v17
  v_cvt_pk_bf16_f32 v69, v18, v19
  v_cvt_pk_bf16_f32 v70, v20, v21
  v_cvt_pk_bf16_f32 v71, v22, v23
  s_nop 0
  v_permlane32_swap_b32 v68, v70
  v_permlane32_swap_b32 v69, v71
  buffer_store_dwordx4 v[68:71], v13, s[16:19], s32 offen offset:0 sc1
  v_cvt_pk_bf16_f32 v72, v24, v25
  v_cvt_pk_bf16_f32 v73, v26, v27
  v_cvt_pk_bf16_f32 v74, v28, v29
  v_cvt_pk_bf16_f32 v75, v30, v31
  s_nop 0
  v_permlane32_swap_b32 v72, v74
  v_permlane32_swap_b32 v73, v75
  buffer_store_dwordx4 v[72:75], v13, s[16:19], s32 offen offset:32 sc1
  v_add_f32 v32, v32, v12
  v_mul_f32 v64, v32, v32
  v_fma_f32 v64, v64, s33, 1.0
  v_mul_f32 v64, v64, v32
  v_mul_f32 v64, s34, v64
  v_exp_f32 v64, v64
  s_nop 0
  v_add_f32 v64, 1.0, v64
  v_rcp_f32 v64, v64
  s_nop 0
  v_mul_f32 v32, v32, v64
  v_add_f32 v33, v33, v12
  v_mul_f32 v64, v33, v33
  v_fma_f32 v64, v64, s33, 1.0
  v_mul_f32 v64, v64, v33
  v_mul_f32 v64, s34, v64
  v_exp_f32 v64, v64
  s_nop 0
  v_add_f32 v64, 1.0, v64
  v_rcp_f32 v64, v64
  s_nop 0
  v_mul_f32 v33, v33, v64
  v_add_f32 v34, v34, v12
  v_mul_f32 v64, v34, v34
  v_fma_f32 v64, v64, s33, 1.0
  v_mul_f32 v64, v64, v34
  v_mul_f32 v64, s34, v64
  v_exp_f32 v64, v64
  s_nop 0
  v_add_f32 v64, 1.0, v64
  v_rcp_f32 v64, v64
  s_nop 0
  v_mul_f32 v34, v34, v64
  v_add_f32 v35, v35, v12
  v_mul_f32 v64, v35, v35
  v_fma_f32 v64, v64, s33, 1.0
  v_mul_f32 v64, v64, v35
  v_mul_f32 v64, s34, v64
  v_exp_f32 v64, v64
  s_nop 0
  v_add_f32 v64, 1.0, v64
  v_rcp_f32 v64, v64
  s_nop 0
  v_mul_f32 v35, v35, v64
  v_add_f32 v36, v36, v12
  v_mul_f32 v64, v36, v36
  v_fma_f32 v64, v64, s33, 1.0
  v_mul_f32 v64, v64, v36
  v_mul_f32 v64, s34, v64
  v_exp_f32 v64, v64
  s_nop 0
  v_add_f32 v64, 1.0, v64
  v_rcp_f32 v64, v64
  s_nop 0
  v_mul_f32 v36, v36, v64
  v_add_f32 v37, v37, v12
  v_mul_f32 v64, v37, v37
  v_fma_f32 v64, v64, s33, 1.0
  v_mul_f32 v64, v64, v37
  v_mul_f32 v64, s34, v64
  v_exp_f32 v64, v64
  s_nop 0
  v_add_f32 v64, 1.0, v64
  v_rcp_f32 v64, v64
  s_nop 0
  v_mul_f32 v37, v37, v64
  v_add_f32 v38, v38, v12
  v_mul_f32 v64, v38, v38
  v_fma_f32 v64, v64, s33, 1.0
  v_mul_f32 v64, v64, v38
  v_mul_f32 v64, s34, v64
  v_exp_f32 v64, v64
  s_nop 0
  v_add_f32 v64, 1.0, v64
  v_rcp_f32 v64, v64
  s_nop 0
  v_mul_f32 v38, v38, v64
  v_add_f32 v39, v39, v12
  v_mul_f32 v64, v39, v39
  v_fma_f32 v64, v64, s33, 1.0
  v_mul_f32 v64, v64, v39
  v_mul_f32 v64, s34, v64
  v_exp_f32 v64, v64
  s_nop 0
  v_add_f32 v64, 1.0, v64
  v_rcp_f32 v64, v64
  s_nop 0
  v_mul_f32 v39, v39, v64
  v_add_f32 v40, v40, v12
  v_mul_f32 v64, v40, v40
  v_fma_f32 v64, v64, s33, 1.0
  v_mul_f32 v64, v64, v40
  v_mul_f32 v64, s34, v64
  v_exp_f32 v64, v64
  s_nop 0
  v_add_f32 v64, 1.0, v64
  v_rcp_f32 v64, v64
  s_nop 0
  v_mul_f32 v40, v40, v64
  v_add_f32 v41, v41, v12
  v_mul_f32 v64, v41, v41
  v_fma_f32 v64, v64, s33, 1.0
  v_mul_f32 v64, v64, v41
  v_mul_f32 v64, s34, v64
  v_exp_f32 v64, v64
  s_nop 0
  v_add_f32 v64, 1.0, v64
  v_rcp_f32 v64, v64
  s_nop 0
  v_mul_f32 v41, v41, v64
  v_add_f32 v42, v42, v12
  v_mul_f32 v64, v42, v42
  v_fma_f32 v64, v64, s33, 1.0
  v_mul_f32 v64, v64, v42
  v_mul_f32 v64, s34, v64
  v_exp_f32 v64, v64
  s_nop 0
  v_add_f32 v64, 1.0, v64
  v_rcp_f32 v64, v64
  s_nop 0
  v_mul_f32 v42, v42, v64
  v_add_f32 v43, v43, v12
  v_mul_f32 v64, v43, v43
  v_fma_f32 v64, v64, s33, 1.0
  v_mul_f32 v64, v64, v43
  v_mul_f32 v64, s34, v64
  v_exp_f32 v64, v64
  s_nop 0
  v_add_f32 v64, 1.0, v64
  v_rcp_f32 v64, v64
  s_nop 0
  v_mul_f32 v43, v43, v64
  v_add_f32 v44, v44, v12
  v_mul_f32 v64, v44, v44
  v_fma_f32 v64, v64, s33, 1.0
  v_mul_f32 v64, v64, v44
  v_mul_f32 v64, s34, v64
  v_exp_f32 v64, v64
  s_nop 0
  v_add_f32 v64, 1.0, v64
  v_rcp_f32 v64, v64
  s_nop 0
  v_mul_f32 v44, v44, v64
  v_add_f32 v45, v45, v12
  v_mul_f32 v64, v45, v45
  v_fma_f32 v64, v64, s33, 1.0
  v_mul_f32 v64, v64, v45
  v_mul_f32 v64, s34, v64
  v_exp_f32 v64, v64
  s_nop 0
  v_add_f32 v64, 1.0, v64
  v_rcp_f32 v64, v64
  s_nop 0
  v_mul_f32 v45, v45, v64
  v_add_f32 v46, v46, v12
  v_mul_f32 v64, v46, v46
  v_fma_f32 v64, v64, s33, 1.0
  v_mul_f32 v64, v64, v46
  v_mul_f32 v64, s34, v64
  v_exp_f32 v64, v64
  s_nop 0
  v_add_f32 v64, 1.0, v64
  v_rcp_f32 v64, v64
  s_nop 0
  v_mul_f32 v46, v46, v64
  v_add_f32 v47, v47, v12
  v_mul_f32 v64, v47, v47
  v_fma_f32 v64, v64, s33, 1.0
  v_mul_f32 v64, v64, v47
  v_mul_f32 v64, s34, v64
  v_exp_f32 v64, v64
  s_nop 0
  v_add_f32 v64, 1.0, v64
  v_rcp_f32 v64, v64
  s_nop 0
  v_mul_f32 v47, v47, v64
  v_cvt_pk_bf16_f32 v68, v32, v33
  v_cvt_pk_bf16_f32 v69, v34, v35
  v_cvt_pk_bf16_f32 v70, v36, v37
  v_cvt_pk_bf16_f32 v71, v38, v39
  s_nop 0
  v_permlane32_swap_b32 v68, v70
  v_permlane32_swap_b32 v69, v71
  buffer_store_dwordx4 v[68:71], v13, s[16:19], s32 offen offset:64 sc1
  v_cvt_pk_bf16_f32 v72, v40, v41
  v_cvt_pk_bf16_f32 v73, v42, v43
  v_cvt_pk_bf16_f32 v74, v44, v45
  v_cvt_pk_bf16_f32 v75, v46, v47
  s_nop 0
  v_permlane32_swap_b32 v72, v74
  v_permlane32_swap_b32 v73, v75
  buffer_store_dwordx4 v[72:75], v13, s[16:19], s32 offen offset:96 sc1
  v_add_f32 v48, v48, v12
  v_mul_f32 v64, v48, v48
  v_fma_f32 v64, v64, s33, 1.0
  v_mul_f32 v64, v64, v48
  v_mul_f32 v64, s34, v64
  v_exp_f32 v64, v64
  s_nop 0
  v_add_f32 v64, 1.0, v64
  v_rcp_f32 v64, v64
  s_nop 0
  v_mul_f32 v48, v48, v64
  v_add_f32 v49, v49, v12
  v_mul_f32 v64, v49, v49
  v_fma_f32 v64, v64, s33, 1.0
  v_mul_f32 v64, v64, v49
  v_mul_f32 v64, s34, v64
  v_exp_f32 v64, v64
  s_nop 0
  v_add_f32 v64, 1.0, v64
  v_rcp_f32 v64, v64
  s_nop 0
  v_mul_f32 v49, v49, v64
  v_add_f32 v50, v50, v12
  v_mul_f32 v64, v50, v50
  v_fma_f32 v64, v64, s33, 1.0
  v_mul_f32 v64, v64, v50
  v_mul_f32 v64, s34, v64
  v_exp_f32 v64, v64
  s_nop 0
  v_add_f32 v64, 1.0, v64
  v_rcp_f32 v64, v64
  s_nop 0
  v_mul_f32 v50, v50, v64
  v_add_f32 v51, v51, v12
  v_mul_f32 v64, v51, v51
  v_fma_f32 v64, v64, s33, 1.0
  v_mul_f32 v64, v64, v51
  v_mul_f32 v64, s34, v64
  v_exp_f32 v64, v64
  s_nop 0
  v_add_f32 v64, 1.0, v64
  v_rcp_f32 v64, v64
  s_nop 0
  v_mul_f32 v51, v51, v64
  v_add_f32 v52, v52, v12
  v_mul_f32 v64, v52, v52
  v_fma_f32 v64, v64, s33, 1.0
  v_mul_f32 v64, v64, v52
  v_mul_f32 v64, s34, v64
  v_exp_f32 v64, v64
  s_nop 0
  v_add_f32 v64, 1.0, v64
  v_rcp_f32 v64, v64
  s_nop 0
  v_mul_f32 v52, v52, v64
  v_add_f32 v53, v53, v12
  v_mul_f32 v64, v53, v53
  v_fma_f32 v64, v64, s33, 1.0
  v_mul_f32 v64, v64, v53
  v_mul_f32 v64, s34, v64
  v_exp_f32 v64, v64
  s_nop 0
  v_add_f32 v64, 1.0, v64
  v_rcp_f32 v64, v64
  s_nop 0
  v_mul_f32 v53, v53, v64
  v_add_f32 v54, v54, v12
  v_mul_f32 v64, v54, v54
  v_fma_f32 v64, v64, s33, 1.0
  v_mul_f32 v64, v64, v54
  v_mul_f32 v64, s34, v64
  v_exp_f32 v64, v64
  s_nop 0
  v_add_f32 v64, 1.0, v64
  v_rcp_f32 v64, v64
  s_nop 0
  v_mul_f32 v54, v54, v64
  v_add_f32 v55, v55, v12
  v_mul_f32 v64, v55, v55
  v_fma_f32 v64, v64, s33, 1.0
  v_mul_f32 v64, v64, v55
  v_mul_f32 v64, s34, v64
  v_exp_f32 v64, v64
  s_nop 0
  v_add_f32 v64, 1.0, v64
  v_rcp_f32 v64, v64
  s_nop 0
  v_mul_f32 v55, v55, v64
  v_add_f32 v56, v56, v12
  v_mul_f32 v64, v56, v56
  v_fma_f32 v64, v64, s33, 1.0
  v_mul_f32 v64, v64, v56
  v_mul_f32 v64, s34, v64
  v_exp_f32 v64, v64
  s_nop 0
  v_add_f32 v64, 1.0, v64
  v_rcp_f32 v64, v64
  s_nop 0
  v_mul_f32 v56, v56, v64
  v_add_f32 v57, v57, v12
  v_mul_f32 v64, v57, v57
  v_fma_f32 v64, v64, s33, 1.0
  v_mul_f32 v64, v64, v57
  v_mul_f32 v64, s34, v64
  v_exp_f32 v64, v64
  s_nop 0
  v_add_f32 v64, 1.0, v64
  v_rcp_f32 v64, v64
  s_nop 0
  v_mul_f32 v57, v57, v64
  v_add_f32 v58, v58, v12
  v_mul_f32 v64, v58, v58
  v_fma_f32 v64, v64, s33, 1.0
  v_mul_f32 v64, v64, v58
  v_mul_f32 v64, s34, v64
  v_exp_f32 v64, v64
  s_nop 0
  v_add_f32 v64, 1.0, v64
  v_rcp_f32 v64, v64
  s_nop 0
  v_mul_f32 v58, v58, v64
  v_add_f32 v59, v59, v12
  v_mul_f32 v64, v59, v59
  v_fma_f32 v64, v64, s33, 1.0
  v_mul_f32 v64, v64, v59
  v_mul_f32 v64, s34, v64
  v_exp_f32 v64, v64
  s_nop 0
  v_add_f32 v64, 1.0, v64
  v_rcp_f32 v64, v64
  s_nop 0
  v_mul_f32 v59, v59, v64
  v_add_f32 v60, v60, v12
  v_mul_f32 v64, v60, v60
  v_fma_f32 v64, v64, s33, 1.0
  v_mul_f32 v64, v64, v60
  v_mul_f32 v64, s34, v64
  v_exp_f32 v64, v64
  s_nop 0
  v_add_f32 v64, 1.0, v64
  v_rcp_f32 v64, v64
  s_nop 0
  v_mul_f32 v60, v60, v64
  v_add_f32 v61, v61, v12
  v_mul_f32 v64, v61, v61
  v_fma_f32 v64, v64, s33, 1.0
  v_mul_f32 v64, v64, v61
  v_mul_f32 v64, s34, v64
  v_exp_f32 v64, v64
  s_nop 0
  v_add_f32 v64, 1.0, v64
  v_rcp_f32 v64, v64
  s_nop 0
  v_mul_f32 v61, v61, v64
  v_add_f32 v62, v62, v12
  v_mul_f32 v64, v62, v62
  v_fma_f32 v64, v64, s33, 1.0
  v_mul_f32 v64, v64, v62
  v_mul_f32 v64, s34, v64
  v_exp_f32 v64, v64
  s_nop 0
  v_add_f32 v64, 1.0, v64
  v_rcp_f32 v64, v64
  s_nop 0
  v_mul_f32 v62, v62, v64
  v_add_f32 v63, v63, v12
  v_mul_f32 v64, v63, v63
  v_fma_f32 v64, v64, s33, 1.0
  v_mul_f32 v64, v64, v63
  v_mul_f32 v64, s34, v64
  v_exp_f32 v64, v64
  s_nop 0
  v_add_f32 v64, 1.0, v64
  v_rcp_f32 v64, v64
  s_nop 0
  v_mul_f32 v63, v63, v64
  v_cvt_pk_bf16_f32 v68, v48, v49
  v_cvt_pk_bf16_f32 v69, v50, v51
  v_cvt_pk_bf16_f32 v70, v52, v53
  v_cvt_pk_bf16_f32 v71, v54, v55
  s_nop 0
  v_permlane32_swap_b32 v68, v70
  v_permlane32_swap_b32 v69, v71
  buffer_store_dwordx4 v[68:71], v13, s[16:19], s32 offen offset:128 sc1
  v_cvt_pk_bf16_f32 v72, v56, v57
  v_cvt_pk_bf16_f32 v73, v58, v59
  v_cvt_pk_bf16_f32 v74, v60, v61
  v_cvt_pk_bf16_f32 v75, v62, v63
  s_nop 0
  v_permlane32_swap_b32 v72, v74
  v_permlane32_swap_b32 v73, v75
  buffer_store_dwordx4 v[72:75], v13, s[16:19], s32 offen offset:160 sc1
G4_DONE:
  s_waitcnt vmcnt(0)
  s_barrier
  s_cmp_eq_u32 s94, 0
  s_cbranch_scc0 G4_ANN
  s_mov_b64 exec, 1
  v_mov_b32 v10, 1
  v_mov_b32 v11, 16
  buffer_atomic_add v10, v11, s[28:31], 0 offen
  s_mov_b64 exec, -1
G4_ANN:
  v_mov_b32 v10, 16
  s_mov_b32 s96, 0
G5W_7:
  buffer_load_dword v11, v10, s[28:31], 0 offen sc1
  s_waitcnt vmcnt(0)
  v_readfirstlane_b32 s3, v11
  s_nop 0
  s_cmp_eq_u32 s3, 224
  s_cbranch_scc1 G5W_7_ok
  s_sleep 8
  s_add_u32 s96, s96, 1
  s_cmp_lt_u32 s96, 60000
  s_cbranch_scc1 G5W_7
  s_branch W_FAIL
G5W_7_ok:
  s_cmp_lt_u32 s95, 192
  s_cbranch_scc0 G5_DONE
  s_add_u32 s8, s92, 0x4800000
  s_addc_u32 s9, s93, 0
  s_mov_b32 s10, 0x510000
  s_mov_b32 s11, 0x00020000
  s_mov_b32 s12, s84
  s_mov_b32 s13, s85
  s_mov_b32 s14, 0x1200000
  s_mov_b32 s15, 0x00020000
  s_add_u32 s16, s92, 0x5000000
  s_addc_u32 s17, s93, 0
  s_mov_b32 s18, 0x900000
  s_mov_b32 s19, 0x00020000
  s_mul_hi_u32 s33, s95, 715827883
  s_mul_i32 s32, s33, 6
  s_sub_u32 s36, s95, s32
  s_and_b32 s37, s33, 15
  s_lshr_b32 s38, s33, 4
  s_mov_b32 s42, s38
  s_mul_i32 s38, s38, 2304
  s_mul_i32 s36, s36, 96
  s_lshl_b32 s37, s37, 7
  v_add_u32 v10, 0, v0
  v_mul_u32_u24 v11, 43691, v10
  v_lshrrev_b32 v11, 19, v11
  v_mul_u32_u24 v12, 12, v11
  v_sub_u32 v12, v10, v12
  v_mul_u32_u24 v11, 1152, v11
  v_lshl_add_u32 v1, v12, 4, v11
  v_add_u32 v10, 64, v0
  v_mul_u32_u24 v11, 43691, v10
  v_lshrrev_b32 v11, 19, v11
  v_mul_u32_u24 v12, 12, v11
  v_sub_u32 v12, v10, v12
  v_mul_u32_u24 v11, 1152, v11
  v_lshl_add_u32 v2, v12, 4, v11
  v_add_u32 v10, 128, v0
  v_mul_u32_u24 v11, 43691, v10
  v_lshrrev_b32 v11, 19, v11
  v_mul_u32_u24 v12, 12, v11
  v_sub_u32 v12, v10, v12
  v_mul_u32_u24 v11, 1152, v11
  v_lshl_add_u32 v3, v12, 4, v11
  v_lshrrev_b32 v10, 4, v0
  v_and_b32 v11, 15, v0
  v_lshlrev_b32 v12, 2, v10
  v_xor_b32 v12, v12, v11
  v_mul_u32_u24 v13, 4096, v10
  v_lshl_add_u32 v4, v12, 4, v13
  v_lshrrev_b32 v12, 2, v11
  v_lshrrev_b32 v13, 1, v10
  v_lshl_or_b32 v13, v13, 3, v12
  v_and_b32 v14, 1, v10
  v_and_b32 v15, 3, v0
  v_mul_u32_u24 v16, 192, v13
  v_lshl_add_u32 v16, v14, 5, v16
  v_lshl_add_u32 v5, v15, 3, v16
  s_lshl_b32 s32, s94, 2
  v_lshlrev_b32 v16, 1, v14
  v_or_b32 v16, s32, v16
  v_lshrrev_b32 v17, 1, v15
  v_or_b32 v16, v16, v17
  v_lshlrev_b32 v17, 2, v12
  v_xor_b32 v16, v16, v17
  v_lshlrev_b32 v16, 4, v16
  v_lshl_add_u32 v16, v13, 8, v16
  v_and_b32 v17, 1, v15
  v_lshl_add_u32 v16, v17, 3, v16
  v_add_u32 v6, 12288, v16
  s_lshl_b32 s32, s94, 4
  s_add_u32 s32, s32, s38
  s_mul_i32 s39, s32, 1152
  s_lshl_b32 s33, s36, 1
  s_add_u32 s39, s39, s33
  s_mul_i32 s40, s32, 4096
  s_lshl_b32 s33, s37, 1
  s_add_u32 s40, s40, s33
  s_mul_i32 s43, s94, 3072
  s_lshl_b32 s44, s94, 12
  s_add_u32 s44, s44, 12288
  s_barrier
  s_add_u32 m0, s43, 0
  s_nop 0
  buffer_load_dwordx4 v1, s[8:11], s39 offen sc1 lds
  s_add_u32 m0, s43, 1024
  s_nop 0
  buffer_load_dwordx4 v2, s[8:11], s39 offen sc1 lds
  s_add_u32 m0, s43, 2048
  s_nop 0
  buffer_load_dwordx4 v3, s[8:11], s39 offen sc1 lds
  s_add_u32 m0, s44, 0
  s_nop 0
  buffer_load_dwordx4 v4, s[12:15], s40 offen lds
  s_add_u32 m0, s44, 1024
  s_add_u32 s32, s40, 16384
  buffer_load_dwordx4 v4, s[12:15], s32 offen lds
  s_add_u32 m0, s44, 2048
  s_add_u32 s32, s40, 32768
  buffer_load_dwordx4 v4, s[12:15], s32 offen lds
  s_add_u32 m0, s44, 3072
  s_add_u32 s32, s40, 49152
  buffer_load_dwordx4 v4, s[12:15], s32 offen lds
  s_add_u32 s39, s39, 73728
  s_add_u32 s40, s40, 262144
  s_add_u32 m0, s43, 28672
  s_nop 0
  buffer_load_dwordx4 v1, s[8:11], s39 offen sc1 lds
  s_add_u32 m0, s43, 29696
  s_nop 0
  buffer_load_dwordx4 v2, s[8:11], s39 offen sc1 lds
  s_add_u32 m0, s43, 30720
  s_nop 0
  buffer_load_dwordx4 v3, s[8:11], s39 offen sc1 lds
  s_add_u32 m0, s44, 28672
  s_nop 0
  buffer_load_dwordx4 v4, s[12:15], s40 offen lds
  s_add_u32 m0, s44, 29696
  s_add_u32 s32, s40, 16384
  buffer_load_dwordx4 v4, s[12:15], s32 offen lds
  s_add_u32 m0, s44, 30720
  s_add_u32 s32, s40, 32768
  buffer_load_dwordx4 v4, s[12:15], s32 offen lds
  s_add_u32 m0, s44, 31744
  s_add_u32 s32, s40, 49152
  buffer_load_dwordx4 v4, s[12:15], s32 offen lds
  s_add_u32 s39, s39, 73728
  s_add_u32 s40, s40, 262144
  s_add_u32 m0, s43, 57344
  s_nop 0
  buffer_load_dwordx4 v1, s[8:11], s39 offen sc1 lds
  s_add_u32 m0, s43, 58368
  s_nop 0
  buffer_load_dwordx4 v2, s[8:11], s39 offen sc1 lds
  s_add_u32 m0, s43, 59392
  s_nop 0
  buffer_load_dwordx4 v3, s[8:11], s39 offen sc1 lds
  s_add_u32 m0, s44, 57344
  s_nop 0
  buffer_load_dwordx4 v4, s[12:15], s40 offen lds
  s_add_u32 m0, s44, 58368
  s_add_u32 s32, s40, 16384
  buffer_load_dwordx4 v4, s[12:15], s32 offen lds
  s_add_u32 m0, s44, 59392
  s_add_u32 s32, s40, 32768
  buffer_load_dwordx4 v4, s[12:15], s32 offen lds
  s_add_u32 m0, s44, 60416
  s_add_u32 s32, s40, 49152
  buffer_load_dwordx4 v4, s[12:15], s32 offen lds
  s_add_u32 s39, s39, 73728
  s_add_u32 s40, s40, 262144
  v_mov_b64 v[16:17], 0
  v_mov_b64 v[18:19], 0
  v_mov_b64 v[20:21], 0
  v_mov_b64 v[22:23], 0
  v_mov_b64 v[24:25], 0
  v_mov_b64 v[26:27], 0
  v_mov_b64 v[28:29], 0
  v_mov_b64 v[30:31], 0
  v_mov_b64 v[32:33], 0
  v_mov_b64 v[34:35], 0
  v_mov_b64 v[36:37], 0
  v_mov_b64 v[38:39], 0
  v_mov_b64 v[40:41], 0
  v_mov_b64 v[42:43], 0
  v_mov_b64 v[44:45], 0
  v_mov_b64 v[46:47], 0
  v_mov_b64 v[48:49], 0
  v_mov_b64 v[50:51], 0
  v_mov_b64 v[52:53], 0
  v_mov_b64 v[54:55], 0
  v_mov_b64 v[56:57], 0
  v_mov_b64 v[58:59], 0
  v_mov_b64 v[60:61], 0
  v_mov_b64 v[62:63], 0
  s_mov_b32 s41, 0
G5L_8:
  s_add_u32 s33, s41, 3
  s_cmp_lt_u32 s33, 36
  s_cbranch_scc0 G5L_8_t0
  s_waitcnt vmcnt(14)
  s_barrier
  s_add_u32 m0, s43, 86016
  s_nop 0
  buffer_load_dwordx4 v1, s[8:11], s39 offen sc1 lds
  s_add_u32 m0, s43, 87040
  s_nop 0
  buffer_load_dwordx4 v2, s[8:11], s39 offen sc1 lds
  s_add_u32 m0, s43, 88064
  s_nop 0
  buffer_load_dwordx4 v3, s[8:11], s39 offen sc1 lds
  s_add_u32 m0, s44, 86016
  s_nop 0
  buffer_load_dwordx4 v4, s[12:15], s40 offen lds
  s_add_u32 m0, s44, 87040
  s_add_u32 s32, s40, 16384
  buffer_load_dwordx4 v4, s[12:15], s32 offen lds
  s_add_u32 m0, s44, 88064
  s_add_u32 s32, s40, 32768
  buffer_load_dwordx4 v4, s[12:15], s32 offen lds
  s_add_u32 m0, s44, 89088
  s_add_u32 s32, s40, 49152
  buffer_load_dwordx4 v4, s[12:15], s32 offen lds
  s_add_u32 s39, s39, 73728
  s_add_u32 s40, s40, 262144
  s_branch G5L_8_c0
G5L_8_t0:
  s_waitcnt vmcnt(0)
  s_barrier
G5L_8_c0:
  v_add_u32 v7, 0, v5
  v_add_u32 v8, 0, v6
  ds_read_b64_tr_b16 v[76:77], v8 offset:0
  ds_read_b64_tr_b16 v[78:79], v8 offset:1024
  ds_read_b64_tr_b16 v[64:65], v7 offset:0
  ds_read_b64_tr_b16 v[66:67], v7 offset:768
  ds_read_b64_tr_b16 v[68:69], v7 offset:64
  ds_read_b64_tr_b16 v[70:71], v7 offset:832
  ds_read_b64_tr_b16 v[72:73], v7 offset:128
  ds_read_b64_tr_b16 v[74:75], v7 offset:896
  s_waitcnt lgkmcnt(4)
  ds_read_b64_tr_b16 v[92:93], v8 offset:4096
  ds_read_b64_tr_b16 v[94:95], v8 offset:5120
  ds_read_b64_tr_b16 v[80:81], v7 offset:3072
  ds_read_b64_tr_b16 v[82:83], v7 offset:3840
  ds_read_b64_tr_b16 v[84:85], v7 offset:3136
  ds_read_b64_tr_b16 v[86:87], v7 offset:3904
  ds_read_b64_tr_b16 v[88:89], v7 offset:3200
  ds_read_b64_tr_b16 v[90:91], v7 offset:3968
  v_mfma_f32_32x32x16_bf16 v[16:31], v[64:67], v[76:79], v[16:31]
  s_waitcnt lgkmcnt(10)
  v_mfma_f32_32x32x16_bf16 v[32:47], v[68:71], v[76:79], v[32:47]
  s_waitcnt lgkmcnt(8)
  v_mfma_f32_32x32x16_bf16 v[48:63], v[72:75], v[76:79], v[48:63]
  s_waitcnt lgkmcnt(4)
  ds_read_b64_tr_b16 v[76:77], v8 offset:8192
  ds_read_b64_tr_b16 v[78:79], v8 offset:9216
  ds_read_b64_tr_b16 v[64:65], v7 offset:6144
  ds_read_b64_tr_b16 v[66:67], v7 offset:6912
  ds_read_b64_tr_b16 v[68:69], v7 offset:6208
  ds_read_b64_tr_b16 v[70:71], v7 offset:6976
  ds_read_b64_tr_b16 v[72:73], v7 offset:6272
  ds_read_b64_tr_b16 v[74:75], v7 offset:7040
  v_mfma_f32_32x32x16_bf16 v[16:31], v[80:83], v[92:95], v[16:31]
  s_waitcnt lgkmcnt(10)
  v_mfma_f32_32x32x16_bf16 v[32:47], v[84:87], v[92:95], v[32:47]
  s_waitcnt lgkmcnt(8)
  v_mfma_f32_32x32x16_bf16 v[48:63], v[88:91], v[92:95], v[48:63]
  s_waitcnt lgkmcnt(4)
  ds_read_b64_tr_b16 v[92:93], v8 offset:12288
  ds_read_b64_tr_b16 v[94:95], v8 offset:13312
  ds_read_b64_tr_b16 v[80:81], v7 offset:9216
  ds_read_b64_tr_b16 v[82:83], v7 offset:9984
  ds_read_b64_tr_b16 v[84:85], v7 offset:9280
  ds_read_b64_tr_b16 v[86:87], v7 offset:10048
  ds_read_b64_tr_b16 v[88:89], v7 offset:9344
  ds_read_b64_tr_b16 v[90:91], v7 offset:10112
  v_mfma_f32_32x32x16_bf16 v[16:31], v[64:67], v[76:79], v[16:31]
  s_waitcnt lgkmcnt(10)
  v_mfma_f32_32x32x16_bf16 v[32:47], v[68:71], v[76:79], v[32:47]
  s_waitcnt lgkmcnt(8)
  v_mfma_f32_32x32x16_bf16 v[48:63], v[72:75], v[76:79], v[48:63]
  s_waitcnt lgkmcnt(4)
  v_mfma_f32_32x32x16_bf16 v[16:31], v[80:83], v[92:95], v[16:31]
  s_waitcnt lgkmcnt(2)
  v_mfma_f32_32x32x16_bf16 v[32:47], v[84:87], v[92:95], v[32:47]
  s_waitcnt lgkmcnt(0)
  v_mfma_f32_32x32x16_bf16 v[48:63], v[88:91], v[92:95], v[48:63]
  s_add_u32 s33, s41, 4
  s_cmp_lt_u32 s33, 36
  s_cbranch_scc0 G5L_8_t1
  s_waitcnt vmcnt(14)
  s_barrier
  s_add_u32 m0, s43, 0
  s_nop 0
  buffer_load_dwordx4 v1, s[8:11], s39 offen sc1 lds
  s_add_u32 m0, s43, 1024
  s_nop 0
  buffer_load_dwordx4 v2, s[8:11], s39 offen sc1 lds
  s_add_u32 m0, s43, 2048
  s_nop 0
  buffer_load_dwordx4 v3, s[8:11], s39 offen sc1 lds
  s_add_u32 m0, s44, 0
  s_nop 0
  buffer_load_dwordx4 v4, s[12:15], s40 offen lds
  s_add_u32 m0, s44, 1024
  s_add_u32 s32, s40, 16384
  buffer_load_dwordx4 v4, s[12:15], s32 offen lds
  s_add_u32 m0, s44, 2048
  s_add_u32 s32, s40, 32768
  buffer_load_dwordx4 v4, s[12:15], s32 offen lds
  s_add_u32 m0, s44, 3072
  s_add_u32 s32, s40, 49152
  buffer_load_dwordx4 v4, s[12:15], s32 offen lds
  s_add_u32 s39, s39, 73728
  s_add_u32 s40, s40, 262144
  s_branch G5L_8_c1
G5L_8_t1:
  s_waitcnt vmcnt(0)
  s_barrier
G5L_8_c1:
  v_add_u32 v7, 28672, v5
  v_add_u32 v8, 28672, v6
  ds_read_b64_tr_b16 v[76:77], v8 offset:0
  ds_read_b64_tr_b16 v[78:79], v8 offset:1024
  ds_read_b64_tr_b16 v[64:65], v7 offset:0
  ds_read_b64_tr_b16 v[66:67], v7 offset:768
  ds_read_b64_tr_b16 v[68:69], v7 offset:64
  ds_read_b64_tr_b16 v[70:71], v7 offset:832
  ds_read_b64_tr_b16 v[72:73], v7 offset:128
  ds_read_b64_tr_b16 v[74:75], v7 offset:896
  s_waitcnt lgkmcnt(4)
  ds_read_b64_tr_b16 v[92:93], v8 offset:4096
  ds_read_b64_tr_b16 v[94:95], v8 offset:5120
  ds_read_b64_tr_b16 v[80:81], v7 offset:3072
  ds_read_b64_tr_b16 v[82:83], v7 offset:3840
  ds_read_b64_tr_b16 v[84:85], v7 offset:3136
  ds_read_b64_tr_b16 v[86:87], v7 offset:3904
  ds_read_b64_tr_b16 v[88:89], v7 offset:3200
  ds_read_b64_tr_b16 v[90:91], v7 offset:3968
  v_mfma_f32_32x32x16_bf16 v[16:31], v[64:67], v[76:79], v[16:31]
  s_waitcnt lgkmcnt(10)
  v_mfma_f32_32x32x16_bf16 v[32:47], v[68:71], v[76:79], v[32:47]
  s_waitcnt lgkmcnt(8)
  v_mfma_f32_32x32x16_bf16 v[48:63], v[72:75], v[76:79], v[48:63]
  s_waitcnt lgkmcnt(4)
  ds_read_b64_tr_b16 v[76:77], v8 offset:8192
  ds_read_b64_tr_b16 v[78:79], v8 offset:9216
  ds_read_b64_tr_b16 v[64:65], v7 offset:6144
  ds_read_b64_tr_b16 v[66:67], v7 offset:6912
  ds_read_b64_tr_b16 v[68:69], v7 offset:6208
  ds_read_b64_tr_b16 v[70:71], v7 offset:6976
  ds_read_b64_tr_b16 v[72:73], v7 offset:6272
  ds_read_b64_tr_b16 v[74:75], v7 offset:7040
  v_mfma_f32_32x32x16_bf16 v[16:31], v[80:83], v[92:95], v[16:31]
  s_waitcnt lgkmcnt(10)
  v_mfma_f32_32x32x16_bf16 v[32:47], v[84:87], v[92:95], v[32:47]
  s_waitcnt lgkmcnt(8)
  v_mfma_f32_32x32x16_bf16 v[48:63], v[88:91], v[92:95], v[48:63]
  s_waitcnt lgkmcnt(4)
  ds_read_b64_tr_b16 v[92:93], v8 offset:12288
  ds_read_b64_tr_b16 v[94:95], v8 offset:13312
  ds_read_b64_tr_b16 v[80:81], v7 offset:9216
  ds_read_b64_tr_b16 v[82:83], v7 offset:9984
  ds_read_b64_tr_b16 v[84:85], v7 offset:9280
  ds_read_b64_tr_b16 v[86:87], v7 offset:10048
  ds_read_b64_tr_b16 v[88:89], v7 offset:9344
  ds_read_b64_tr_b16 v[90:91], v7 offset:10112
  v_mfma_f32_32x32x16_bf16 v[16:31], v[64:67], v[76:79], v[16:31]
  s_waitcnt lgkmcnt(10)
  v_mfma_f32_32x32x16_bf16 v[32:47], v[68:71], v[76:79], v[32:47]
  s_waitcnt lgkmcnt(8)
  v_mfma_f32_32x32x16_bf16 v[48:63], v[72:75], v[76:79], v[48:63]
  s_waitcnt lgkmcnt(4)
  v_mfma_f32_32x32x16_bf16 v[16:31], v[80:83], v[92:95], v[16:31]
  s_waitcnt lgkmcnt(2)
  v_mfma_f32_32x32x16_bf16 v[32:47], v[84:87], v[92:95], v[32:47]
  s_waitcnt lgkmcnt(0)
  v_mfma_f32_32x32x16_bf16 v[48:63], v[88:91], v[92:95], v[48:63]
  s_add_u32 s33, s41, 5
  s_cmp_lt_u32 s33, 36
  s_cbranch_scc0 G5L_8_t2
  s_waitcnt vmcnt(14)
  s_barrier
  s_add_u32 m0, s43, 28672
  s_nop 0
  buffer_load_dwordx4 v1, s[8:11], s39 offen sc1 lds
  s_add_u32 m0, s43, 29696
  s_nop 0
  buffer_load_dwordx4 v2, s[8:11], s39 offen sc1 lds
  s_add_u32 m0, s43, 30720
  s_nop 0
  buffer_load_dwordx4 v3, s[8:11], s39 offen sc1 lds
  s_add_u32 m0, s44, 28672
  s_nop 0
  buffer_load_dwordx4 v4, s[12:15], s40 offen lds
  s_add_u32 m0, s44, 29696
  s_add_u32 s32, s40, 16384
  buffer_load_dwordx4 v4, s[12:15], s32 offen lds
  s_add_u32 m0, s44, 30720
  s_add_u32 s32, s40, 32768
  buffer_load_dwordx4 v4, s[12:15], s32 offen lds
  s_add_u32 m0, s44, 31744
  s_add_u32 s32, s40, 49152
  buffer_load_dwordx4 v4, s[12:15], s32 offen lds
  s_add_u32 s39, s39, 73728
  s_add_u32 s40, s40, 262144
  s_branch G5L_8_c2
G5L_8_t2:
  s_waitcnt vmcnt(0)
  s_barrier
G5L_8_c2:
  v_add_u32 v7, 57344, v5
  v_add_u32 v8, 57344, v6
  ds_read_b64_tr_b16 v[76:77], v8 offset:0
  ds_read_b64_tr_b16 v[78:79], v8 offset:1024
  ds_read_b64_tr_b16 v[64:65], v7 offset:0
  ds_read_b64_tr_b16 v[66:67], v7 offset:768
  ds_read_b64_tr_b16 v[68:69], v7 offset:64
  ds_read_b64_tr_b16 v[70:71], v7 offset:832
  ds_read_b64_tr_b16 v[72:73], v7 offset:128
  ds_read_b64_tr_b16 v[74:75], v7 offset:896
  s_waitcnt lgkmcnt(4)
  ds_read_b64_tr_b16 v[92:93], v8 offset:4096
  ds_read_b64_tr_b16 v[94:95], v8 offset:5120
  ds_read_b64_tr_b16 v[80:81], v7 offset:3072
  ds_read_b64_tr_b16 v[82:83], v7 offset:3840
  ds_read_b64_tr_b16 v[84:85], v7 offset:3136
  ds_read_b64_tr_b16 v[86:87], v7 offset:3904
  ds_read_b64_tr_b16 v[88:89], v7 offset:3200
  ds_read_b64_tr_b16 v[90:91], v7 offset:3968
  v_mfma_f32_32x32x16_bf16 v[16:31], v[64:67], v[76:79], v[16:31]
  s_waitcnt lgkmcnt(10)
  v_mfma_f32_32x32x16_bf16 v[32:47], v[68:71], v[76:79], v[32:47]
  s_waitcnt lgkmcnt(8)
  v_mfma_f32_32x32x16_bf16 v[48:63], v[72:75], v[76:79], v[48:63]
  s_waitcnt lgkmcnt(4)
  ds_read_b64_tr_b16 v[76:77], v8 offset:8192
  ds_read_b64_tr_b16 v[78:79], v8 offset:9216
  ds_read_b64_tr_b16 v[64:65], v7 offset:6144
  ds_read_b64_tr_b16 v[66:67], v7 offset:6912
  ds_read_b64_tr_b16 v[68:69], v7 offset:6208
  ds_read_b64_tr_b16 v[70:71], v7 offset:6976
  ds_read_b64_tr_b16 v[72:73], v7 offset:6272
  ds_read_b64_tr_b16 v[74:75], v7 offset:7040
  v_mfma_f32_32x32x16_bf16 v[16:31], v[80:83], v[92:95], v[16:31]
  s_waitcnt lgkmcnt(10)
  v_mfma_f32_32x32x16_bf16 v[32:47], v[84:87], v[92:95], v[32:47]
  s_waitcnt lgkmcnt(8)
  v_mfma_f32_32x32x16_bf16 v[48:63], v[88:91], v[92:95], v[48:63]
  s_waitcnt lgkmcnt(4)
  ds_read_b64_tr_b16 v[92:93], v8 offset:12288
  ds_read_b64_tr_b16 v[94:95], v8 offset:13312
  ds_read_b64_tr_b16 v[80:81], v7 offset:9216
  ds_read_b64_tr_b16 v[82:83], v7 offset:9984
  ds_read_b64_tr_b16 v[84:85], v7 offset:9280
  ds_read_b64_tr_b16 v[86:87], v7 offset:10048
  ds_read_b64_tr_b16 v[88:89], v7 offset:9344
  ds_read_b64_tr_b16 v[90:91], v7 offset:10112
  v_mfma_f32_32x32x16_bf16 v[16:31], v[64:67], v[76:79], v[16:31]
  s_waitcnt lgkmcnt(10)
  v_mfma_f32_32x32x16_bf16 v[32:47], v[68:71], v[76:79], v[32:47]
  s_waitcnt lgkmcnt(8)
  v_mfma_f32_32x32x16_bf16 v[48:63], v[72:75], v[76:79], v[48:63]
  s_waitcnt lgkmcnt(4)
  v_mfma_f32_32x32x16_bf16 v[16:31], v[80:83], v[92:95], v[16:31]
  s_waitcnt lgkmcnt(2)
  v_mfma_f32_32x32x16_bf16 v[32:47], v[84:87], v[92:95], v[32:47]
  s_waitcnt lgkmcnt(0)
  v_mfma_f32_32x32x16_bf16 v[48:63], v[88:91], v[92:95], v[48:63]
  s_add_u32 s33, s41, 6
  s_cmp_lt_u32 s33, 36
  s_cbranch_scc0 G5L_8_t3
  s_waitcnt vmcnt(14)
  s_barrier
  s_add_u32 m0, s43, 57344
  s_nop 0
  buffer_load_dwordx4 v1, s[8:11], s39 offen sc1 lds
  s_add_u32 m0, s43, 58368
  s_nop 0
  buffer_load_dwordx4 v2, s[8:11], s39 offen sc1 lds
  s_add_u32 m0, s43, 59392
  s_nop 0
  buffer_load_dwordx4 v3, s[8:11], s39 offen sc1 lds
  s_add_u32 m0, s44, 57344
  s_nop 0
  buffer_load_dwordx4 v4, s[12:15], s40 offen lds
  s_add_u32 m0, s44, 58368
  s_add_u32 s32, s40, 16384
  buffer_load_dwordx4 v4, s[12:15], s32 offen lds
  s_add_u32 m0, s44, 59392
  s_add_u32 s32, s40, 32768
  buffer_load_dwordx4 v4, s[12:15], s32 offen lds
  s_add_u32 m0, s44, 60416
  s_add_u32 s32, s40, 49152
  buffer_load_dwordx4 v4, s[12:15], s32 offen lds
  s_add_u32 s39, s39, 73728
  s_add_u32 s40, s40, 262144
  s_branch G5L_8_c3
G5L_8_t3:
  s_waitcnt vmcnt(0)
  s_barrier
G5L_8_c3:
  v_add_u32 v7, 86016, v5
  v_add_u32 v8, 86016, v6
  ds_read_b64_tr_b16 v[76:77], v8 offset:0
  ds_read_b64_tr_b16 v[78:79], v8 offset:1024
  ds_read_b64_tr_b16 v[64:65], v7 offset:0
  ds_read_b64_tr_b16 v[66:67], v7 offset:768
  ds_read_b64_tr_b16 v[68:69], v7 offset:64
  ds_read_b64_tr_b16 v[70:71], v7 offset:832
  ds_read_b64_tr_b16 v[72:73], v7 offset:128
  ds_read_b64_tr_b16 v[74:75], v7 offset:896
  s_waitcnt lgkmcnt(4)
  ds_read_b64_tr_b16 v[92:93], v8 offset:4096
  ds_read_b64_tr_b16 v[94:95], v8 offset:5120
  ds_read_b64_tr_b16 v[80:81], v7 offset:3072
  ds_read_b64_tr_b16 v[82:83], v7 offset:3840
  ds_read_b64_tr_b16 v[84:85], v7 offset:3136
  ds_read_b64_tr_b16 v[86:87], v7 offset:3904
  ds_read_b64_tr_b16 v[88:89], v7 offset:3200
  ds_read_b64_tr_b16 v[90:91], v7 offset:3968
  v_mfma_f32_32x32x16_bf16 v[16:31], v[64:67], v[76:79], v[16:31]
  s_waitcnt lgkmcnt(10)
  v_mfma_f32_32x32x16_bf16 v[32:47], v[68:71], v[76:79], v[32:47]
  s_waitcnt lgkmcnt(8)
  v_mfma_f32_32x32x16_bf16 v[48:63], v[72:75], v[76:79], v[48:63]
  s_waitcnt lgkmcnt(4)
  ds_read_b64_tr_b16 v[76:77], v8 offset:8192
  ds_read_b64_tr_b16 v[78:79], v8 offset:9216
  ds_read_b64_tr_b16 v[64:65], v7 offset:6144
  ds_read_b64_tr_b16 v[66:67], v7 offset:6912
  ds_read_b64_tr_b16 v[68:69], v7 offset:6208
  ds_read_b64_tr_b16 v[70:71], v7 offset:6976
  ds_read_b64_tr_b16 v[72:73], v7 offset:6272
  ds_read_b64_tr_b16 v[74:75], v7 offset:7040
  v_mfma_f32_32x32x16_bf16 v[16:31], v[80:83], v[92:95], v[16:31]
  s_waitcnt lgkmcnt(10)
  v_mfma_f32_32x32x16_bf16 v[32:47], v[84:87], v[92:95], v[32:47]
  s_waitcnt lgkmcnt(8)
  v_mfma_f32_32x32x16_bf16 v[48:63], v[88:91], v[92:95], v[48:63]
  s_waitcnt lgkmcnt(4)
  ds_read_b64_tr_b16 v[92:93], v8 offset:12288
  ds_read_b64_tr_b16 v[94:95], v8 offset:13312
  ds_read_b64_tr_b16 v[80:81], v7 offset:9216
  ds_read_b64_tr_b16 v[82:83], v7 offset:9984
  ds_read_b64_tr_b16 v[84:85], v7 offset:9280
  ds_read_b64_tr_b16 v[86:87], v7 offset:10048
  ds_read_b64_tr_b16 v[88:89], v7 offset:9344
  ds_read_b64_tr_b16 v[90:91], v7 offset:10112
  v_mfma_f32_32x32x16_bf16 v[16:31], v[64:67], v[76:79], v[16:31]
  s_waitcnt lgkmcnt(10)
  v_mfma_f32_32x32x16_bf16 v[32:47], v[68:71], v[76:79], v[32:47]
  s_waitcnt lgkmcnt(8)
  v_mfma_f32_32x32x16_bf16 v[48:63], v[72:75], v[76:79], v[48:63]
  s_waitcnt lgkmcnt(4)
  v_mfma_f32_32x32x16_bf16 v[16:31], v[80:83], v[92:95], v[16:31]
  s_waitcnt lgkmcnt(2)
  v_mfma_f32_32x32x16_bf16 v[32:47], v[84:87], v[92:95], v[32:47]
  s_waitcnt lgkmcnt(0)
  v_mfma_f32_32x32x16_bf16 v[48:63], v[88:91], v[92:95], v[48:63]
  s_add_u32 s41, s41, 4
  s_cmp_lt_u32 s41, 36
  s_cbranch_scc1 G5L_8
  v_and_b32 v10, 31, v0
  s_lshl_b32 s32, s94, 5
  s_add_u32 s32, s32, s37
  v_add_u32 v10, s32, v10
  v_mul_u32_u24 v13, 2304, v10
  v_lshrrev_b32 v14, 5, v0
  v_lshl_add_u32 v13, v14, 4, v13
  s_mul_i32 s32, s42, 4718592
  s_lshl_b32 s33, s36, 2
  s_add_u32 s32, s32, s33
  buffer_store_dwordx4 v[16:19], v13, s[16:19], s32 offen offset:0 sc1
  buffer_store_dwordx4 v[20:23], v13, s[16:19], s32 offen offset:32 sc1
  buffer_store_dwordx4 v[24:27], v13, s[16:19], s32 offen offset:64 sc1
  buffer_store_dwordx4 v[28:31], v13, s[16:19], s32 offen offset:96 sc1
  buffer_store_dwordx4 v[32:35], v13, s[16:19], s32 offen offset:128 sc1
  buffer_store_dwordx4 v[36:39], v13, s[16:19], s32 offen offset:160 sc1
  buffer_store_dwordx4 v[40:43], v13, s[16:19], s32 offen offset:192 sc1
  buffer_store_dwordx4 v[44:47], v13, s[16:19], s32 offen offset:224 sc1
  buffer_store_dwordx4 v[48:51], v13, s[16:19], s32 offen offset:256 sc1
  buffer_store_dwordx4 v[52:55], v13, s[16:19], s32 offen offset:288 sc1
  buffer_store_dwordx4 v[56:59], v13, s[16:19], s32 offen offset:320 sc1
  buffer_store_dwordx4 v[60:63], v13, s[16:19], s32 offen offset:352 sc1
G5_DONE:
  s_waitcnt vmcnt(0)
  s_barrier
  s_cmp_eq_u32 s94, 0
  s_cbranch_scc0 G5_ANN
  s_mov_b64 exec, 1
  v_mov_b32 v10, 1
  v_mov_b32 v11, 20
  buffer_atomic_add v10, v11, s[28:31], 0 offen
  s_mov_b64 exec, -1
G5_ANN:
  s_mov_b32 s8, s74
  s_mov_b32 s9, s75
  s_mov_b32 s10, 0x480000
  s_mov_b32 s11, 0x00020000
  s_mul_hi_u32 s36, s95, 306783379
  s_mul_i32 s37, s36, 14
  s_sub_u32 s37, s95, s37
  s_lshr_b32 s40, s94, 1
  s_and_b32 s41, s94, 1
  v_lshlrev_b32 v1, 4, v0
  v_lshrrev_b32 v10, 3, v0
  v_mul_u32_u24 v11, 1152, v10
  v_and_b32 v10, 7, v0
  s_lshl_b32 s32, s94, 1
  s_and_b32 s32, s32, 3
  s_lshl_b32 s32, s32, 1
  v_xor_b32 v12, s32, v10
  v_lshl_add_u32 v6, v12, 4, v11
  s_lshl_b32 s32, s94, 1
  s_add_u32 s32, s32, 1
  s_and_b32 s32, s32, 3
  s_lshl_b32 s32, s32, 1
  v_xor_b32 v12, s32, v10
  v_lshl_add_u32 v7, v12, 4, v11
  v_lshrrev_b32 v10, 4, v0
  v_bfe_u32 v11, v0, 2, 2
  v_lshl_or_b32 v10, v10, 2, v11
  v_lshlrev_b32 v10, 7, v10
  v_and_b32 v11, 3, v0
  v_lshl_add_u32 v10, v11, 3, v10
  s_xor_b32 s32, s94, 0
  s_lshl_b32 s32, s32, 5
  v_add_u32 v2, s32, v10
  s_xor_b32 s32, s94, 1
  s_lshl_b32 s32, s32, 5
  v_add_u32 v3, s32, v10
  s_xor_b32 s32, s94, 2
  s_lshl_b32 s32, s32, 5
  v_add_u32 v4, s32, v10
  s_xor_b32 s32, s94, 3
  s_lshl_b32 s32, s32, 5
  v_add_u32 v5, s32, v10
  s_lshl_b32 s33, s36, 8
  s_lshl_b32 s32, s94, 5
  s_add_u32 s33, s33, s32
  s_mul_i32 s33, s33, 1152
  s_lshl_b32 s34, s94, 12
  s_add_u32 s34, s34, 16384
  s_barrier
  s_add_u32 m0, s34, 0
  s_add_u32 s32, s33, 0
  buffer_load_dwordx4 v6, s[8:11], s32 offen lds
  s_add_u32 m0, s34, 1024
  s_add_u32 s32, s33, 9216
  buffer_load_dwordx4 v6, s[8:11], s32 offen lds
  s_add_u32 m0, s34, 2048
  s_add_u32 s32, s33, 18432
  buffer_load_dwordx4 v7, s[8:11], s32 offen lds
  s_add_u32 m0, s34, 3072
  s_add_u32 s32, s33, 27648
  buffer_load_dwordx4 v7, s[8:11], s32 offen lds
  s_add_u32 m0, s34, 16384
  s_add_u32 s32, s33, 128
  buffer_load_dwordx4 v6, s[8:11], s32 offen lds
  s_add_u32 m0, s34, 17408
  s_add_u32 s32, s33, 9344
  buffer_load_dwordx4 v6, s[8:11], s32 offen lds
  s_add_u32 m0, s34, 18432
  s_add_u32 s32, s33, 18560
  buffer_load_dwordx4 v7, s[8:11], s32 offen lds
  s_add_u32 m0, s34, 19456
  s_add_u32 s32, s33, 27776
  buffer_load_dwordx4 v7, s[8:11], s32 offen lds
  s_add_u32 m0, s34, 32768
  s_add_u32 s32, s33, 256
  buffer_load_dwordx4 v6, s[8:11], s32 offen lds
  s_add_u32 m0, s34, 33792
  s_add_u32 s32, s33, 9472
  buffer_load_dwordx4 v6, s[8:11], s32 offen lds
  s_add_u32 m0, s34, 34816
  s_add_u32 s32, s33, 18688
  buffer_load_dwordx4 v7, s[8:11], s32 offen lds
  s_add_u32 m0, s34, 35840
  s_add_u32 s32, s33, 27904
  buffer_load_dwordx4 v7, s[8:11], s32 offen lds
  s_add_u32 m0, s34, 49152
  s_add_u32 s32, s33, 384
  buffer_load_dwordx4 v6, s[8:11], s32 offen lds
  s_add_u32 m0, s34, 50176
  s_add_u32 s32, s33, 9600
  buffer_load_dwordx4 v6, s[8:11], s32 offen lds
  s_add_u32 m0, s34, 51200
  s_add_u32 s32, s33, 18816
  buffer_load_dwordx4 v7, s[8:11], s32 offen lds
  s_add_u32 m0, s34, 52224
  s_add_u32 s32, s33, 28032
  buffer_load_dwordx4 v7, s[8:11], s32 offen lds
  s_add_u32 m0, s34, 65536
  s_add_u32 s32, s33, 512
  buffer_load_dwordx4 v6, s[8:11], s32 offen lds
  s_add_u32 m0, s34, 66560
  s_add_u32 s32, s33, 9728
  buffer_load_dwordx4 v6, s[8:11], s32 offen lds
  s_add_u32 m0, s34, 67584
  s_add_u32 s32, s33, 18944
  buffer_load_dwordx4 v7, s[8:11], s32 offen lds
  s_add_u32 m0, s34, 68608
  s_add_u32 s32, s33, 28160
  buffer_load_dwordx4 v7, s[8:11], s32 offen lds
  s_add_u32 m0, s34, 81920
  s_add_u32 s32, s33, 640
  buffer_load_dwordx4 v6, s[8:11], s32 offen lds
  s_add_u32 m0, s34, 82944
  s_add_u32 s32, s33, 9856
  buffer_load_dwordx4 v6, s[8:11], s32 offen lds
  s_add_u32 m0, s34, 83968
  s_add_u32 s32, s33, 19072
  buffer_load_dwordx4 v7, s[8:11], s32 offen lds
  s_add_u32 m0, s34, 84992
  s_add_u32 s32, s33, 28288
  buffer_load_dwordx4 v7, s[8:11], s32 offen lds
  s_add_u32 m0, s34, 98304
  s_add_u32 s32, s33, 768
  buffer_load_dwordx4 v6, s[8:11], s32 offen lds
  s_add_u32 m0, s34, 99328
  s_add_u32 s32, s33, 9984
  buffer_load_dwordx4 v6, s[8:11], s32 offen lds
  s_add_u32 m0, s34, 100352
  s_add_u32 s32, s33, 19200
  buffer_load_dwordx4 v7, s[8:11], s32 offen lds
  s_add_u32 m0, s34, 101376
  s_add_u32 s32, s33, 28416
  buffer_load_dwordx4 v7, s[8:11], s32 offen lds
  s_add_u32 m0, s34, 114688
  s_add_u32 s32, s33, 896
  buffer_load_dwordx4 v6, s[8:11], s32 offen lds
  s_add_u32 m0, s34, 115712
  s_add_u32 s32, s33, 10112
  buffer_load_dwordx4 v6, s[8:11], s32 offen lds
  s_add_u32 m0, s34, 116736
  s_add_u32 s32, s33, 19328
  buffer_load_dwordx4 v7, s[8:11], s32 offen lds
  s_add_u32 m0, s34, 117760
  s_add_u32 s32, s33, 28544
  buffer_load_dwordx4 v7, s[8:11], s32 offen lds
  s_waitcnt vmcnt(28)
  s_barrier
  v_add_u32 v8, 16384, v2
  v_add_u32 v9, 16384, v3
  v_add_u32 v10, 16384, v4
  v_add_u32 v11, 16384, v5
  ds_read_b64_tr_b16 a[0:1], v8 offset:0
  ds_read_b64_tr_b16 a[2:3], v9 offset:2048
  ds_read_b64_tr_b16 a[4:5], v10 offset:4096
  ds_read_b64_tr_b16 a[6:7], v11 offset:6144
  ds_read_b64_tr_b16 a[8:9], v8 offset:8192
  ds_read_b64_tr_b16 a[10:11], v9 offset:10240
  ds_read_b64_tr_b16 a[12:13], v10 offset:12288
  ds_read_b64_tr_b16 a[14:15], v11 offset:14336
  s_waitcnt lgkmcnt(0)
  s_waitcnt vmcnt(24)
  s_barrier
  s_add_u32 m0, s34, 0
  s_add_u32 s32, s33, 1024
  buffer_load_dwordx4 v6, s[8:11], s32 offen lds
  s_add_u32 m0, s34, 1024
  s_add_u32 s32, s33, 10240
  buffer_load_dwordx4 v6, s[8:11], s32 offen lds
  s_add_u32 m0, s34, 2048
  s_add_u32 s32, s33, 19456
  buffer_load_dwordx4 v7, s[8:11], s32 offen lds
  s_add_u32 m0, s34, 3072
  s_add_u32 s32, s33, 28672
  buffer_load_dwordx4 v7, s[8:11], s32 offen lds
  v_add_u32 v8, 32768, v2
  v_add_u32 v9, 32768, v3
  v_add_u32 v10, 32768, v4
  v_add_u32 v11, 32768, v5
  ds_read_b64_tr_b16 a[32:33], v8 offset:0
  ds_read_b64_tr_b16 a[34:35], v9 offset:2048
  ds_read_b64_tr_b16 a[36:37], v10 offset:4096
  ds_read_b64_tr_b16 a[38:39], v11 offset:6144
  ds_read_b64_tr_b16 a[40:41], v8 offset:8192
  ds_read_b64_tr_b16 a[42:43], v9 offset:10240
  ds_read_b64_tr_b16 a[44:45], v10 offset:12288
  ds_read_b64_tr_b16 a[46:47], v11 offset:14336
  s_waitcnt lgkmcnt(0)
  s_waitcnt vmcnt(24)
  s_barrier
  s_add_u32 m0, s34, 16384
  s_add_u32 s32, s33, 147456
  buffer_load_dwordx4 v6, s[8:11], s32 offen lds
  s_add_u32 m0, s34, 17408
  s_add_u32 s32, s33, 156672
  buffer_load_dwordx4 v6, s[8:11], s32 offen lds
  s_add_u32 m0, s34, 18432
  s_add_u32 s32, s33, 165888
  buffer_load_dwordx4 v7, s[8:11], s32 offen lds
  s_add_u32 m0, s34, 19456
  s_add_u32 s32, s33, 175104
  buffer_load_dwordx4 v7, s[8:11], s32 offen lds
  v_add_u32 v8, 49152, v2
  v_add_u32 v9, 49152, v3
  v_add_u32 v10, 49152, v4
  v_add_u32 v11, 49152, v5
  ds_read_b64_tr_b16 a[64:65], v8 offset:0
  ds_read_b64_tr_b16 a[66:67], v9 offset:2048
  ds_read_b64_tr_b16 a[68:69], v10 offset:4096
  ds_read_b64_tr_b16 a[70:71], v11 offset:6144
  ds_read_b64_tr_b16 a[72:73], v8 offset:8192
  ds_read_b64_tr_b16 a[74:75], v9 offset:10240
  ds_read_b64_tr_b16 a[76:77], v10 offset:12288
  ds_read_b64_tr_b16 a[78:79], v11 offset:14336
  s_waitcnt lgkmcnt(0)
  s_waitcnt vmcnt(24)
  s_barrier
  s_add_u32 m0, s34, 32768
  s_add_u32 s32, s33, 147584
  buffer_load_dwordx4 v6, s[8:11], s32 offen lds
  s_add_u32 m0, s34, 33792
  s_add_u32 s32, s33, 156800
  buffer_load_dwordx4 v6, s[8:11], s32 offen lds
  s_add_u32 m0, s34, 34816
  s_add_u32 s32, s33, 166016
  buffer_load_dwordx4 v7, s[8:11], s32 offen lds
  s_add_u32 m0, s34, 35840
  s_add_u32 s32, s33, 175232
  buffer_load_dwordx4 v7, s[8:11], s32 offen lds
  v_add_u32 v8, 65536, v2
  v_add_u32 v9, 65536, v3
  v_add_u32 v10, 65536, v4
  v_add_u32 v11, 65536, v5
  ds_read_b64_tr_b16 a[96:97], v8 offset:0
  ds_read_b64_tr_b16 a[98:99], v9 offset:2048
  ds_read_b64_tr_b16 a[100:101], v10 offset:4096
  ds_read_b64_tr_b16 a[102:103], v11 offset:6144
  ds_read_b64_tr_b16 a[104:105], v8 offset:8192
  ds_read_b64_tr_b16 a[106:107], v9 offset:10240
  ds_read_b64_tr_b16 a[108:109], v10 offset:12288
  ds_read_b64_tr_b16 a[110:111], v11 offset:14336
  s_waitcnt lgkmcnt(0)
  s_waitcnt vmcnt(24)
  s_barrier
  s_add_u32 m0, s34, 49152
  s_add_u32 s32, s33, 147712
  buffer_load_dwordx4 v6, s[8:11], s32 offen lds
  s_add_u32 m0, s34, 50176
  s_add_u32 s32, s33, 156928
  buffer_load_dwordx4 v6, s[8:11], s32 offen lds
  s_add_u32 m0, s34, 51200
  s_add_u32 s32, s33, 166144
  buffer_load_dwordx4 v7, s[8:11], s32 offen lds
  s_add_u32 m0, s34, 52224
  s_add_u32 s32, s33, 175360
  buffer_load_dwordx4 v7, s[8:11], s32 offen lds
  v_add_u32 v8, 81920, v2
  v_add_u32 v9, 81920, v3
  v_add_u32 v10, 81920, v4
  v_add_u32 v11, 81920, v5
  ds_read_b64_tr_b16 a[128:129], v8 offset:0
  ds_read_b64_tr_b16 a[130:131], v9 offset:2048
  ds_read_b64_tr_b16 a[132:133], v10 offset:4096
  ds_read_b64_tr_b16 a[134:135], v11 offset:6144
  ds_read_b64_tr_b16 a[136:137], v8 offset:8192
  ds_read_b64_tr_b16 a[138:139], v9 offset:10240
  ds_read_b64_tr_b16 a[140:141], v10 offset:12288
  ds_read_b64_tr_b16 a[142:143], v11 offset:14336
  s_waitcnt lgkmcnt(0)
  s_waitcnt vmcnt(24)
  s_barrier
  s_add_u32 m0, s34, 65536
  s_add_u32 s32, s33, 147840
  buffer_load_dwordx4 v6, s[8:11], s32 offen lds
  s_add_u32 m0, s34, 66560
  s_add_u32 s32, s33, 157056
  buffer_load_dwordx4 v6, s[8:11], s32 offen lds
  s_add_u32 m0, s34, 67584
  s_add_u32 s32, s33, 166272
  buffer_load_dwordx4 v7, s[8:11], s32 offen lds
  s_add_u32 m0, s34, 68608
  s_add_u32 s32, s33, 175488
  buffer_load_dwordx4 v7, s[8:11], s32 offen lds
  v_add_u32 v8, 98304, v2
  v_add_u32 v9, 98304, v3
  v_add_u32 v10, 98304, v4
  v_add_u32 v11, 98304, v5
  ds_read_b64_tr_b16 a[160:161], v8 offset:0
  ds_read_b64_tr_b16 a[162:163], v9 offset:2048
  ds_read_b64_tr_b16 a[164:165], v10 offset:4096
  ds_read_b64_tr_b16 a[166:167], v11 offset:6144
  ds_read_b64_tr_b16 a[168:169], v8 offset:8192
  ds_read_b64_tr_b16 a[170:171], v9 offset:10240
  ds_read_b64_tr_b16 a[172:173], v10 offset:12288
  ds_read_b64_tr_b16 a[174:175], v11 offset:14336
  s_waitcnt lgkmcnt(0)
  s_waitcnt vmcnt(24)
  s_barrier
  s_add_u32 m0, s34, 81920
  s_add_u32 s32, s33, 147968
  buffer_load_dwordx4 v6, s[8:11], s32 offen lds
  s_add_u32 m0, s34, 82944
  s_add_u32 s32, s33, 157184
  buffer_load_dwordx4 v6, s[8:11], s32 offen lds
  s_add_u32 m0, s34, 83968
  s_add_u32 s32, s33, 166400
  buffer_load_dwordx4 v7, s[8:11], s32 offen lds
  s_add_u32 m0, s34, 84992
  s_add_u32 s32, s33, 175616
  buffer_load_dwordx4 v7, s[8:11], s32 offen lds
  v_add_u32 v8, 114688, v2
  v_add_u32 v9, 114688, v3
  v_add_u32 v10, 114688, v4
  v_add_u32 v11, 114688, v5
  ds_read_b64_tr_b16 a[192:193], v8 offset:0
  ds_read_b64_tr_b16 a[194:195], v9 offset:2048
  ds_read_b64_tr_b16 a[196:197], v10 offset:4096
  ds_read_b64_tr_b16 a[198:199], v11 offset:6144
  ds_read_b64_tr_b16 a[200:201], v8 offset:8192
  ds_read_b64_tr_b16 a[202:203], v9 offset:10240
  ds_read_b64_tr_b16 a[204:205], v10 offset:12288
  ds_read_b64_tr_b16 a[206:207], v11 offset:14336
  s_waitcnt lgkmcnt(0)
  s_waitcnt vmcnt(24)
  s_barrier
  s_add_u32 m0, s34, 98304
  s_add_u32 s32, s33, 148096
  buffer_load_dwordx4 v6, s[8:11], s32 offen lds
  s_add_u32 m0, s34, 99328
  s_add_u32 s32, s33, 157312
  buffer_load_dwordx4 v6, s[8:11], s32 offen lds
  s_add_u32 m0, s34, 100352
  s_add_u32 s32, s33, 166528
  buffer_load_dwordx4 v7, s[8:11], s32 offen lds
  s_add_u32 m0, s34, 101376
  s_add_u32 s32, s33, 175744
  buffer_load_dwordx4 v7, s[8:11], s32 offen lds
  v_add_u32 v8, 131072, v2
  v_add_u32 v9, 131072, v3
  v_add_u32 v10, 131072, v4
  v_add_u32 v11, 131072, v5
  ds_read_b64_tr_b16 a[224:225], v8 offset:0
  ds_read_b64_tr_b16 a[226:227], v9 offset:2048
  ds_read_b64_tr_b16 a[228:229], v10 offset:4096
  ds_read_b64_tr_b16 a[230:231], v11 offset:6144
  ds_read_b64_tr_b16 a[232:233], v8 offset:8192
  ds_read_b64_tr_b16 a[234:235], v9 offset:10240
  ds_read_b64_tr_b16 a[236:237], v10 offset:12288
  ds_read_b64_tr_b16 a[238:239], v11 offset:14336
  s_waitcnt lgkmcnt(0)
  s_waitcnt vmcnt(24)
  s_barrier
  s_add_u32 m0, s34, 114688
  s_add_u32 s32, s33, 148224
  buffer_load_dwordx4 v6, s[8:11], s32 offen lds
  s_add_u32 m0, s34, 115712
  s_add_u32 s32, s33, 157440
  buffer_load_dwordx4 v6, s[8:11], s32 offen lds
  s_add_u32 m0, s34, 116736
  s_add_u32 s32, s33, 166656
  buffer_load_dwordx4 v7, s[8:11], s32 offen lds
  s_add_u32 m0, s34, 117760
  s_add_u32 s32, s33, 175872
  buffer_load_dwordx4 v7, s[8:11], s32 offen lds
  v_add_u32 v8, 16384, v2
  v_add_u32 v9, 16384, v3
  v_add_u32 v10, 16384, v4
  v_add_u32 v11, 16384, v5
  ds_read_b64_tr_b16 v[224:225], v8 offset:0
  ds_read_b64_tr_b16 v[226:227], v9 offset:2048
  ds_read_b64_tr_b16 v[228:229], v10 offset:4096
  ds_read_b64_tr_b16 v[230:231], v11 offset:6144
  ds_read_b64_tr_b16 v[232:233], v8 offset:8192
  ds_read_b64_tr_b16 v[234:235], v9 offset:10240
  ds_read_b64_tr_b16 v[236:237], v10 offset:12288
  ds_read_b64_tr_b16 v[238:239], v11 offset:14336
  s_waitcnt lgkmcnt(0)
  s_waitcnt vmcnt(24)
  s_barrier
  s_add_u32 m0, s34, 0
  s_add_u32 s32, s33, 148352
  buffer_load_dwordx4 v6, s[8:11], s32 offen lds
  s_add_u32 m0, s34, 1024
  s_add_u32 s32, s33, 157568
  buffer_load_dwordx4 v6, s[8:11], s32 offen lds
  s_add_u32 m0, s34, 2048
  s_add_u32 s32, s33, 166784
  buffer_load_dwordx4 v7, s[8:11], s32 offen lds
  s_add_u32 m0, s34, 3072
  s_add_u32 s32, s33, 176000
  buffer_load_dwordx4 v7, s[8:11], s32 offen lds
  v_add_u32 v8, 32768, v2
  v_add_u32 v9, 32768, v3
  v_add_u32 v10, 32768, v4
  v_add_u32 v11, 32768, v5
  ds_read_b64_tr_b16 a[16:17], v8 offset:0
  ds_read_b64_tr_b16 a[18:19], v9 offset:2048
  ds_read_b64_tr_b16 a[20:21], v10 offset:4096
  ds_read_b64_tr_b16 a[22:23], v11 offset:6144
  ds_read_b64_tr_b16 a[24:25], v8 offset:8192
  ds_read_b64_tr_b16 a[26:27], v9 offset:10240
  ds_read_b64_tr_b16 a[28:29], v10 offset:12288
  ds_read_b64_tr_b16 a[30:31], v11 offset:14336
  s_waitcnt lgkmcnt(0)
  s_waitcnt vmcnt(24)
  s_barrier
  s_add_u32 m0, s34, 16384
  s_add_u32 s32, s33, 148480
  buffer_load_dwordx4 v6, s[8:11], s32 offen lds
  s_add_u32 m0, s34, 17408
  s_add_u32 s32, s33, 157696
  buffer_load_dwordx4 v6, s[8:11], s32 offen lds
  s_add_u32 m0, s34, 18432
  s_add_u32 s32, s33, 166912
  buffer_load_dwordx4 v7, s[8:11], s32 offen lds
  s_add_u32 m0, s34, 19456
  s_add_u32 s32, s33, 176128
  buffer_load_dwordx4 v7, s[8:11], s32 offen lds
  v_add_u32 v8, 49152, v2
  v_add_u32 v9, 49152, v3
  v_add_u32 v10, 49152, v4
  v_add_u32 v11, 49152, v5
  ds_read_b64_tr_b16 a[48:49], v8 offset:0
  ds_read_b64_tr_b16 a[50:51], v9 offset:2048
  ds_read_b64_tr_b16 a[52:53], v10 offset:4096
  ds_read_b64_tr_b16 a[54:55], v11 offset:6144
  ds_read_b64_tr_b16 a[56:57], v8 offset:8192
  ds_read_b64_tr_b16 a[58:59], v9 offset:10240
  ds_read_b64_tr_b16 a[60:61], v10 offset:12288
  ds_read_b64_tr_b16 a[62:63], v11 offset:14336
  s_waitcnt lgkmcnt(0)
  s_waitcnt vmcnt(24)
  s_barrier
  v_add_u32 v8, 65536, v2
  v_add_u32 v9, 65536, v3
  v_add_u32 v10, 65536, v4
  v_add_u32 v11, 65536, v5
  ds_read_b64_tr_b16 a[80:81], v8 offset:0
  ds_read_b64_tr_b16 a[82:83], v9 offset:2048
  ds_read_b64_tr_b16 a[84:85], v10 offset:4096
  ds_read_b64_tr_b16 a[86:87], v11 offset:6144
  ds_read_b64_tr_b16 a[88:89], v8 offset:8192
  ds_read_b64_tr_b16 a[90:91], v9 offset:10240
  ds_read_b64_tr_b16 a[92:93], v10 offset:12288
  ds_read_b64_tr_b16 a[94:95], v11 offset:14336
  s_waitcnt lgkmcnt(0)
  s_waitcnt vmcnt(20)
  s_barrier
  v_add_u32 v8, 81920, v2
  v_add_u32 v9, 81920, v3
  v_add_u32 v10, 81920, v4
  v_add_u32 v11, 81920, v5
  ds_read_b64_tr_b16 a[112:113], v8 offset:0
  ds_read_b64_tr_b16 a[114:115], v9 offset:2048
  ds_read_b64_tr_b16 a[116:117], v10 offset:4096
  ds_read_b64_tr_b16 a[118:119], v11 offset:6144
  ds_read_b64_tr_b16 a[120:121], v8 offset:8192
  ds_read_b64_tr_b16 a[122:123], v9 offset:10240
  ds_read_b64_tr_b16 a[124:125], v10 offset:12288
  ds_read_b64_tr_b16 a[126:127], v11 offset:14336
  s_waitcnt lgkmcnt(0)
  s_waitcnt vmcnt(16)
  s_barrier
  v_add_u32 v8, 98304, v2
  v_add_u32 v9, 98304, v3
  v_add_u32 v10, 98304, v4
  v_add_u32 v11, 98304, v5
  ds_read_b64_tr_b16 a[144:145], v8 offset:0
  ds_read_b64_tr_b16 a[146:147], v9 offset:2048
  ds_read_b64_tr_b16 a[148:149], v10 offset:4096
  ds_read_b64_tr_b16 a[150:151], v11 offset:6144
  ds_read_b64_tr_b16 a[152:153], v8 offset:8192
  ds_read_b64_tr_b16 a[154:155], v9 offset:10240
  ds_read_b64_tr_b16 a[156:157], v10 offset:12288
  ds_read_b64_tr_b16 a[158:159], v11 offset:14336
  s_waitcnt lgkmcnt(0)
  s_waitcnt vmcnt(12)
  s_barrier
  v_add_u32 v8, 114688, v2
  v_add_u32 v9, 114688, v3
  v_add_u32 v10, 114688, v4
  v_add_u32 v11, 114688, v5
  ds_read_b64_tr_b16 a[176:177], v8 offset:0
  ds_read_b64_tr_b16 a[178:179], v9 offset:2048
  ds_read_b64_tr_b16 a[180:181], v10 offset:4096
  ds_read_b64_tr_b16 a[182:183], v11 offset:6144
  ds_read_b64_tr_b16 a[184:185], v8 offset:8192
  ds_read_b64_tr_b16 a[186:187], v9 offset:10240
  ds_read_b64_tr_b16 a[188:189], v10 offset:12288
  ds_read_b64_tr_b16 a[190:191], v11 offset:14336
  s_waitcnt lgkmcnt(0)
  s_waitcnt vmcnt(8)
  s_barrier
  v_add_u32 v8, 131072, v2
  v_add_u32 v9, 131072, v3
  v_add_u32 v10, 131072, v4
  v_add_u32 v11, 131072, v5
  ds_read_b64_tr_b16 a[208:209], v8 offset:0
  ds_read_b64_tr_b16 a[210:211], v9 offset:2048
  ds_read_b64_tr_b16 a[212:213], v10 offset:4096
  ds_read_b64_tr_b16 a[214:215], v11 offset:6144
  ds_read_b64_tr_b16 a[216:217], v8 offset:8192
  ds_read_b64_tr_b16 a[218:219], v9 offset:10240
  ds_read_b64_tr_b16 a[220:221], v10 offset:12288
  ds_read_b64_tr_b16 a[222:223], v11 offset:14336
  s_waitcnt lgkmcnt(0)
  s_waitcnt vmcnt(4)
  s_barrier
  v_add_u32 v8, 16384, v2
  v_add_u32 v9, 16384, v3
  v_add_u32 v10, 16384, v4
  v_add_u32 v11, 16384, v5
  ds_read_b64_tr_b16 a[240:241], v8 offset:0
  ds_read_b64_tr_b16 a[242:243], v9 offset:2048
  ds_read_b64_tr_b16 a[244:245], v10 offset:4096
  ds_read_b64_tr_b16 a[246:247], v11 offset:6144
  ds_read_b64_tr_b16 a[248:249], v8 offset:8192
  ds_read_b64_tr_b16 a[250:251], v9 offset:10240
  ds_read_b64_tr_b16 a[252:253], v10 offset:12288
  ds_read_b64_tr_b16 a[254:255], v11 offset:14336
  s_waitcnt lgkmcnt(0)
  s_waitcnt vmcnt(0)
  s_barrier
  v_add_u32 v8, 32768, v2
  v_add_u32 v9, 32768, v3
  v_add_u32 v10, 32768, v4
  v_add_u32 v11, 32768, v5
  ds_read_b64_tr_b16 v[240:241], v8 offset:0
  ds_read_b64_tr_b16 v[242:243], v9 offset:2048
  ds_read_b64_tr_b16 v[244:245], v10 offset:4096
  ds_read_b64_tr_b16 v[246:247], v11 offset:6144
  ds_read_b64_tr_b16 v[248:249], v8 offset:8192
  ds_read_b64_tr_b16 v[250:251], v9 offset:10240
  ds_read_b64_tr_b16 v[252:253], v10 offset:12288
  ds_read_b64_tr_b16 v[254:255], v11 offset:14336
  s_waitcnt lgkmcnt(0)
  s_barrier
  s_add_u32 s12, s92, 0x800000
  s_addc_u32 s13, s93, 0
  s_mov_b32 s14, 0x3000000
  s_mov_b32 s15, 0x00020000
  s_add_u32 s16, s92, 0x3800000
  s_addc_u32 s17, s93, 0
  s_mov_b32 s18, 0x1000000
  s_mov_b32 s19, 0x00020000
  s_add_u32 s20, s92, 0x6000000
  s_addc_u32 s21, s93, 0
  s_mov_b32 s22, 0x2400000
  s_mov_b32 s23, 0x00020000
  s_add_u32 s24, s92, 0x60000
  s_addc_u32 s25, s93, 0
  s_mov_b32 s26, 0x5600
  s_mov_b32 s27, 0x00020000
  s_mov_b32 s52, s64
  s_mov_b32 s53, s65
  s_mov_b32 s54, 0x240000
  s_mov_b32 s55, 0x00020000
  s_add_u32 s56, s92, 0x5000000
  s_addc_u32 s57, s93, 0
  s_mov_b32 s58, 0x900000
  s_mov_b32 s59, 0x00020000
  s_mov_b32 s60, s88
  s_mov_b32 s61, s89
  s_mov_b32 s62, 0x240000
  s_mov_b32 s63, 0x00020000
  s_mov_b32 s8, s86
  s_mov_b32 s9, s87
  s_mov_b32 s10, 0x1000
  s_mov_b32 s11, 0x00020000
  v_and_b32 v10, 15, v0
  v_lshrrev_b32 v11, 4, v0
  v_lshlrev_b32 v11, 2, v11
  v_add_u32 v12, 0, v11
  v_cmp_le_u32 s[44:45], v12, v10
  v_add_u32 v12, 1, v11
  v_cmp_le_u32 s[46:47], v12, v10
  v_add_u32 v12, 2, v11
  v_cmp_le_u32 s[48:49], v12, v10
  v_add_u32 v12, 3, v11
  v_cmp_le_u32 s[50:51], v12, v10
  s_lshl_b32 s42, s36, 1
  s_add_u32 s42, s42, s40
  s_lshl_b32 s42, s42, 13
  v_mov_b32 v10, 20
  s_mov_b32 s96, 0
G3W_9:
  buffer_load_dword v11, v10, s[28:31], 0 offen sc1
  s_waitcnt vmcnt(0)
  v_readfirstlane_b32 s3, v11
  s_nop 0
  s_cmp_eq_u32 s3, 224
  s_cbranch_scc1 G3W_9_ok
  s_sleep 8
  s_add_u32 s96, s96, 1
  s_cmp_lt_u32 s96, 60000
  s_cbranch_scc1 G3W_9
  s_branch W_FAIL
G3W_9_ok:
  s_mov_b32 s38, s37
  s_mov_b32 s39, -1
  s_lshl_b32 s32, s38, 18
  s_add_u32 s32, s32, s42
  s_add_u32 s33, s32, 0
  buffer_load_dwordx4 v[32:35], v1, s[12:15], s33 offen sc1
  s_add_u32 s33, s33, 16777216
  buffer_load_dwordx4 v[64:67], v1, s[12:15], s33 offen sc1
  s_add_u32 s33, s32, 1024
  buffer_load_dwordx4 v[36:39], v1, s[12:15], s33 offen sc1
  s_add_u32 s33, s33, 16777216
  buffer_load_dwordx4 v[68:71], v1, s[12:15], s33 offen sc1
  s_add_u32 s33, s32, 2048
  buffer_load_dwordx4 v[40:43], v1, s[12:15], s33 offen sc1
  s_add_u32 s33, s33, 16777216
  buffer_load_dwordx4 v[72:75], v1, s[12:15], s33 offen sc1
  s_add_u32 s33, s32, 3072
  buffer_load_dwordx4 v[44:47], v1, s[12:15], s33 offen sc1
  s_add_u32 s33, s33, 16777216
  buffer_load_dwordx4 v[76:79], v1, s[12:15], s33 offen sc1
  s_add_u32 s33, s32, 4096
  buffer_load_dwordx4 v[48:51], v1, s[12:15], s33 offen sc1
  s_add_u32 s33, s33, 16777216
  buffer_load_dwordx4 v[80:83], v1, s[12:15], s33 offen sc1
  s_add_u32 s33, s32, 5120
  buffer_load_dwordx4 v[52:55], v1, s[12:15], s33 offen sc1
  s_add_u32 s33, s33, 16777216
  buffer_load_dwordx4 v[84:87], v1, s[12:15], s33 offen sc1
  s_add_u32 s33, s32, 6144
  buffer_load_dwordx4 v[56:59], v1, s[12:15], s33 offen sc1
  s_add_u32 s33, s33, 16777216
  buffer_load_dwordx4 v[88:91], v1, s[12:15], s33 offen sc1
  s_add_u32 s33, s32, 7168
  buffer_load_dwordx4 v[60:63], v1, s[12:15], s33 offen sc1
  s_add_u32 s33, s33, 16777216
  buffer_load_dwordx4 v[92:95], v1, s[12:15], s33 offen sc1
  s_lshl_b32 s34, s41, 10
  s_add_u32 s32, s32, s34
  s_add_u32 s32, s32, 33554432
  s_add_u32 s33, s32, 0
  buffer_load_dwordx4 v[16:19], v1, s[12:15], s33 offen sc1
  s_add_u32 s33, s32, 2048
  buffer_load_dwordx4 v[20:23], v1, s[12:15], s33 offen sc1
  s_add_u32 s33, s32, 4096
  buffer_load_dwordx4 v[24:27], v1, s[12:15], s33 offen sc1
  s_add_u32 s33, s32, 6144
  buffer_load_dwordx4 v[28:31], v1, s[12:15], s33 offen sc1
G23_10:
  s_cmp_lt_i32 s39, 0
  s_cbranch_scc1 G23_10_nr
  s_cmp_lt_u32 s36, 9
  s_cbranch_scc0 G3R_11_skip
  v_and_b32 v10, 15, v0
  v_lshlrev_b32 v10, 2, v10
  s_lshl_b32 s32, s39, 6
  s_add_u32 s32, s32, 16384
  s_mov_b32 s96, 0
G3R_11:
  buffer_load_dword v11, v10, s[24:27], s32 offen sc1
  s_waitcnt vmcnt(0)
  v_cmp_ne_u32 vcc, 1, v11
  s_nop 0
  s_cbranch_vccz G3R_11_ok
  s_sleep 1
  s_add_u32 s96, s96, 1
  s_cmp_lt_u32 s96, 60000
  s_cbranch_scc1 G3R_11
  s_branch W_FAIL
G3R_11_ok:
  s_lshl_b32 s32, s36, 2
  s_add_u32 s32, s32, s94
  s_mul_i32 s33, s39, 589824
  s_lshl_b32 s34, s32, 10
  s_add_u32 s33, s33, s34
  buffer_load_dwordx4 v[128:131], v1, s[20:23], s33 offen sc1
  s_add_u32 s33, s33, 36864
  buffer_load_dwordx4 v[132:135], v1, s[20:23], s33 offen sc1
  s_add_u32 s33, s33, 36864
  buffer_load_dwordx4 v[136:139], v1, s[20:23], s33 offen sc1
  s_add_u32 s33, s33, 36864
  buffer_load_dwordx4 v[140:143], v1, s[20:23], s33 offen sc1
  s_add_u32 s33, s33, 36864
  buffer_load_dwordx4 v[144:147], v1, s[20:23], s33 offen sc1
  s_add_u32 s33, s33, 36864
  buffer_load_dwordx4 v[148:151], v1, s[20:23], s33 offen sc1
  s_add_u32 s33, s33, 36864
  buffer_load_dwordx4 v[152:155], v1, s[20:23], s33 offen sc1
  s_add_u32 s33, s33, 36864
  buffer_load_dwordx4 v[156:159], v1, s[20:23], s33 offen sc1
  s_add_u32 s33, s33, 36864
  buffer_load_dwordx4 v[160:163], v1, s[20:23], s33 offen sc1
  s_add_u32 s33, s33, 36864
  buffer_load_dwordx4 v[164:167], v1, s[20:23], s33 offen sc1
  s_add_u32 s33, s33, 36864
  buffer_load_dwordx4 v[168:171], v1, s[20:23], s33 offen sc1
  s_add_u32 s33, s33, 36864
  buffer_load_dwordx4 v[172:175], v1, s[20:23], s33 offen sc1
  s_add_u32 s33, s33, 36864
  buffer_load_dwordx4 v[176:179], v1, s[20:23], s33 offen sc1
  s_add_u32 s33, s33, 36864
  buffer_load_dwordx4 v[180:183], v1, s[20:23], s33 offen sc1
  s_add_u32 s33, s33, 36864
  buffer_load_dwordx4 v[184:187], v1, s[20:23], s33 offen sc1
  s_add_u32 s33, s33, 36864
  buffer_load_dwordx4 v[188:191], v1, s[20:23], s33 offen sc1
  s_mul_hi_u32 s33, s32, 477218589
  s_mul_i32 s34, s33, 9
  s_sub_u32 s34, s32, s34
  s_lshl_b32 s34, s34, 2
  s_add_u32 s34, s34, s33
  s_lshl_b32 s34, s34, 4
  v_lshrrev_b32 v10, 4, v0
  v_lshlrev_b32 v10, 2, v10
  v_add_u32 v10, s34, v10
  v_and_b32 v11, 15, v0
  s_lshl_b32 s32, s39, 5
  v_add_u32 v11, s32, v11
  v_mul_u32_u24 v12, 576, v11
  v_add_u32 v12, v12, v10
  v_lshlrev_b32 v13, 1, v12
  v_lshlrev_b32 v14, 2, v12
  v_lshlrev_b32 v15, 1, v11
  s_mov_b32 s32, 18432
  s_mov_b32 s33, 36864
  s_mov_b32 s34, 4718592
  s_add_u32 s35, s34, s33
  buffer_load_dwordx2 v[200:201], v13, s[52:55], 0 offen
  buffer_load_dwordx2 v[202:203], v13, s[52:55], s32 offen
  buffer_load_dwordx4 v[204:207], v14, s[56:59], 0 offen sc1
  buffer_load_dwordx4 v[208:211], v14, s[56:59], s33 offen sc1
  buffer_load_dwordx4 v[212:215], v14, s[56:59], s34 offen sc1
  buffer_load_dwordx4 v[216:219], v14, s[56:59], s35 offen sc1
  buffer_load_ushort v220, v15, s[8:11], 0 offen
  buffer_load_ushort v221, v15, s[8:11], 0 offen offset:32
  s_mov_b32 s33, 0x00003f80
  s_mov_b32 s34, 0x3f800000
  s_waitcnt vmcnt(0)
  v_lshlrev_b32 v220, 16, v220
  v_lshlrev_b32 v221, 16, v221
  v_add_f32 v96, v204, v212
  v_add_f32 v96, v96, v220
  v_add_f32 v97, v205, v213
  v_add_f32 v97, v97, v220
  v_add_f32 v98, v206, v214
  v_add_f32 v98, v98, v220
  v_add_f32 v99, v207, v215
  v_add_f32 v99, v99, v220
  v_dot2_f32_bf16 v96, v200, s33, v96
  v_dot2_f32_bf16 v97, v200, s34, v97
  v_dot2_f32_bf16 v98, v201, s33, v98
  v_dot2_f32_bf16 v99, v201, s34, v99
  v_add_f32 v100, v208, v216
  v_add_f32 v100, v100, v221
  v_add_f32 v101, v209, v217
  v_add_f32 v101, v101, v221
  v_add_f32 v102, v210, v218
  v_add_f32 v102, v102, v221
  v_add_f32 v103, v211, v219
  v_add_f32 v103, v103, v221
  v_dot2_f32_bf16 v100, v202, s33, v100
  v_dot2_f32_bf16 v101, v202, s34, v101
  v_dot2_f32_bf16 v102, v203, s33, v102
  v_dot2_f32_bf16 v103, v203, s34, v103
  v_dot2_f32_bf16 v96, v128, s33, v96
  v_dot2_f32_bf16 v97, v128, s34, v97
  v_dot2_f32_bf16 v98, v129, s33, v98
  v_dot2_f32_bf16 v99, v129, s34, v99
  v_dot2_f32_bf16 v100, v130, s33, v100
  v_dot2_f32_bf16 v101, v130, s34, v101
  v_dot2_f32_bf16 v102, v131, s33, v102
  v_dot2_f32_bf16 v103, v131, s34, v103
  v_dot2_f32_bf16 v96, v132, s33, v96
  v_dot2_f32_bf16 v97, v132, s34, v97
  v_dot2_f32_bf16 v98, v133, s33, v98
  v_dot2_f32_bf16 v99, v133, s34, v99
  v_dot2_f32_bf16 v100, v134, s33, v100
  v_dot2_f32_bf16 v101, v134, s34, v101
  v_dot2_f32_bf16 v102, v135, s33, v102
  v_dot2_f32_bf16 v103, v135, s34, v103
  v_dot2_f32_bf16 v96, v136, s33, v96
  v_dot2_f32_bf16 v97, v136, s34, v97
  v_dot2_f32_bf16 v98, v137, s33, v98
  v_dot2_f32_bf16 v99, v137, s34, v99
  v_dot2_f32_bf16 v100, v138, s33, v100
  v_dot2_f32_bf16 v101, v138, s34, v101
  v_dot2_f32_bf16 v102, v139, s33, v102
  v_dot2_f32_bf16 v103, v139, s34, v103
  v_dot2_f32_bf16 v96, v140, s33, v96
  v_dot2_f32_bf16 v97, v140, s34, v97
  v_dot2_f32_bf16 v98, v141, s33, v98
  v_dot2_f32_bf16 v99, v141, s34, v99
  v_dot2_f32_bf16 v100, v142, s33, v100
  v_dot2_f32_bf16 v101, v142, s34, v101
  v_dot2_f32_bf16 v102, v143, s33, v102
  v_dot2_f32_bf16 v103, v143, s34, v103
  v_dot2_f32_bf16 v96, v144, s33, v96
  v_dot2_f32_bf16 v97, v144, s34, v97
  v_dot2_f32_bf16 v98, v145, s33, v98
  v_dot2_f32_bf16 v99, v145, s34, v99
  v_dot2_f32_bf16 v100, v146, s33, v100
  v_dot2_f32_bf16 v101, v146, s34, v101
  v_dot2_f32_bf16 v102, v147, s33, v102
  v_dot2_f32_bf16 v103, v147, s34, v103
  v_dot2_f32_bf16 v96, v148, s33, v96
  v_dot2_f32_bf16 v97, v148, s34, v97
  v_dot2_f32_bf16 v98, v149, s33, v98
  v_dot2_f32_bf16 v99, v149, s34, v99
  v_dot2_f32_bf16 v100, v150, s33, v100
  v_dot2_f32_bf16 v101, v150, s34, v101
  v_dot2_f32_bf16 v102, v151, s33, v102
  v_dot2_f32_bf16 v103, v151, s34, v103
  v_dot2_f32_bf16 v96, v152, s33, v96
  v_dot2_f32_bf16 v97, v152, s34, v97
  v_dot2_f32_bf16 v98, v153, s33, v98
  v_dot2_f32_bf16 v99, v153, s34, v99
  v_dot2_f32_bf16 v100, v154, s33, v100
  v_dot2_f32_bf16 v101, v154, s34, v101
  v_dot2_f32_bf16 v102, v155, s33, v102
  v_dot2_f32_bf16 v103, v155, s34, v103
  v_dot2_f32_bf16 v96, v156, s33, v96
  v_dot2_f32_bf16 v97, v156, s34, v97
  v_dot2_f32_bf16 v98, v157, s33, v98
  v_dot2_f32_bf16 v99, v157, s34, v99
  v_dot2_f32_bf16 v100, v158, s33, v100
  v_dot2_f32_bf16 v101, v158, s34, v101
  v_dot2_f32_bf16 v102, v159, s33, v102
  v_dot2_f32_bf16 v103, v159, s34, v103
  v_dot2_f32_bf16 v96, v160, s33, v96
  v_dot2_f32_bf16 v97, v160, s34, v97
  v_dot2_f32_bf16 v98, v161, s33, v98
  v_dot2_f32_bf16 v99, v161, s34, v99
  v_dot2_f32_bf16 v100, v162, s33, v100
  v_dot2_f32_bf16 v101, v162, s34, v101
  v_dot2_f32_bf16 v102, v163, s33, v102
  v_dot2_f32_bf16 v103, v163, s34, v103
  v_dot2_f32_bf16 v96, v164, s33, v96
  v_dot2_f32_bf16 v97, v164, s34, v97
  v_dot2_f32_bf16 v98, v165, s33, v98
  v_dot2_f32_bf16 v99, v165, s34, v99
  v_dot2_f32_bf16 v100, v166, s33, v100
  v_dot2_f32_bf16 v101, v166, s34, v101
  v_dot2_f32_bf16 v102, v167, s33, v102
  v_dot2_f32_bf16 v103, v167, s34, v103
  v_dot2_f32_bf16 v96, v168, s33, v96
  v_dot2_f32_bf16 v97, v168, s34, v97
  v_dot2_f32_bf16 v98, v169, s33, v98
  v_dot2_f32_bf16 v99, v169, s34, v99
  v_dot2_f32_bf16 v100, v170, s33, v100
  v_dot2_f32_bf16 v101, v170, s34, v101
  v_dot2_f32_bf16 v102, v171, s33, v102
  v_dot2_f32_bf16 v103, v171, s34, v103
  v_dot2_f32_bf16 v96, v172, s33, v96
  v_dot2_f32_bf16 v97, v172, s34, v97
  v_dot2_f32_bf16 v98, v173, s33, v98
  v_dot2_f32_bf16 v99, v173, s34, v99
  v_dot2_f32_bf16 v100, v174, s33, v100
  v_dot2_f32_bf16 v101, v174, s34, v101
  v_dot2_f32_bf16 v102, v175, s33, v102
  v_dot2_f32_bf16 v103, v175, s34, v103
  v_dot2_f32_bf16 v96, v176, s33, v96
  v_dot2_f32_bf16 v97, v176, s34, v97
  v_dot2_f32_bf16 v98, v177, s33, v98
  v_dot2_f32_bf16 v99, v177, s34, v99
  v_dot2_f32_bf16 v100, v178, s33, v100
  v_dot2_f32_bf16 v101, v178, s34, v101
  v_dot2_f32_bf16 v102, v179, s33, v102
  v_dot2_f32_bf16 v103, v179, s34, v103
  v_dot2_f32_bf16 v96, v180, s33, v96
  v_dot2_f32_bf16 v97, v180, s34, v97
  v_dot2_f32_bf16 v98, v181, s33, v98
  v_dot2_f32_bf16 v99, v181, s34, v99
  v_dot2_f32_bf16 v100, v182, s33, v100
  v_dot2_f32_bf16 v101, v182, s34, v101
  v_dot2_f32_bf16 v102, v183, s33, v102
  v_dot2_f32_bf16 v103, v183, s34, v103
  v_dot2_f32_bf16 v96, v184, s33, v96
  v_dot2_f32_bf16 v97, v184, s34, v97
  v_dot2_f32_bf16 v98, v185, s33, v98
  v_dot2_f32_bf16 v99, v185, s34, v99
  v_dot2_f32_bf16 v100, v186, s33, v100
  v_dot2_f32_bf16 v101, v186, s34, v101
  v_dot2_f32_bf16 v102, v187, s33, v102
  v_dot2_f32_bf16 v103, v187, s34, v103
  v_dot2_f32_bf16 v96, v188, s33, v96
  v_dot2_f32_bf16 v97, v188, s34, v97
  v_dot2_f32_bf16 v98, v189, s33, v98
  v_dot2_f32_bf16 v99, v189, s34, v99
  v_dot2_f32_bf16 v100, v190, s33, v100
  v_dot2_f32_bf16 v101, v190, s34, v101
  v_dot2_f32_bf16 v102, v191, s33, v102
  v_dot2_f32_bf16 v103, v191, s34, v103
  v_cvt_pk_bf16_f32 v104, v96, v97
  v_cvt_pk_bf16_f32 v105, v98, v99
  v_cvt_pk_bf16_f32 v106, v100, v101
  v_cvt_pk_bf16_f32 v107, v102, v103
  buffer_store_dwordx2 v[104:105], v13, s[60:63], 0 offen
  buffer_store_dwordx2 v[106:107], v13, s[60:63], s32 offen
G3R_11_skip:
G23_10_nr:
  s_lshr_b32 s32, s42, 5
  s_lshl_b32 s33, s38, 2
  s_add_u32 s32, s32, s33
  s_add_u32 s32, s32, 8192
  v_mov_b32 v10, s32
  s_mov_b32 s96, 0
G2W_12:
  buffer_load_dword v11, v10, s[24:27], 0 offen sc1
  s_waitcnt vmcnt(0)
  v_readfirstlane_b32 s3, v11
  s_nop 0
  s_cmp_eq_u32 s3, 1
  s_cbranch_scc1 G2W_12_ok
  s_sleep 1
  s_add_u32 s96, s96, 1
  s_cmp_lt_u32 s96, 60000
  s_cbranch_scc1 G2W_12
  s_branch W_FAIL
G2W_12_ok:
  s_lshl_b32 s32, s38, 18
  s_add_u32 s32, s32, s42
  s_add_u32 s33, s32, 0
  buffer_load_dwordx4 v[96:99], v1, s[16:19], s33 offen sc1
  s_add_u32 s33, s33, 4096
  buffer_load_dwordx4 v[112:115], v1, s[16:19], s33 offen sc1
  s_add_u32 s33, s32, 1024
  buffer_load_dwordx4 v[100:103], v1, s[16:19], s33 offen sc1
  s_add_u32 s33, s33, 4096
  buffer_load_dwordx4 v[116:119], v1, s[16:19], s33 offen sc1
  s_add_u32 s33, s32, 2048
  buffer_load_dwordx4 v[104:107], v1, s[16:19], s33 offen sc1
  s_add_u32 s33, s33, 4096
  buffer_load_dwordx4 v[120:123], v1, s[16:19], s33 offen sc1
  s_add_u32 s33, s32, 3072
  buffer_load_dwordx4 v[108:111], v1, s[16:19], s33 offen sc1
  s_add_u32 s33, s33, 4096
  buffer_load_dwordx4 v[124:127], v1, s[16:19], s33 offen sc1
  s_waitcnt vmcnt(0)
  v_mfma_f32_16x16x32_bf16 v[128:131], v[96:99], v[16:19], 0
  v_mfma_f32_16x16x32_bf16 v[132:135], v[32:35], v[16:19], 0
  v_mfma_f32_16x16x32_bf16 v[136:139], v[36:39], v[16:19], 0
  v_mfma_f32_16x16x32_bf16 v[128:131], v[100:103], v[20:23], v[128:131]
  v_mfma_f32_16x16x32_bf16 v[132:135], v[40:43], v[20:23], v[132:135]
  v_mfma_f32_16x16x32_bf16 v[136:139], v[44:47], v[20:23], v[136:139]
  v_mfma_f32_16x16x32_bf16 v[128:131], v[104:107], v[24:27], v[128:131]
  v_mfma_f32_16x16x32_bf16 v[132:135], v[48:51], v[24:27], v[132:135]
  v_mfma_f32_16x16x32_bf16 v[136:139], v[52:55], v[24:27], v[136:139]
  v_mfma_f32_16x16x32_bf16 v[128:131], v[108:111], v[28:31], v[128:131]
  v_mfma_f32_16x16x32_bf16 v[132:135], v[56:59], v[28:31], v[132:135]
  v_mfma_f32_16x16x32_bf16 v[136:139], v[60:63], v[28:31], v[136:139]
  v_mov_b32 v10, 0xff800000
  s_cmp_eq_u32 s41, 0
  s_nop 4
  s_cbranch_scc0 G23_10_q1
  s_nop 3
  v_cndmask_b32 v132, v10, v132, s[44:45]
  v_mov_b32 v136, v10
  v_cndmask_b32 v133, v10, v133, s[46:47]
  v_mov_b32 v137, v10
  v_cndmask_b32 v134, v10, v134, s[48:49]
  v_mov_b32 v138, v10
  v_cndmask_b32 v135, v10, v135, s[50:51]
  v_mov_b32 v139, v10
  s_branch G23_10_qd
G23_10_q1:
  v_cndmask_b32 v136, v10, v136, s[44:45]
  v_cndmask_b32 v137, v10, v137, s[46:47]
  v_cndmask_b32 v138, v10, v138, s[48:49]
  v_cndmask_b32 v139, v10, v139, s[50:51]
G23_10_qd:
  v_max3_f32 v11, v128, v129, v132
  v_max3_f32 v11, v11, v133, v134
  v_max3_f32 v11, v11, v135, v136
  v_max3_f32 v11, v11, v137, v138
  v_max_f32 v11, v11, v139
  v_mov_b32 v12, v11
  s_nop 1
  v_permlane16_swap_b32 v11, v12
  v_max_f32 v11, v11, v12
  v_mov_b32 v12, v11
  s_nop 1
  v_permlane32_swap_b32 v11, v12
  v_max_f32 v11, v11, v12
  v_sub_f32 v128, v128, v11
  v_sub_f32 v129, v129, v11
  v_sub_f32 v132, v132, v11
  v_sub_f32 v133, v133, v11
  v_sub_f32 v134, v134, v11
  v_sub_f32 v135, v135, v11
  v_sub_f32 v136, v136, v11
  v_sub_f32 v137, v137, v11
  v_sub_f32 v138, v138, v11
  v_sub_f32 v139, v139, v11
  v_exp_f32 v128, v128
  v_exp_f32 v129, v129
  v_exp_f32 v132, v132
  v_exp_f32 v133, v133
  v_exp_f32 v134, v134
  v_exp_f32 v135, v135
  v_exp_f32 v136, v136
  v_exp_f32 v137, v137
  v_exp_f32 v138, v138
  v_exp_f32 v139, v139
  v_cvt_pk_bf16_f32 v140, v132, v133
  v_cvt_pk_bf16_f32 v141, v134, v135
  v_cvt_pk_bf16_f32 v142, v136, v137
  v_cvt_pk_bf16_f32 v143, v138, v139
  v_cvt_pk_bf16_f32 v144, v128, v129
  v_cvt_pk_bf16_f32 v145, v128, v129
  s_mov_b32 s32, 0x3f803f80
  v_mov_b32 v12, 0
  v_dot2_f32_bf16 v12, v140, s32, v12
  v_dot2_f32_bf16 v12, v141, s32, v12
  v_dot2_f32_bf16 v12, v142, s32, v12
  v_dot2_f32_bf16 v12, v143, s32, v12
  v_dot2_f32_bf16 v12, v144, s32, v12
  v_mfma_f32_16x16x32_bf16 v[148:151], v[64:67], v[140:143], 0
  v_mfma_f32_16x16x32_bf16 v[152:155], v[68:71], v[140:143], 0
  v_mfma_f32_16x16x32_bf16 v[156:159], v[72:75], v[140:143], 0
  v_mfma_f32_16x16x32_bf16 v[160:163], v[76:79], v[140:143], 0
  v_mfma_f32_16x16x32_bf16 v[164:167], v[80:83], v[140:143], 0
  v_mfma_f32_16x16x32_bf16 v[168:171], v[84:87], v[140:143], 0
  v_mfma_f32_16x16x32_bf16 v[172:175], v[88:91], v[140:143], 0
  v_mfma_f32_16x16x32_bf16 v[176:179], v[92:95], v[140:143], 0
  v_mfma_f32_16x16x16_bf16 v[148:151], v[112:113], v[144:145], v[148:151]
  v_mfma_f32_16x16x16_bf16 v[152:155], v[114:115], v[144:145], v[152:155]
  v_mfma_f32_16x16x16_bf16 v[156:159], v[116:117], v[144:145], v[156:159]
  v_mfma_f32_16x16x16_bf16 v[160:163], v[118:119], v[144:145], v[160:163]
  v_mfma_f32_16x16x16_bf16 v[164:167], v[120:121], v[144:145], v[164:167]
  v_mfma_f32_16x16x16_bf16 v[168:171], v[122:123], v[144:145], v[168:171]
  v_mfma_f32_16x16x16_bf16 v[172:175], v[124:125], v[144:145], v[172:175]
  v_mfma_f32_16x16x16_bf16 v[176:179], v[126:127], v[144:145], v[176:179]
  v_mov_b32 v13, v12
  s_nop 1
  v_permlane16_swap_b32 v12, v13
  v_add_f32 v12, v12, v13
  v_mov_b32 v13, v12
  s_nop 1
  v_permlane32_swap_b32 v12, v13
  v_add_f32 v12, v12, v13
  v_rcp_f32 v12, v12
  s_lshl_b32 s32, s40, 13
  s_lshl_b32 s33, s41, 10
  s_add_u32 s32, s32, s33
  v_add_u32 v13, s32, v1
  v_mul_f32 v148, v148, v12
  v_mul_f32 v149, v149, v12
  v_mul_f32 v150, v150, v12
  v_mul_f32 v151, v151, v12
  v_mul_f32 v152, v152, v12
  v_mul_f32 v153, v153, v12
  v_mul_f32 v154, v154, v12
  v_mul_f32 v155, v155, v12
  v_cvt_pk_bf16_f32 v148, v148, v149
  v_cvt_pk_bf16_f32 v149, v150, v151
  v_cvt_pk_bf16_f32 v150, v152, v153
  v_cvt_pk_bf16_f32 v151, v154, v155
  ds_write_b128 v13, v[148:151] offset:0
  v_mul_f32 v156, v156, v12
  v_mul_f32 v157, v157, v12
  v_mul_f32 v158, v158, v12
  v_mul_f32 v159, v159, v12
  v_mul_f32 v160, v160, v12
  v_mul_f32 v161, v161, v12
  v_mul_f32 v162, v162, v12
  v_mul_f32 v163, v163, v12
  v_cvt_pk_bf16_f32 v156, v156, v157
  v_cvt_pk_bf16_f32 v157, v158, v159
  v_cvt_pk_bf16_f32 v158, v160, v161
  v_cvt_pk_bf16_f32 v159, v162, v163
  ds_write_b128 v13, v[156:159] offset:2048
  v_mul_f32 v164, v164, v12
  v_mul_f32 v165, v165, v12
  v_mul_f32 v166, v166, v12
  v_mul_f32 v167, v167, v12
  v_mul_f32 v168, v168, v12
  v_mul_f32 v169, v169, v12
  v_mul_f32 v170, v170, v12
  v_mul_f32 v171, v171, v12
  v_cvt_pk_bf16_f32 v164, v164, v165
  v_cvt_pk_bf16_f32 v165, v166, v167
  v_cvt_pk_bf16_f32 v166, v168, v169
  v_cvt_pk_bf16_f32 v167, v170, v171
  ds_write_b128 v13, v[164:167] offset:4096
  v_mul_f32 v172, v172, v12
  v_mul_f32 v173, v173, v12
  v_mul_f32 v174, v174, v12
  v_mul_f32 v175, v175, v12
  v_mul_f32 v176, v176, v12
  v_mul_f32 v177, v177, v12
  v_mul_f32 v178, v178, v12
  v_mul_f32 v179, v179, v12
  v_cvt_pk_bf16_f32 v172, v172, v173
  v_cvt_pk_bf16_f32 v173, v174, v175
  v_cvt_pk_bf16_f32 v174, v176, v177
  v_cvt_pk_bf16_f32 v175, v178, v179
  ds_write_b128 v13, v[172:175] offset:6144
  s_waitcnt lgkmcnt(0)
  s_barrier
  s_add_u32 s43, s38, 14
  s_cmp_lt_u32 s43, 64
  s_cbranch_scc0 G23_10_np
  s_lshl_b32 s32, s43, 18
  s_add_u32 s32, s32, s42
  s_add_u32 s33, s32, 0
  buffer_load_dwordx4 v[32:35], v1, s[12:15], s33 offen sc1
  s_add_u32 s33, s33, 16777216
  buffer_load_dwordx4 v[64:67], v1, s[12:15], s33 offen sc1
  s_add_u32 s33, s32, 1024
  buffer_load_dwordx4 v[36:39], v1, s[12:15], s33 offen sc1
  s_add_u32 s33, s33, 16777216
  buffer_load_dwordx4 v[68:71], v1, s[12:15], s33 offen sc1
  s_add_u32 s33, s32, 2048
  buffer_load_dwordx4 v[40:43], v1, s[12:15], s33 offen sc1
  s_add_u32 s33, s33, 16777216
  buffer_load_dwordx4 v[72:75], v1, s[12:15], s33 offen sc1
  s_add_u32 s33, s32, 3072
  buffer_load_dwordx4 v[44:47], v1, s[12:15], s33 offen sc1
  s_add_u32 s33, s33, 16777216
  buffer_load_dwordx4 v[76:79], v1, s[12:15], s33 offen sc1
  s_add_u32 s33, s32, 4096
  buffer_load_dwordx4 v[48:51], v1, s[12:15], s33 offen sc1
  s_add_u32 s33, s33, 16777216
  buffer_load_dwordx4 v[80:83], v1, s[12:15], s33 offen sc1
  s_add_u32 s33, s32, 5120
  buffer_load_dwordx4 v[52:55], v1, s[12:15], s33 offen sc1
  s_add_u32 s33, s33, 16777216
  buffer_load_dwordx4 v[84:87], v1, s[12:15], s33 offen sc1
  s_add_u32 s33, s32, 6144
  buffer_load_dwordx4 v[56:59], v1, s[12:15], s33 offen sc1
  s_add_u32 s33, s33, 16777216
  buffer_load_dwordx4 v[88:91], v1, s[12:15], s33 offen sc1
  s_add_u32 s33, s32, 7168
  buffer_load_dwordx4 v[60:63], v1, s[12:15], s33 offen sc1
  s_add_u32 s33, s33, 16777216
  buffer_load_dwordx4 v[92:95], v1, s[12:15], s33 offen sc1
  s_lshl_b32 s34, s41, 10
  s_add_u32 s32, s32, s34
  s_add_u32 s32, s32, 33554432
  s_add_u32 s33, s32, 0
  buffer_load_dwordx4 v[16:19], v1, s[12:15], s33 offen sc1
  s_add_u32 s33, s32, 2048
  buffer_load_dwordx4 v[20:23], v1, s[12:15], s33 offen sc1
  s_add_u32 s33, s32, 4096
  buffer_load_dwordx4 v[24:27], v1, s[12:15], s33 offen sc1
  s_add_u32 s33, s32, 6144
  buffer_load_dwordx4 v[28:31], v1, s[12:15], s33 offen sc1
G23_10_np:
  ds_read_b128 v[200:203], v1 offset:0
  ds_read_b128 v[204:207], v1 offset:1024
  ds_read_b128 v[208:211], v1 offset:2048
  ds_read_b128 v[212:215], v1 offset:3072
  s_waitcnt lgkmcnt(3)
  v_mfma_f32_16x16x32_bf16 v[128:131], a[0:3], v[200:203], 0
  v_mfma_f32_16x16x32_bf16 v[136:139], a[32:35], v[200:203], 0
  v_mfma_f32_16x16x32_bf16 v[144:147], a[64:67], v[200:203], 0
  v_mfma_f32_16x16x32_bf16 v[152:155], a[96:99], v[200:203], 0
  v_mfma_f32_16x16x32_bf16 v[160:163], a[128:131], v[200:203], 0
  v_mfma_f32_16x16x32_bf16 v[168:171], a[160:163], v[200:203], 0
  v_mfma_f32_16x16x32_bf16 v[176:179], a[192:195], v[200:203], 0
  v_mfma_f32_16x16x32_bf16 v[184:187], a[224:227], v[200:203], 0
  v_mfma_f32_16x16x32_bf16 v[192:195], v[224:227], v[200:203], 0
  ds_read_b128 v[200:203], v1 offset:4096
  s_waitcnt lgkmcnt(3)
  v_mfma_f32_16x16x32_bf16 v[132:135], a[0:3], v[204:207], 0
  v_mfma_f32_16x16x32_bf16 v[140:143], a[32:35], v[204:207], 0
  v_mfma_f32_16x16x32_bf16 v[148:151], a[64:67], v[204:207], 0
  v_mfma_f32_16x16x32_bf16 v[156:159], a[96:99], v[204:207], 0
  v_mfma_f32_16x16x32_bf16 v[164:167], a[128:131], v[204:207], 0
  v_mfma_f32_16x16x32_bf16 v[172:175], a[160:163], v[204:207], 0
  v_mfma_f32_16x16x32_bf16 v[180:183], a[192:195], v[204:207], 0
  v_mfma_f32_16x16x32_bf16 v[188:191], a[224:227], v[204:207], 0
  v_mfma_f32_16x16x32_bf16 v[196:199], v[224:227], v[204:207], 0
  ds_read_b128 v[204:207], v1 offset:5120
  s_waitcnt lgkmcnt(3)
  v_mfma_f32_16x16x32_bf16 v[128:131], a[4:7], v[208:211], v[128:131]
  v_mfma_f32_16x16x32_bf16 v[136:139], a[36:39], v[208:211], v[136:139]
  v_mfma_f32_16x16x32_bf16 v[144:147], a[68:71], v[208:211], v[144:147]
  v_mfma_f32_16x16x32_bf16 v[152:155], a[100:103], v[208:211], v[152:155]
  v_mfma_f32_16x16x32_bf16 v[160:163], a[132:135], v[208:211], v[160:163]
  v_mfma_f32_16x16x32_bf16 v[168:171], a[164:167], v[208:211], v[168:171]
  v_mfma_f32_16x16x32_bf16 v[176:179], a[196:199], v[208:211], v[176:179]
  v_mfma_f32_16x16x32_bf16 v[184:187], a[228:231], v[208:211], v[184:187]
  v_mfma_f32_16x16x32_bf16 v[192:195], v[228:231], v[208:211], v[192:195]
  ds_read_b128 v[208:211], v1 offset:6144
  s_waitcnt lgkmcnt(3)
  v_mfma_f32_16x16x32_bf16 v[132:135], a[4:7], v[212:215], v[132:135]
  v_mfma_f32_16x16x32_bf16 v[140:143], a[36:39], v[212:215], v[140:143]
  v_mfma_f32_16x16x32_bf16 v[148:151], a[68:71], v[212:215], v[148:151]
  v_mfma_f32_16x16x32_bf16 v[156:159], a[100:103], v[212:215], v[156:159]
  v_mfma_f32_16x16x32_bf16 v[164:167], a[132:135], v[212:215], v[164:167]
  v_mfma_f32_16x16x32_bf16 v[172:175], a[164:167], v[212:215], v[172:175]
  v_mfma_f32_16x16x32_bf16 v[180:183], a[196:199], v[212:215], v[180:183]
  v_mfma_f32_16x16x32_bf16 v[188:191], a[228:231], v[212:215], v[188:191]
  v_mfma_f32_16x16x32_bf16 v[196:199], v[228:231], v[212:215], v[196:199]
  ds_read_b128 v[212:215], v1 offset:7168
  s_waitcnt lgkmcnt(3)
  v_mfma_f32_16x16x32_bf16 v[128:131], a[8:11], v[200:203], v[128:131]
  v_mfma_f32_16x16x32_bf16 v[136:139], a[40:43], v[200:203], v[136:139]
  v_mfma_f32_16x16x32_bf16 v[144:147], a[72:75], v[200:203], v[144:147]
  v_mfma_f32_16x16x32_bf16 v[152:155], a[104:107], v[200:203], v[152:155]
  v_mfma_f32_16x16x32_bf16 v[160:163], a[136:139], v[200:203], v[160:163]
  v_mfma_f32_16x16x32_bf16 v[168:171], a[168:171], v[200:203], v[168:171]
  v_mfma_f32_16x16x32_bf16 v[176:179], a[200:203], v[200:203], v[176:179]
  v_mfma_f32_16x16x32_bf16 v[184:187], a[232:235], v[200:203], v[184:187]
  v_mfma_f32_16x16x32_bf16 v[192:195], v[232:235], v[200:203], v[192:195]
  ds_read_b128 v[200:203], v1 offset:8192
  s_waitcnt lgkmcnt(3)
  v_mfma_f32_16x16x32_bf16 v[132:135], a[8:11], v[204:207], v[132:135]
  v_mfma_f32_16x16x32_bf16 v[140:143], a[40:43], v[204:207], v[140:143]
  v_mfma_f32_16x16x32_bf16 v[148:151], a[72:75], v[204:207], v[148:151]
  v_mfma_f32_16x16x32_bf16 v[156:159], a[104:107], v[204:207], v[156:159]
  v_mfma_f32_16x16x32_bf16 v[164:167], a[136:139], v[204:207], v[164:167]
  v_mfma_f32_16x16x32_bf16 v[172:175], a[168:171], v[204:207], v[172:175]
  v_mfma_f32_16x16x32_bf16 v[180:183], a[200:203], v[204:207], v[180:183]
  v_mfma_f32_16x16x32_bf16 v[188:191], a[232:235], v[204:207], v[188:191]
  v_mfma_f32_16x16x32_bf16 v[196:199], v[232:235], v[204:207], v[196:199]
  ds_read_b128 v[204:207], v1 offset:9216
  s_waitcnt lgkmcnt(3)
  v_mfma_f32_16x16x32_bf16 v[128:131], a[12:15], v[208:211], v[128:131]
  v_mfma_f32_16x16x32_bf16 v[136:139], a[44:47], v[208:211], v[136:139]
  v_mfma_f32_16x16x32_bf16 v[144:147], a[76:79], v[208:211], v[144:147]
  v_mfma_f32_16x16x32_bf16 v[152:155], a[108:111], v[208:211], v[152:155]
  v_mfma_f32_16x16x32_bf16 v[160:163], a[140:143], v[208:211], v[160:163]
  v_mfma_f32_16x16x32_bf16 v[168:171], a[172:175], v[208:211], v[168:171]
  v_mfma_f32_16x16x32_bf16 v[176:179], a[204:207], v[208:211], v[176:179]
  v_mfma_f32_16x16x32_bf16 v[184:187], a[236:239], v[208:211], v[184:187]
  v_mfma_f32_16x16x32_bf16 v[192:195], v[236:239], v[208:211], v[192:195]
  ds_read_b128 v[208:211], v1 offset:10240
  s_waitcnt lgkmcnt(3)
  v_mfma_f32_16x16x32_bf16 v[132:135], a[12:15], v[212:215], v[132:135]
  v_mfma_f32_16x16x32_bf16 v[140:143], a[44:47], v[212:215], v[140:143]
  v_mfma_f32_16x16x32_bf16 v[148:151], a[76:79], v[212:215], v[148:151]
  v_mfma_f32_16x16x32_bf16 v[156:159], a[108:111], v[212:215], v[156:159]
  v_mfma_f32_16x16x32_bf16 v[164:167], a[140:143], v[212:215], v[164:167]
  v_mfma_f32_16x16x32_bf16 v[172:175], a[172:175], v[212:215], v[172:175]
  v_mfma_f32_16x16x32_bf16 v[180:183], a[204:207], v[212:215], v[180:183]
  v_mfma_f32_16x16x32_bf16 v[188:191], a[236:239], v[212:215], v[188:191]
  v_mfma_f32_16x16x32_bf16 v[196:199], v[236:239], v[212:215], v[196:199]
  ds_read_b128 v[212:215], v1 offset:11264
  s_waitcnt lgkmcnt(3)
  v_mfma_f32_16x16x32_bf16 v[128:131], a[16:19], v[200:203], v[128:131]
  v_mfma_f32_16x16x32_bf16 v[136:139], a[48:51], v[200:203], v[136:139]
  v_mfma_f32_16x16x32_bf16 v[144:147], a[80:83], v[200:203], v[144:147]
  v_mfma_f32_16x16x32_bf16 v[152:155], a[112:115], v[200:203], v[152:155]
  v_mfma_f32_16x16x32_bf16 v[160:163], a[144:147], v[200:203], v[160:163]
  v_mfma_f32_16x16x32_bf16 v[168:171], a[176:179], v[200:203], v[168:171]
  v_mfma_f32_16x16x32_bf16 v[176:179], a[208:211], v[200:203], v[176:179]
  v_mfma_f32_16x16x32_bf16 v[184:187], a[240:243], v[200:203], v[184:187]
  v_mfma_f32_16x16x32_bf16 v[192:195], v[240:243], v[200:203], v[192:195]
  ds_read_b128 v[200:203], v1 offset:12288
  s_waitcnt lgkmcnt(3)
  v_mfma_f32_16x16x32_bf16 v[132:135], a[16:19], v[204:207], v[132:135]
  v_mfma_f32_16x16x32_bf16 v[140:143], a[48:51], v[204:207], v[140:143]
  v_mfma_f32_16x16x32_bf16 v[148:151], a[80:83], v[204:207], v[148:151]
  v_mfma_f32_16x16x32_bf16 v[156:159], a[112:115], v[204:207], v[156:159]
  v_mfma_f32_16x16x32_bf16 v[164:167], a[144:147], v[204:207], v[164:167]
  v_mfma_f32_16x16x32_bf16 v[172:175], a[176:179], v[204:207], v[172:175]
  v_mfma_f32_16x16x32_bf16 v[180:183], a[208:211], v[204:207], v[180:183]
  v_mfma_f32_16x16x32_bf16 v[188:191], a[240:243], v[204:207], v[188:191]
  v_mfma_f32_16x16x32_bf16 v[196:199], v[240:243], v[204:207], v[196:199]
  ds_read_b128 v[204:207], v1 offset:13312
  s_waitcnt lgkmcnt(3)
  v_mfma_f32_16x16x32_bf16 v[128:131], a[20:23], v[208:211], v[128:131]
  v_mfma_f32_16x16x32_bf16 v[136:139], a[52:55], v[208:211], v[136:139]
  v_mfma_f32_16x16x32_bf16 v[144:147], a[84:87], v[208:211], v[144:147]
  v_mfma_f32_16x16x32_bf16 v[152:155], a[116:119], v[208:211], v[152:155]
  v_mfma_f32_16x16x32_bf16 v[160:163], a[148:151], v[208:211], v[160:163]
  v_mfma_f32_16x16x32_bf16 v[168:171], a[180:183], v[208:211], v[168:171]
  v_mfma_f32_16x16x32_bf16 v[176:179], a[212:215], v[208:211], v[176:179]
  v_mfma_f32_16x16x32_bf16 v[184:187], a[244:247], v[208:211], v[184:187]
  v_mfma_f32_16x16x32_bf16 v[192:195], v[244:247], v[208:211], v[192:195]
  ds_read_b128 v[208:211], v1 offset:14336
  s_waitcnt lgkmcnt(3)
  v_mfma_f32_16x16x32_bf16 v[132:135], a[20:23], v[212:215], v[132:135]
  v_mfma_f32_16x16x32_bf16 v[140:143], a[52:55], v[212:215], v[140:143]
  v_mfma_f32_16x16x32_bf16 v[148:151], a[84:87], v[212:215], v[148:151]
  v_mfma_f32_16x16x32_bf16 v[156:159], a[116:119], v[212:215], v[156:159]
  v_mfma_f32_16x16x32_bf16 v[164:167], a[148:151], v[212:215], v[164:167]
  v_mfma_f32_16x16x32_bf16 v[172:175], a[180:183], v[212:215], v[172:175]
  v_mfma_f32_16x16x32_bf16 v[180:183], a[212:215], v[212:215], v[180:183]
  v_mfma_f32_16x16x32_bf16 v[188:191], a[244:247], v[212:215], v[188:191]
  v_mfma_f32_16x16x32_bf16 v[196:199], v[244:247], v[212:215], v[196:199]
  ds_read_b128 v[212:215], v1 offset:15360
  s_waitcnt lgkmcnt(3)
  v_mfma_f32_16x16x32_bf16 v[128:131], a[24:27], v[200:203], v[128:131]
  v_mfma_f32_16x16x32_bf16 v[136:139], a[56:59], v[200:203], v[136:139]
  v_mfma_f32_16x16x32_bf16 v[144:147], a[88:91], v[200:203], v[144:147]
  v_mfma_f32_16x16x32_bf16 v[152:155], a[120:123], v[200:203], v[152:155]
  v_mfma_f32_16x16x32_bf16 v[160:163], a[152:155], v[200:203], v[160:163]
  v_mfma_f32_16x16x32_bf16 v[168:171], a[184:187], v[200:203], v[168:171]
  v_mfma_f32_16x16x32_bf16 v[176:179], a[216:219], v[200:203], v[176:179]
  v_mfma_f32_16x16x32_bf16 v[184:187], a[248:251], v[200:203], v[184:187]
  v_mfma_f32_16x16x32_bf16 v[192:195], v[248:251], v[200:203], v[192:195]
  s_waitcnt lgkmcnt(2)
  v_mfma_f32_16x16x32_bf16 v[132:135], a[24:27], v[204:207], v[132:135]
  v_mfma_f32_16x16x32_bf16 v[140:143], a[56:59], v[204:207], v[140:143]
  v_mfma_f32_16x16x32_bf16 v[148:151], a[88:91], v[204:207], v[148:151]
  v_mfma_f32_16x16x32_bf16 v[156:159], a[120:123], v[204:207], v[156:159]
  v_mfma_f32_16x16x32_bf16 v[164:167], a[152:155], v[204:207], v[164:167]
  v_mfma_f32_16x16x32_bf16 v[172:175], a[184:187], v[204:207], v[172:175]
  v_mfma_f32_16x16x32_bf16 v[180:183], a[216:219], v[204:207], v[180:183]
  v_mfma_f32_16x16x32_bf16 v[188:191], a[248:251], v[204:207], v[188:191]
  v_mfma_f32_16x16x32_bf16 v[196:199], v[248:251], v[204:207], v[196:199]
  s_waitcnt lgkmcnt(1)
  v_mfma_f32_16x16x32_bf16 v[128:131], a[28:31], v[208:211], v[128:131]
  v_mfma_f32_16x16x32_bf16 v[136:139], a[60:63], v[208:211], v[136:139]
  v_mfma_f32_16x16x32_bf16 v[144:147], a[92:95], v[208:211], v[144:147]
  v_mfma_f32_16x16x32_bf16 v[152:155], a[124:127], v[208:211], v[152:155]
  v_mfma_f32_16x16x32_bf16 v[160:163], a[156:159], v[208:211], v[160:163]
  v_mfma_f32_16x16x32_bf16 v[168:171], a[188:191], v[208:211], v[168:171]
  v_mfma_f32_16x16x32_bf16 v[176:179], a[220:223], v[208:211], v[176:179]
  v_mfma_f32_16x16x32_bf16 v[184:187], a[252:255], v[208:211], v[184:187]
  v_mfma_f32_16x16x32_bf16 v[192:195], v[252:255], v[208:211], v[192:195]
  s_waitcnt lgkmcnt(0)
  v_mfma_f32_16x16x32_bf16 v[132:135], a[28:31], v[212:215], v[132:135]
  v_mfma_f32_16x16x32_bf16 v[140:143], a[60:63], v[212:215], v[140:143]
  v_mfma_f32_16x16x32_bf16 v[148:151], a[92:95], v[212:215], v[148:151]
  v_mfma_f32_16x16x32_bf16 v[156:159], a[124:127], v[212:215], v[156:159]
  v_mfma_f32_16x16x32_bf16 v[164:167], a[156:159], v[212:215], v[164:167]
  v_mfma_f32_16x16x32_bf16 v[172:175], a[188:191], v[212:215], v[172:175]
  v_mfma_f32_16x16x32_bf16 v[180:183], a[220:223], v[212:215], v[180:183]
  v_mfma_f32_16x16x32_bf16 v[188:191], a[252:255], v[212:215], v[188:191]
  v_mfma_f32_16x16x32_bf16 v[196:199], v[252:255], v[212:215], v[196:199]
  s_lshl_b32 s32, s38, 4
  s_add_u32 s32, s32, s36
  s_mul_i32 s32, s32, 36864
  s_mul_i32 s33, s94, 9216
  s_add_u32 s32, s32, s33
  v_cvt_pk_bf16_f32 v128, v128, v129
  v_cvt_pk_bf16_f32 v129, v130, v131
  v_cvt_pk_bf16_f32 v130, v132, v133
  v_cvt_pk_bf16_f32 v131, v134, v135
  buffer_store_dwordx4 v[128:131], v1, s[20:23], s32 offen sc1
  s_add_u32 s32, s32, 1024
  v_cvt_pk_bf16_f32 v136, v136, v137
  v_cvt_pk_bf16_f32 v137, v138, v139
  v_cvt_pk_bf16_f32 v138, v140, v141
  v_cvt_pk_bf16_f32 v139, v142, v143
  buffer_store_dwordx4 v[136:139], v1, s[20:23], s32 offen sc1
  s_add_u32 s32, s32, 1024
  v_cvt_pk_bf16_f32 v144, v144, v145
  v_cvt_pk_bf16_f32 v145, v146, v147
  v_cvt_pk_bf16_f32 v146, v148, v149
  v_cvt_pk_bf16_f32 v147, v150, v151
  buffer_store_dwordx4 v[144:147], v1, s[20:23], s32 offen sc1
  s_add_u32 s32, s32, 1024
  v_cvt_pk_bf16_f32 v152, v152, v153
  v_cvt_pk_bf16_f32 v153, v154, v155
  v_cvt_pk_bf16_f32 v154, v156, v157
  v_cvt_pk_bf16_f32 v155, v158, v159
  buffer_store_dwordx4 v[152:155], v1, s[20:23], s32 offen sc1
  s_add_u32 s32, s32, 1024
  v_cvt_pk_bf16_f32 v160, v160, v161
  v_cvt_pk_bf16_f32 v161, v162, v163
  v_cvt_pk_bf16_f32 v162, v164, v165
  v_cvt_pk_bf16_f32 v163, v166, v167
  buffer_store_dwordx4 v[160:163], v1, s[20:23], s32 offen sc1
  s_add_u32 s32, s32, 1024
  v_cvt_pk_bf16_f32 v168, v168, v169
  v_cvt_pk_bf16_f32 v169, v170, v171
  v_cvt_pk_bf16_f32 v170, v172, v173
  v_cvt_pk_bf16_f32 v171, v174, v175
  buffer_store_dwordx4 v[168:171], v1, s[20:23], s32 offen sc1
  s_add_u32 s32, s32, 1024
  v_cvt_pk_bf16_f32 v176, v176, v177
  v_cvt_pk_bf16_f32 v177, v178, v179
  v_cvt_pk_bf16_f32 v178, v180, v181
  v_cvt_pk_bf16_f32 v179, v182, v183
  buffer_store_dwordx4 v[176:179], v1, s[20:23], s32 offen sc1
  s_add_u32 s32, s32, 1024
  v_cvt_pk_bf16_f32 v184, v184, v185
  v_cvt_pk_bf16_f32 v185, v186, v187
  v_cvt_pk_bf16_f32 v186, v188, v189
  v_cvt_pk_bf16_f32 v187, v190, v191
  buffer_store_dwordx4 v[184:187], v1, s[20:23], s32 offen sc1
  s_add_u32 s32, s32, 1024
  v_cvt_pk_bf16_f32 v192, v192, v193
  v_cvt_pk_bf16_f32 v193, v194, v195
  v_cvt_pk_bf16_f32 v194, v196, v197
  v_cvt_pk_bf16_f32 v195, v198, v199
  buffer_store_dwordx4 v[192:195], v1, s[20:23], s32 offen sc1
  s_waitcnt vmcnt(0)
  s_barrier
  s_cmp_eq_u32 s94, 0
  s_cbranch_scc0 G23_10_nf
  s_lshl_b32 s32, s38, 4
  s_add_u32 s32, s32, s36
  s_lshl_b32 s32, s32, 2
  s_add_u32 s32, s32, 16384
  s_mov_b64 exec, 1
  v_mov_b32 v10, 1
  v_mov_b32 v11, 0
  buffer_store_dword v10, v11, s[24:27], s32 offen sc1
  s_mov_b64 exec, -1
G23_10_nf:
  s_mov_b32 s39, s38
  s_mov_b32 s38, s43
  s_cmp_lt_u32 s38, 64
  s_cbranch_scc1 G23_10
  s_cmp_lt_u32 s36, 9
  s_cbranch_scc0 G3E_13_skip
  v_and_b32 v10, 15, v0
  v_lshlrev_b32 v10, 2, v10
  s_lshl_b32 s32, s39, 6
  s_add_u32 s32, s32, 16384
  s_mov_b32 s96, 0
G3E_13:
  buffer_load_dword v11, v10, s[24:27], s32 offen sc1
  s_waitcnt vmcnt(0)
  v_cmp_ne_u32 vcc, 1, v11
  s_nop 0
  s_cbranch_vccz G3E_13_ok
  s_sleep 1
  s_add_u32 s96, s96, 1
  s_cmp_lt_u32 s96, 60000
  s_cbranch_scc1 G3E_13
  s_branch W_FAIL
G3E_13_ok:
  s_lshl_b32 s32, s36, 2
  s_add_u32 s32, s32, s94
  s_mul_i32 s33, s39, 589824
  s_lshl_b32 s34, s32, 10
  s_add_u32 s33, s33, s34
  buffer_load_dwordx4 v[128:131], v1, s[20:23], s33 offen sc1
  s_add_u32 s33, s33, 36864
  buffer_load_dwordx4 v[132:135], v1, s[20:23], s33 offen sc1
  s_add_u32 s33, s33, 36864
  buffer_load_dwordx4 v[136:139], v1, s[20:23], s33 offen sc1
  s_add_u32 s33, s33, 36864
  buffer_load_dwordx4 v[140:143], v1, s[20:23], s33 offen sc1
  s_add_u32 s33, s33, 36864
  buffer_load_dwordx4 v[144:147], v1, s[20:23], s33 offen sc1
  s_add_u32 s33, s33, 36864
  buffer_load_dwordx4 v[148:151], v1, s[20:23], s33 offen sc1
  s_add_u32 s33, s33, 36864
  buffer_load_dwordx4 v[152:155], v1, s[20:23], s33 offen sc1
  s_add_u32 s33, s33, 36864
  buffer_load_dwordx4 v[156:159], v1, s[20:23], s33 offen sc1
  s_add_u32 s33, s33, 36864
  buffer_load_dwordx4 v[160:163], v1, s[20:23], s33 offen sc1
  s_add_u32 s33, s33, 36864
  buffer_load_dwordx4 v[164:167], v1, s[20:23], s33 offen sc1
  s_add_u32 s33, s33, 36864
  buffer_load_dwordx4 v[168:171], v1, s[20:23], s33 offen sc1
  s_add_u32 s33, s33, 36864
  buffer_load_dwordx4 v[172:175], v1, s[20:23], s33 offen sc1
  s_add_u32 s33, s33, 36864
  buffer_load_dwordx4 v[176:179], v1, s[20:23], s33 offen sc1
  s_add_u32 s33, s33, 36864
  buffer_load_dwordx4 v[180:183], v1, s[20:23], s33 offen sc1
  s_add_u32 s33, s33, 36864
  buffer_load_dwordx4 v[184:187], v1, s[20:23], s33 offen sc1
  s_add_u32 s33, s33, 36864
  buffer_load_dwordx4 v[188:191], v1, s[20:23], s33 offen sc1
  s_mul_hi_u32 s33, s32, 477218589
  s_mul_i32 s34, s33, 9
  s_sub_u32 s34, s32, s34
  s_lshl_b32 s34, s34, 2
  s_add_u32 s34, s34, s33
  s_lshl_b32 s34, s34, 4
  v_lshrrev_b32 v10, 4, v0
  v_lshlrev_b32 v10, 2, v10
  v_add_u32 v10, s34, v10
  v_and_b32 v11, 15, v0
  s_lshl_b32 s32, s39, 5
  v_add_u32 v11, s32, v11
  v_mul_u32_u24 v12, 576, v11
  v_add_u32 v12, v12, v10
  v_lshlrev_b32 v13, 1, v12
  v_lshlrev_b32 v14, 2, v12
  v_lshlrev_b32 v15, 1, v11
  s_mov_b32 s32, 18432
  s_mov_b32 s33, 36864
  s_mov_b32 s34, 4718592
  s_add_u32 s35, s34, s33
  buffer_load_dwordx2 v[200:201], v13, s[52:55], 0 offen
  buffer_load_dwordx2 v[202:203], v13, s[52:55], s32 offen
  buffer_load_dwordx4 v[204:207], v14, s[56:59], 0 offen sc1
  buffer_load_dwordx4 v[208:211], v14, s[56:59], s33 offen sc1
  buffer_load_dwordx4 v[212:215], v14, s[56:59], s34 offen sc1
  buffer_load_dwordx4 v[216:219], v14, s[56:59], s35 offen sc1
  buffer_load_ushort v220, v15, s[8:11], 0 offen
  buffer_load_ushort v221, v15, s[8:11], 0 offen offset:32
  s_mov_b32 s33, 0x00003f80
  s_mov_b32 s34, 0x3f800000
  s_waitcnt vmcnt(0)
  v_lshlrev_b32 v220, 16, v220
  v_lshlrev_b32 v221, 16, v221
  v_add_f32 v96, v204, v212
  v_add_f32 v96, v96, v220
  v_add_f32 v97, v205, v213
  v_add_f32 v97, v97, v220
  v_add_f32 v98, v206, v214
  v_add_f32 v98, v98, v220
  v_add_f32 v99, v207, v215
  v_add_f32 v99, v99, v220
  v_dot2_f32_bf16 v96, v200, s33, v96
  v_dot2_f32_bf16 v97, v200, s34, v97
  v_dot2_f32_bf16 v98, v201, s33, v98
  v_dot2_f32_bf16 v99, v201, s34, v99
  v_add_f32 v100, v208, v216
  v_add_f32 v100, v100, v221
  v_add_f32 v101, v209, v217
  v_add_f32 v101, v101, v221
  v_add_f32 v102, v210, v218
  v_add_f32 v102, v102, v221
  v_add_f32 v103, v211, v219
  v_add_f32 v103, v103, v221
  v_dot2_f32_bf16 v100, v202, s33, v100
  v_dot2_f32_bf16 v101, v202, s34, v101
  v_dot2_f32_bf16 v102, v203, s33, v102
  v_dot2_f32_bf16 v103, v203, s34, v103
  v_dot2_f32_bf16 v96, v128, s33, v96
  v_dot2_f32_bf16 v97, v128, s34, v97
  v_dot2_f32_bf16 v98, v129, s33, v98
  v_dot2_f32_bf16 v99, v129, s34, v99
  v_dot2_f32_bf16 v100, v130, s33, v100
  v_dot2_f32_bf16 v101, v130, s34, v101
  v_dot2_f32_bf16 v102, v131, s33, v102
  v_dot2_f32_bf16 v103, v131, s34, v103
  v_dot2_f32_bf16 v96, v132, s33, v96
  v_dot2_f32_bf16 v97, v132, s34, v97
  v_dot2_f32_bf16 v98, v133, s33, v98
  v_dot2_f32_bf16 v99, v133, s34, v99
  v_dot2_f32_bf16 v100, v134, s33, v100
  v_dot2_f32_bf16 v101, v134, s34, v101
  v_dot2_f32_bf16 v102, v135, s33, v102
  v_dot2_f32_bf16 v103, v135, s34, v103
  v_dot2_f32_bf16 v96, v136, s33, v96
  v_dot2_f32_bf16 v97, v136, s34, v97
  v_dot2_f32_bf16 v98, v137, s33, v98
  v_dot2_f32_bf16 v99, v137, s34, v99
  v_dot2_f32_bf16 v100, v138, s33, v100
  v_dot2_f32_bf16 v101, v138, s34, v101
  v_dot2_f32_bf16 v102, v139, s33, v102
  v_dot2_f32_bf16 v103, v139, s34, v103
  v_dot2_f32_bf16 v96, v140, s33, v96
  v_dot2_f32_bf16 v97, v140, s34, v97
  v_dot2_f32_bf16 v98, v141, s33, v98
  v_dot2_f32_bf16 v99, v141, s34, v99
  v_dot2_f32_bf16 v100, v142, s33, v100
  v_dot2_f32_bf16 v101, v142, s34, v101
  v_dot2_f32_bf16 v102, v143, s33, v102
  v_dot2_f32_bf16 v103, v143, s34, v103
  v_dot2_f32_bf16 v96, v144, s33, v96
  v_dot2_f32_bf16 v97, v144, s34, v97
  v_dot2_f32_bf16 v98, v145, s33, v98
  v_dot2_f32_bf16 v99, v145, s34, v99
  v_dot2_f32_bf16 v100, v146, s33, v100
  v_dot2_f32_bf16 v101, v146, s34, v101
  v_dot2_f32_bf16 v102, v147, s33, v102
  v_dot2_f32_bf16 v103, v147, s34, v103
  v_dot2_f32_bf16 v96, v148, s33, v96
  v_dot2_f32_bf16 v97, v148, s34, v97
  v_dot2_f32_bf16 v98, v149, s33, v98
  v_dot2_f32_bf16 v99, v149, s34, v99
  v_dot2_f32_bf16 v100, v150, s33, v100
  v_dot2_f32_bf16 v101, v150, s34, v101
  v_dot2_f32_bf16 v102, v151, s33, v102
  v_dot2_f32_bf16 v103, v151, s34, v103
  v_dot2_f32_bf16 v96, v152, s33, v96
  v_dot2_f32_bf16 v97, v152, s34, v97
  v_dot2_f32_bf16 v98, v153, s33, v98
  v_dot2_f32_bf16 v99, v153, s34, v99
  v_dot2_f32_bf16 v100, v154, s33, v100
  v_dot2_f32_bf16 v101, v154, s34, v101
  v_dot2_f32_bf16 v102, v155, s33, v102
  v_dot2_f32_bf16 v103, v155, s34, v103
  v_dot2_f32_bf16 v96, v156, s33, v96
  v_dot2_f32_bf16 v97, v156, s34, v97
  v_dot2_f32_bf16 v98, v157, s33, v98
  v_dot2_f32_bf16 v99, v157, s34, v99
  v_dot2_f32_bf16 v100, v158, s33, v100
  v_dot2_f32_bf16 v101, v158, s34, v101
  v_dot2_f32_bf16 v102, v159, s33, v102
  v_dot2_f32_bf16 v103, v159, s34, v103
  v_dot2_f32_bf16 v96, v160, s33, v96
  v_dot2_f32_bf16 v97, v160, s34, v97
  v_dot2_f32_bf16 v98, v161, s33, v98
  v_dot2_f32_bf16 v99, v161, s34, v99
  v_dot2_f32_bf16 v100, v162, s33, v100
  v_dot2_f32_bf16 v101, v162, s34, v101
  v_dot2_f32_bf16 v102, v163, s33, v102
  v_dot2_f32_bf16 v103, v163, s34, v103
  v_dot2_f32_bf16 v96, v164, s33, v96
  v_dot2_f32_bf16 v97, v164, s34, v97
  v_dot2_f32_bf16 v98, v165, s33, v98
  v_dot2_f32_bf16 v99, v165, s34, v99
  v_dot2_f32_bf16 v100, v166, s33, v100
  v_dot2_f32_bf16 v101, v166, s34, v101
  v_dot2_f32_bf16 v102, v167, s33, v102
  v_dot2_f32_bf16 v103, v167, s34, v103
  v_dot2_f32_bf16 v96, v168, s33, v96
  v_dot2_f32_bf16 v97, v168, s34, v97
  v_dot2_f32_bf16 v98, v169, s33, v98
  v_dot2_f32_bf16 v99, v169, s34, v99
  v_dot2_f32_bf16 v100, v170, s33, v100
  v_dot2_f32_bf16 v101, v170, s34, v101
  v_dot2_f32_bf16 v102, v171, s33, v102
  v_dot2_f32_bf16 v103, v171, s34, v103
  v_dot2_f32_bf16 v96, v172, s33, v96
  v_dot2_f32_bf16 v97, v172, s34, v97
  v_dot2_f32_bf16 v98, v173, s33, v98
  v_dot2_f32_bf16 v99, v173, s34, v99
  v_dot2_f32_bf16 v100, v174, s33, v100
  v_dot2_f32_bf16 v101, v174, s34, v101
  v_dot2_f32_bf16 v102, v175, s33, v102
  v_dot2_f32_bf16 v103, v175, s34, v103
  v_dot2_f32_bf16 v96, v176, s33, v96
  v_dot2_f32_bf16 v97, v176, s34, v97
  v_dot2_f32_bf16 v98, v177, s33, v98
  v_dot2_f32_bf16 v99, v177, s34, v99
  v_dot2_f32_bf16 v100, v178, s33, v100
  v_dot2_f32_bf16 v101, v178, s34, v101
  v_dot2_f32_bf16 v102, v179, s33, v102
  v_dot2_f32_bf16 v103, v179, s34, v103
  v_dot2_f32_bf16 v96, v180, s33, v96
  v_dot2_f32_bf16 v97, v180, s34, v97
  v_dot2_f32_bf16 v98, v181, s33, v98
  v_dot2_f32_bf16 v99, v181, s34, v99
  v_dot2_f32_bf16 v100, v182, s33, v100
  v_dot2_f32_bf16 v101, v182, s34, v101
  v_dot2_f32_bf16 v102, v183, s33, v102
  v_dot2_f32_bf16 v103, v183, s34, v103
  v_dot2_f32_bf16 v96, v184, s33, v96
  v_dot2_f32_bf16 v97, v184, s34, v97
  v_dot2_f32_bf16 v98, v185, s33, v98
  v_dot2_f32_bf16 v99, v185, s34, v99
  v_dot2_f32_bf16 v100, v186, s33, v100
  v_dot2_f32_bf16 v101, v186, s34, v101
  v_dot2_f32_bf16 v102, v187, s33, v102
  v_dot2_f32_bf16 v103, v187, s34, v103
  v_dot2_f32_bf16 v96, v188, s33, v96
  v_dot2_f32_bf16 v97, v188, s34, v97
  v_dot2_f32_bf16 v98, v189, s33, v98
  v_dot2_f32_bf16 v99, v189, s34, v99
  v_dot2_f32_bf16 v100, v190, s33, v100
  v_dot2_f32_bf16 v101, v190, s34, v101
  v_dot2_f32_bf16 v102, v191, s33, v102
  v_dot2_f32_bf16 v103, v191, s34, v103
  v_cvt_pk_bf16_f32 v104, v96, v97
  v_cvt_pk_bf16_f32 v105, v98, v99
  v_cvt_pk_bf16_f32 v106, v100, v101
  v_cvt_pk_bf16_f32 v107, v102, v103
  buffer_store_dwordx2 v[104:105], v13, s[60:63], 0 offen
  buffer_store_dwordx2 v[106:107], v13, s[60:63], s32 offen
G3E_13_skip:
  s_waitcnt vmcnt(0)
  s_branch END
W_FAIL:
  s_mov_b64 exec, 1
  v_mov_b32 v1, 0xbad
  v_mov_b32 v2, 28
  buffer_store_dword v1, v2, s[28:31], 0 offen
  s_waitcnt vmcnt(0)
  s_branch END
ROLE_CHAIN:
  s_mov_b32 s32, s95
  s_mov_b32 s8, s92
  s_mov_b32 s9, s93
  s_mov_b32 s10, 0x48000
  s_mov_b32 s11, 0x00020000
  s_add_u32 s12, s92, 0x50000
  s_addc_u32 s13, s93, 0
  s_mov_b32 s14, 0x2400
  s_mov_b32 s15, 0x00020000
  s_add_u32 s16, s92, 0x800000
  s_addc_u32 s17, s93, 0
  s_mov_b32 s18, 0x2000000
  s_mov_b32 s19, 0x00020000
  s_add_u32 s20, s92, 0x3800000
  s_addc_u32 s21, s93, 0
  s_mov_b32 s22, 0x1000000
  s_mov_b32 s23, 0x00020000
  s_add_u32 s24, s92, 0x60000
  s_addc_u32 s25, s93, 0
  s_mov_b32 s26, 0x5600
  s_mov_b32 s27, 0x00020000
  s_mov_b32 s36, s68
  s_mov_b32 s37, s69
  s_mov_b32 s38, 0x480000
  s_mov_b32 s39, 0x00020000
  s_mov_b32 s40, s70
  s_mov_b32 s41, s71
  s_mov_b32 s42, 0x480000
  s_mov_b32 s43, 0x00020000
  s_mov_b32 s44, s72
  s_mov_b32 s45, s73
  s_mov_b32 s46, 0x480000
  s_mov_b32 s47, 0x00020000
  s_mov_b32 s48, s74
  s_mov_b32 s49, s75
  s_mov_b32 s50, 0x480000
  s_mov_b32 s51, 0x00020000
  s_mov_b32 s52, s66
  s_mov_b32 s53, s67
  s_mov_b32 s54, 0x2400
  s_mov_b32 s55, 0x00020000
  v_and_b32 v12, 15, v0
  v_lshrrev_b32 v13, 2, v12
  v_lshlrev_b32 v13, 1, v13
  v_and_b32 v14, 1, v12
  v_or_b32 v13, v13, v14
  v_mul_u32_u24 v13, 1152, v13
  v_bfe_u32 v12, v12, 1, 1
  v_lshl_add_u32 v13, v12, 4, v13
  v_lshrrev_b32 v12, 4, v0
  v_lshl_add_u32 v13, v12, 5, v13
  s_lshl_b32 s98, s94, 7
  buffer_load_dwordx4 v[64:67], v13, s[52:55], s98 offen
  buffer_load_dwordx4 v[68:71], v13, s[52:55], s98 offen offset:512
  s_mov_b32 s98, 1024
  buffer_load_dwordx4 v[72:75], v13, s[52:55], s98 offen
  v_lshlrev_b32 v4, 4, v0
  v_lshlrev_b32 v7, 2, v0
  v_mov_b32 v12, 0
  v_mov_b32 v13, 0
  v_mov_b32 v14, 0
  v_mov_b32 v15, 0
  v_and_b32 v16, 31, v0
  v_lshlrev_b32 v16, 4, v16
  v_lshrrev_b32 v17, 5, v0
  v_lshlrev_b32 v17, 14, v17
  v_add_u32 v16, v16, v17
  s_lshl_b32 s35, s32, 9
  s_lshl_b32 s98, s94, 15
  s_add_u32 s35, s35, s98
  buffer_store_dwordx4 v[12:15], v16, s[8:11], s35 offen sc1
  s_add_u32 s35, s35, 131072
  buffer_store_dwordx4 v[12:15], v16, s[8:11], s35 offen sc1
  s_add_u32 s35, s35, 131072
  s_cmp_eq_u32 s94, 0
  s_cbranch_scc0 CH_INIT_H1_DONE
  buffer_store_dwordx4 v[12:15], v16, s[8:11], s35 offen sc1
  s_add_u32 s35, s35, 131072
CH_INIT_H1_DONE:
  s_cmp_eq_u32 s94, 0
  s_cbranch_scc0 CH_INIT_W1
  s_mul_i32 s35, s32, 288
  s_mov_b32 exec_lo, 0x3ffff
  s_mov_b32 exec_hi, 0
  buffer_store_dwordx4 v[12:15], v4, s[12:15], s35 offen sc1
  s_mov_b64 exec, -1
  s_branch CH_INIT_DONE
CH_INIT_W1:
  s_lshl_b32 s35, s32, 8
  s_cmp_eq_u32 s94, 3
  s_cbranch_scc1 CH_INIT_W3
  s_cmp_eq_u32 s94, 2
  s_cselect_b32 s98, 8192, 0
  s_add_u32 s35, s35, s98
  buffer_store_dword v12, v7, s[24:27], s35 offen sc1
  s_branch CH_INIT_DONE
CH_INIT_W3:
  s_lshl_b32 s35, s32, 7
  s_add_u32 s35, s35, 16384
  s_mov_b32 exec_hi, 0
  buffer_store_dword v12, v7, s[24:27], s35 offen sc1
  s_mov_b64 exec, -1
CH_INIT_DONE:
  v_lshrrev_b32 v22, 4, v0
  v_and_b32 v21, 15, v0
  v_lshlrev_b32 v19, 1, v22
  v_xor_b32 v19, v19, v21
  v_lshlrev_b32 v20, 13, v22
  v_lshl_add_u32 v12, v19, 4, v20
  v_xor_b32 v19, 8, v19
  v_lshl_add_u32 v13, v19, 4, v20
  v_lshrrev_b32 v19, 3, v0
  v_mul_u32_u24 v20, 1152, v19
  v_and_b32 v19, 7, v0
  s_lshl_b32 s35, s94, 1
  s_and_b32 s35, s35, 3
  s_lshl_b32 s35, s35, 1
  v_xor_b32 v23, s35, v19
  v_lshl_add_u32 v14, v23, 4, v20
  s_lshl_b32 s35, s94, 1
  s_add_u32 s35, s35, 1
  s_and_b32 s35, s35, 3
  s_lshl_b32 s35, s35, 1
  v_xor_b32 v23, s35, v19
  v_lshl_add_u32 v15, v23, 4, v20
  s_lshl_b32 s98, s32, 8
  s_lshl_b32 s35, s94, 17
  s_add_u32 s98, s98, s35
  s_lshl_b32 s99, s32, 7
  s_lshl_b32 s35, s94, 5
  s_add_u32 s99, s99, s35
  s_mul_i32 s99, s99, 1152
  s_lshl_b32 s100, s94, 12
  s_add_u32 s100, s100, 16384
  s_add_u32 m0, s100, 0
  s_add_u32 s35, s98, 524288
  buffer_load_dwordx4 v12, s[40:43], s35 offen lds
  s_add_u32 m0, s100, 1024
  s_add_u32 s35, s98, 557056
  buffer_load_dwordx4 v12, s[40:43], s35 offen lds
  s_add_u32 m0, s100, 2048
  s_add_u32 s35, s98, 589824
  buffer_load_dwordx4 v13, s[40:43], s35 offen lds
  s_add_u32 m0, s100, 3072
  s_add_u32 s35, s98, 622592
  buffer_load_dwordx4 v13, s[40:43], s35 offen lds
  s_add_u32 m0, s100, 16384
  s_add_u32 s35, s98, 1048576
  buffer_load_dwordx4 v12, s[40:43], s35 offen lds
  s_add_u32 m0, s100, 17408
  s_add_u32 s35, s98, 1081344
  buffer_load_dwordx4 v12, s[40:43], s35 offen lds
  s_add_u32 m0, s100, 18432
  s_add_u32 s35, s98, 1114112
  buffer_load_dwordx4 v13, s[40:43], s35 offen lds
  s_add_u32 m0, s100, 19456
  s_add_u32 s35, s98, 1146880
  buffer_load_dwordx4 v13, s[40:43], s35 offen lds
  s_add_u32 m0, s100, 32768
  s_add_u32 s35, s98, 2097152
  buffer_load_dwordx4 v12, s[40:43], s35 offen lds
  s_add_u32 m0, s100, 33792
  s_add_u32 s35, s98, 2129920
  buffer_load_dwordx4 v12, s[40:43], s35 offen lds
  s_add_u32 m0, s100, 34816
  s_add_u32 s35, s98, 2162688
  buffer_load_dwordx4 v13, s[40:43], s35 offen lds
  s_add_u32 m0, s100, 35840
  s_add_u32 s35, s98, 2195456
  buffer_load_dwordx4 v13, s[40:43], s35 offen lds
  s_add_u32 m0, s100, 49152
  s_add_u32 s35, s98, 2621440
  buffer_load_dwordx4 v12, s[40:43], s35 offen lds
  s_add_u32 m0, s100, 50176
  s_add_u32 s35, s98, 2654208
  buffer_load_dwordx4 v12, s[40:43], s35 offen lds
  s_add_u32 m0, s100, 51200
  s_add_u32 s35, s98, 2686976
  buffer_load_dwordx4 v13, s[40:43], s35 offen lds
  s_add_u32 m0, s100, 52224
  s_add_u32 s35, s98, 2719744
  buffer_load_dwordx4 v13, s[40:43], s35 offen lds
  s_add_u32 m0, s100, 65536
  s_add_u32 s35, s98, 3670016
  buffer_load_dwordx4 v12, s[40:43], s35 offen lds
  s_add_u32 m0, s100, 66560
  s_add_u32 s35, s98, 3702784
  buffer_load_dwordx4 v12, s[40:43], s35 offen lds
  s_add_u32 m0, s100, 67584
  s_add_u32 s35, s98, 3735552
  buffer_load_dwordx4 v13, s[40:43], s35 offen lds
  s_add_u32 m0, s100, 68608
  s_add_u32 s35, s98, 3768320
  buffer_load_dwordx4 v13, s[40:43], s35 offen lds
  s_add_u32 m0, s100, 81920
  s_add_u32 s35, s98, 0
  buffer_load_dwordx4 v12, s[44:47], s35 offen lds
  s_add_u32 m0, s100, 82944
  s_add_u32 s35, s98, 32768
  buffer_load_dwordx4 v12, s[44:47], s35 offen lds
  s_add_u32 m0, s100, 83968
  s_add_u32 s35, s98, 65536
  buffer_load_dwordx4 v13, s[44:47], s35 offen lds
  s_add_u32 m0, s100, 84992
  s_add_u32 s35, s98, 98304
  buffer_load_dwordx4 v13, s[44:47], s35 offen lds
  s_add_u32 m0, s100, 98304
  s_add_u32 s35, s98, 524288
  buffer_load_dwordx4 v12, s[44:47], s35 offen lds
  s_add_u32 m0, s100, 99328
  s_add_u32 s35, s98, 557056
  buffer_load_dwordx4 v12, s[44:47], s35 offen lds
  s_add_u32 m0, s100, 100352
  s_add_u32 s35, s98, 589824
  buffer_load_dwordx4 v13, s[44:47], s35 offen lds
  s_add_u32 m0, s100, 101376
  s_add_u32 s35, s98, 622592
  buffer_load_dwordx4 v13, s[44:47], s35 offen lds
  s_add_u32 m0, s100, 114688
  s_add_u32 s35, s98, 1048576
  buffer_load_dwordx4 v12, s[44:47], s35 offen lds
  s_add_u32 m0, s100, 115712
  s_add_u32 s35, s98, 1081344
  buffer_load_dwordx4 v12, s[44:47], s35 offen lds
  s_add_u32 m0, s100, 116736
  s_add_u32 s35, s98, 1114112
  buffer_load_dwordx4 v13, s[44:47], s35 offen lds
  s_add_u32 m0, s100, 117760
  s_add_u32 s35, s98, 1146880
  buffer_load_dwordx4 v13, s[44:47], s35 offen lds
  s_add_u32 m0, s100, 131072
  s_add_u32 s35, s98, 1572864
  buffer_load_dwordx4 v12, s[44:47], s35 offen lds
  s_add_u32 m0, s100, 132096
  s_add_u32 s35, s98, 1605632
  buffer_load_dwordx4 v12, s[44:47], s35 offen lds
  s_add_u32 m0, s100, 133120
  s_add_u32 s35, s98, 1638400
  buffer_load_dwordx4 v13, s[44:47], s35 offen lds
  s_add_u32 m0, s100, 134144
  s_add_u32 s35, s98, 1671168
  buffer_load_dwordx4 v13, s[44:47], s35 offen lds
  v_lshrrev_b32 v23, 2, v21
  v_and_b32 v19, 1, v23
  v_lshlrev_b32 v19, 1, v19
  v_and_b32 v20, 1, v22
  v_or_b32 v19, v19, v20
  v_lshrrev_b32 v20, 1, v23
  v_lshl_or_b32 v24, v20, 2, v19
  v_lshl_or_b32 v25, v20, 3, v19
  v_lshrrev_b32 v26, 1, v22
  v_lshl_or_b32 v25, v26, 4, v25
  v_lshlrev_b32 v25, 8, v25
  v_and_b32 v26, 3, v0
  v_lshlrev_b32 v26, 3, v26
  v_add_u32 v25, v25, v26
  s_lshl_b32 s35, s94, 1
  v_xor_b32 v27, s35, v24
  v_lshl_add_u32 v16, v27, 5, v25
  v_xor_b32 v27, 1, v27
  v_lshl_add_u32 v17, v27, 5, v25
  v_and_b32 v24, 1, v22
  v_lshlrev_b32 v25, 5, v24
  v_lshl_or_b32 v25, v20, 4, v25
  v_lshrrev_b32 v27, 1, v22
  v_lshl_or_b32 v25, v27, 2, v25
  v_and_b32 v27, 1, v23
  v_or_b32 v25, v25, v27
  v_lshlrev_b32 v25, 7, v25
  v_add_u32 v25, v25, v26
  v_lshl_or_b32 v24, v24, 1, v20
  v_xor_b32 v24, s94, v24
  v_lshl_add_u32 v18, v24, 5, v25
  s_waitcnt vmcnt(32)
  s_barrier
  s_cmp_eq_u32 s94, 0
  s_cbranch_scc0 CH_CINIT_SKIP
  s_mov_b64 exec, 1
  v_mov_b32 v26, 1
  v_mov_b32 v27, 12
  buffer_atomic_add v26, v27, s[28:31], 0 offen
  s_mov_b64 exec, -1
CH_CINIT_SKIP:
  s_mov_b32 s35, 16384
  v_add_u32 v24, s35, v16
  v_add_u32 v25, s35, v17
  ds_read_b64_tr_b16 a[0:1], v24 offset:0
  ds_read_b64_tr_b16 a[2:3], v24 offset:1024
  ds_read_b64_tr_b16 a[4:5], v24 offset:8192
  ds_read_b64_tr_b16 a[6:7], v24 offset:9216
  ds_read_b64_tr_b16 a[8:9], v25 offset:0
  ds_read_b64_tr_b16 a[10:11], v25 offset:1024
  ds_read_b64_tr_b16 a[12:13], v25 offset:8192
  ds_read_b64_tr_b16 a[14:15], v25 offset:9216
  s_waitcnt lgkmcnt(0)
  s_waitcnt vmcnt(28)
  s_barrier
  s_add_u32 m0, s100, 0
  s_add_u32 s35, s98, 2097152
  buffer_load_dwordx4 v12, s[44:47], s35 offen lds
  s_add_u32 m0, s100, 1024
  s_add_u32 s35, s98, 2129920
  buffer_load_dwordx4 v12, s[44:47], s35 offen lds
  s_add_u32 m0, s100, 2048
  s_add_u32 s35, s98, 2162688
  buffer_load_dwordx4 v13, s[44:47], s35 offen lds
  s_add_u32 m0, s100, 3072
  s_add_u32 s35, s98, 2195456
  buffer_load_dwordx4 v13, s[44:47], s35 offen lds
  s_mov_b32 s35, 32768
  v_add_u32 v24, s35, v16
  v_add_u32 v25, s35, v17
  ds_read_b64_tr_b16 a[16:17], v24 offset:0
  ds_read_b64_tr_b16 a[18:19], v24 offset:1024
  ds_read_b64_tr_b16 a[20:21], v24 offset:8192
  ds_read_b64_tr_b16 a[22:23], v24 offset:9216
  ds_read_b64_tr_b16 a[24:25], v25 offset:0
  ds_read_b64_tr_b16 a[26:27], v25 offset:1024
  ds_read_b64_tr_b16 a[28:29], v25 offset:8192
  ds_read_b64_tr_b16 a[30:31], v25 offset:9216
  s_waitcnt lgkmcnt(0)
  s_waitcnt vmcnt(28)
  s_barrier
  s_add_u32 m0, s100, 16384
  s_add_u32 s35, s98, 2621440
  buffer_load_dwordx4 v12, s[44:47], s35 offen lds
  s_add_u32 m0, s100, 17408
  s_add_u32 s35, s98, 2654208
  buffer_load_dwordx4 v12, s[44:47], s35 offen lds
  s_add_u32 m0, s100, 18432
  s_add_u32 s35, s98, 2686976
  buffer_load_dwordx4 v13, s[44:47], s35 offen lds
  s_add_u32 m0, s100, 19456
  s_add_u32 s35, s98, 2719744
  buffer_load_dwordx4 v13, s[44:47], s35 offen lds
  s_mov_b32 s35, 49152
  v_add_u32 v24, s35, v16
  v_add_u32 v25, s35, v17
  ds_read_b64_tr_b16 a[32:33], v24 offset:0
  ds_read_b64_tr_b16 a[34:35], v24 offset:1024
  ds_read_b64_tr_b16 a[36:37], v24 offset:8192
  ds_read_b64_tr_b16 a[38:39], v24 offset:9216
  ds_read_b64_tr_b16 a[40:41], v25 offset:0
  ds_read_b64_tr_b16 a[42:43], v25 offset:1024
  ds_read_b64_tr_b16 a[44:45], v25 offset:8192
  ds_read_b64_tr_b16 a[46:47], v25 offset:9216
  s_waitcnt lgkmcnt(0)
  s_waitcnt vmcnt(28)
  s_barrier
  s_add_u32 m0, s100, 32768
  s_add_u32 s35, s98, 3145728
  buffer_load_dwordx4 v12, s[44:47], s35 offen lds
  s_add_u32 m0, s100, 33792
  s_add_u32 s35, s98, 3178496
  buffer_load_dwordx4 v12, s[44:47], s35 offen lds
  s_add_u32 m0, s100, 34816
  s_add_u32 s35, s98, 3211264
  buffer_load_dwordx4 v13, s[44:47], s35 offen lds
  s_add_u32 m0, s100, 35840
  s_add_u32 s35, s98, 3244032
  buffer_load_dwordx4 v13, s[44:47], s35 offen lds
  s_mov_b32 s35, 65536
  v_add_u32 v24, s35, v16
  v_add_u32 v25, s35, v17
  ds_read_b64_tr_b16 a[48:49], v24 offset:0
  ds_read_b64_tr_b16 a[50:51], v24 offset:1024
  ds_read_b64_tr_b16 a[52:53], v24 offset:8192
  ds_read_b64_tr_b16 a[54:55], v24 offset:9216
  ds_read_b64_tr_b16 a[56:57], v25 offset:0
  ds_read_b64_tr_b16 a[58:59], v25 offset:1024
  ds_read_b64_tr_b16 a[60:61], v25 offset:8192
  ds_read_b64_tr_b16 a[62:63], v25 offset:9216
  s_waitcnt lgkmcnt(0)
  s_waitcnt vmcnt(28)
  s_barrier
  s_add_u32 m0, s100, 49152
  s_add_u32 s35, s98, 3670016
  buffer_load_dwordx4 v12, s[44:47], s35 offen lds
  s_add_u32 m0, s100, 50176
  s_add_u32 s35, s98, 3702784
  buffer_load_dwordx4 v12, s[44:47], s35 offen lds
  s_add_u32 m0, s100, 51200
  s_add_u32 s35, s98, 3735552
  buffer_load_dwordx4 v13, s[44:47], s35 offen lds
  s_add_u32 m0, s100, 52224
  s_add_u32 s35, s98, 3768320
  buffer_load_dwordx4 v13, s[44:47], s35 offen lds
  s_mov_b32 s35, 81920
  v_add_u32 v24, s35, v16
  v_add_u32 v25, s35, v17
  ds_read_b64_tr_b16 a[64:65], v24 offset:0
  ds_read_b64_tr_b16 a[66:67], v24 offset:1024
  ds_read_b64_tr_b16 a[68:69], v24 offset:8192
  ds_read_b64_tr_b16 a[70:71], v24 offset:9216
  ds_read_b64_tr_b16 a[72:73], v25 offset:0
  ds_read_b64_tr_b16 a[74:75], v25 offset:1024
  ds_read_b64_tr_b16 a[76:77], v25 offset:8192
  ds_read_b64_tr_b16 a[78:79], v25 offset:9216
  s_waitcnt lgkmcnt(0)
  s_waitcnt vmcnt(28)
  s_barrier
  s_add_u32 m0, s100, 65536
  s_add_u32 s35, s98, 4194304
  buffer_load_dwordx4 v12, s[44:47], s35 offen lds
  s_add_u32 m0, s100, 66560
  s_add_u32 s35, s98, 4227072
  buffer_load_dwordx4 v12, s[44:47], s35 offen lds
  s_add_u32 m0, s100, 67584
  s_add_u32 s35, s98, 4259840
  buffer_load_dwordx4 v13, s[44:47], s35 offen lds
  s_add_u32 m0, s100, 68608
  s_add_u32 s35, s98, 4292608
  buffer_load_dwordx4 v13, s[44:47], s35 offen lds
  s_mov_b32 s35, 98304
  v_add_u32 v24, s35, v16
  v_add_u32 v25, s35, v17
  ds_read_b64_tr_b16 a[80:81], v24 offset:0
  ds_read_b64_tr_b16 a[82:83], v24 offset:1024
  ds_read_b64_tr_b16 a[84:85], v24 offset:8192
  ds_read_b64_tr_b16 a[86:87], v24 offset:9216
  ds_read_b64_tr_b16 a[88:89], v25 offset:0
  ds_read_b64_tr_b16 a[90:91], v25 offset:1024
  ds_read_b64_tr_b16 a[92:93], v25 offset:8192
  ds_read_b64_tr_b16 a[94:95], v25 offset:9216
  s_waitcnt lgkmcnt(0)
  s_waitcnt vmcnt(28)
  s_barrier
  s_add_u32 m0, s100, 81920
  s_add_u32 s35, s98, 524288
  buffer_load_dwordx4 v12, s[36:39], s35 offen lds
  s_add_u32 m0, s100, 82944
  s_add_u32 s35, s98, 557056
  buffer_load_dwordx4 v12, s[36:39], s35 offen lds
  s_add_u32 m0, s100, 83968
  s_add_u32 s35, s98, 589824
  buffer_load_dwordx4 v13, s[36:39], s35 offen lds
  s_add_u32 m0, s100, 84992
  s_add_u32 s35, s98, 622592
  buffer_load_dwordx4 v13, s[36:39], s35 offen lds
  s_mov_b32 s35, 114688
  v_add_u32 v24, s35, v16
  v_add_u32 v25, s35, v17
  ds_read_b64_tr_b16 a[96:97], v24 offset:0
  ds_read_b64_tr_b16 a[98:99], v24 offset:1024
  ds_read_b64_tr_b16 a[100:101], v24 offset:8192
  ds_read_b64_tr_b16 a[102:103], v24 offset:9216
  ds_read_b64_tr_b16 a[104:105], v25 offset:0
  ds_read_b64_tr_b16 a[106:107], v25 offset:1024
  ds_read_b64_tr_b16 a[108:109], v25 offset:8192
  ds_read_b64_tr_b16 a[110:111], v25 offset:9216
  s_waitcnt lgkmcnt(0)
  s_waitcnt vmcnt(28)
  s_barrier
  s_add_u32 m0, s100, 98304
  s_add_u32 s35, s98, 1572864
  buffer_load_dwordx4 v12, s[36:39], s35 offen lds
  s_add_u32 m0, s100, 99328
  s_add_u32 s35, s98, 1605632
  buffer_load_dwordx4 v12, s[36:39], s35 offen lds
  s_add_u32 m0, s100, 100352
  s_add_u32 s35, s98, 1638400
  buffer_load_dwordx4 v13, s[36:39], s35 offen lds
  s_add_u32 m0, s100, 101376
  s_add_u32 s35, s98, 1671168
  buffer_load_dwordx4 v13, s[36:39], s35 offen lds
  s_mov_b32 s35, 131072
  v_add_u32 v24, s35, v16
  v_add_u32 v25, s35, v17
  ds_read_b64_tr_b16 a[112:113], v24 offset:0
  ds_read_b64_tr_b16 a[114:115], v24 offset:1024
  ds_read_b64_tr_b16 a[116:117], v24 offset:8192
  ds_read_b64_tr_b16 a[118:119], v24 offset:9216
  ds_read_b64_tr_b16 a[120:121], v25 offset:0
  ds_read_b64_tr_b16 a[122:123], v25 offset:1024
  ds_read_b64_tr_b16 a[124:125], v25 offset:8192
  ds_read_b64_tr_b16 a[126:127], v25 offset:9216
  s_waitcnt lgkmcnt(0)
  s_waitcnt vmcnt(28)
  s_barrier
  s_add_u32 m0, s100, 114688
  s_add_u32 s35, s98, 2097152
  buffer_load_dwordx4 v12, s[36:39], s35 offen lds
  s_add_u32 m0, s100, 115712
  s_add_u32 s35, s98, 2129920
  buffer_load_dwordx4 v12, s[36:39], s35 offen lds
  s_add_u32 m0, s100, 116736
  s_add_u32 s35, s98, 2162688
  buffer_load_dwordx4 v13, s[36:39], s35 offen lds
  s_add_u32 m0, s100, 117760
  s_add_u32 s35, s98, 2195456
  buffer_load_dwordx4 v13, s[36:39], s35 offen lds
  s_mov_b32 s35, 147456
  v_add_u32 v24, s35, v16
  v_add_u32 v25, s35, v17
  ds_read_b64_tr_b16 a[128:129], v24 offset:0
  ds_read_b64_tr_b16 a[130:131], v24 offset:1024
  ds_read_b64_tr_b16 a[132:133], v24 offset:8192
  ds_read_b64_tr_b16 a[134:135], v24 offset:9216
  ds_read_b64_tr_b16 a[136:137], v25 offset:0
  ds_read_b64_tr_b16 a[138:139], v25 offset:1024
  ds_read_b64_tr_b16 a[140:141], v25 offset:8192
  ds_read_b64_tr_b16 a[142:143], v25 offset:9216
  s_waitcnt lgkmcnt(0)
  s_waitcnt vmcnt(28)
  s_barrier
  s_add_u32 m0, s100, 131072
  s_add_u32 s35, s98, 3145728
  buffer_load_dwordx4 v12, s[36:39], s35 offen lds
  s_add_u32 m0, s100, 132096
  s_add_u32 s35, s98, 3178496
  buffer_load_dwordx4 v12, s[36:39], s35 offen lds
  s_add_u32 m0, s100, 133120
  s_add_u32 s35, s98, 3211264
  buffer_load_dwordx4 v13, s[36:39], s35 offen lds
  s_add_u32 m0, s100, 134144
  s_add_u32 s35, s98, 3244032
  buffer_load_dwordx4 v13, s[36:39], s35 offen lds
  s_mov_b32 s35, 16384
  v_add_u32 v24, s35, v16
  v_add_u32 v25, s35, v17
  ds_read_b64_tr_b16 a[144:145], v24 offset:0
  ds_read_b64_tr_b16 a[146:147], v24 offset:1024
  ds_read_b64_tr_b16 a[148:149], v24 offset:8192
  ds_read_b64_tr_b16 a[150:151], v24 offset:9216
  ds_read_b64_tr_b16 a[152:153], v25 offset:0
  ds_read_b64_tr_b16 a[154:155], v25 offset:1024
  ds_read_b64_tr_b16 a[156:157], v25 offset:8192
  ds_read_b64_tr_b16 a[158:159], v25 offset:9216
  s_waitcnt lgkmcnt(0)
  s_waitcnt vmcnt(28)
  s_barrier
  s_add_u32 m0, s100, 0
  s_add_u32 s35, s98, 3670016
  buffer_load_dwordx4 v12, s[36:39], s35 offen lds
  s_add_u32 m0, s100, 1024
  s_add_u32 s35, s98, 3702784
  buffer_load_dwordx4 v12, s[36:39], s35 offen lds
  s_add_u32 m0, s100, 2048
  s_add_u32 s35, s98, 3735552
  buffer_load_dwordx4 v13, s[36:39], s35 offen lds
  s_add_u32 m0, s100, 3072
  s_add_u32 s35, s98, 3768320
  buffer_load_dwordx4 v13, s[36:39], s35 offen lds
  s_mov_b32 s35, 32768
  v_add_u32 v24, s35, v16
  v_add_u32 v25, s35, v17
  ds_read_b64_tr_b16 a[160:161], v24 offset:0
  ds_read_b64_tr_b16 a[162:163], v24 offset:1024
  ds_read_b64_tr_b16 a[164:165], v24 offset:8192
  ds_read_b64_tr_b16 a[166:167], v24 offset:9216
  ds_read_b64_tr_b16 a[168:169], v25 offset:0
  ds_read_b64_tr_b16 a[170:171], v25 offset:1024
  ds_read_b64_tr_b16 a[172:173], v25 offset:8192
  ds_read_b64_tr_b16 a[174:175], v25 offset:9216
  s_waitcnt lgkmcnt(0)
  s_waitcnt vmcnt(28)
  s_barrier
  s_add_u32 m0, s100, 16384
  s_add_u32 s35, s98, 4194304
  buffer_load_dwordx4 v12, s[36:39], s35 offen lds
  s_add_u32 m0, s100, 17408
  s_add_u32 s35, s98, 4227072
  buffer_load_dwordx4 v12, s[36:39], s35 offen lds
  s_add_u32 m0, s100, 18432
  s_add_u32 s35, s98, 4259840
  buffer_load_dwordx4 v13, s[36:39], s35 offen lds
  s_add_u32 m0, s100, 19456
  s_add_u32 s35, s98, 4292608
  buffer_load_dwordx4 v13, s[36:39], s35 offen lds
  s_mov_b32 s35, 49152
  v_add_u32 v24, s35, v16
  v_add_u32 v25, s35, v17
  ds_read_b64_tr_b16 a[176:177], v24 offset:0
  ds_read_b64_tr_b16 a[178:179], v24 offset:1024
  ds_read_b64_tr_b16 a[180:181], v24 offset:8192
  ds_read_b64_tr_b16 a[182:183], v24 offset:9216
  ds_read_b64_tr_b16 a[184:185], v25 offset:0
  ds_read_b64_tr_b16 a[186:187], v25 offset:1024
  ds_read_b64_tr_b16 a[188:189], v25 offset:8192
  ds_read_b64_tr_b16 a[190:191], v25 offset:9216
  s_waitcnt lgkmcnt(0)
  s_waitcnt vmcnt(28)
  s_barrier
  s_add_u32 m0, s100, 32768
  s_add_u32 s35, s99, 0
  buffer_load_dwordx4 v14, s[48:51], s35 offen lds
  s_add_u32 m0, s100, 33792
  s_add_u32 s35, s99, 9216
  buffer_load_dwordx4 v14, s[48:51], s35 offen lds
  s_add_u32 m0, s100, 34816
  s_add_u32 s35, s99, 18432
  buffer_load_dwordx4 v15, s[48:51], s35 offen lds
  s_add_u32 m0, s100, 35840
  s_add_u32 s35, s99, 27648
  buffer_load_dwordx4 v15, s[48:51], s35 offen lds
  s_mov_b32 s35, 65536
  v_add_u32 v24, s35, v16
  v_add_u32 v25, s35, v17
  ds_read_b64_tr_b16 a[192:193], v24 offset:0
  ds_read_b64_tr_b16 a[194:195], v24 offset:1024
  ds_read_b64_tr_b16 a[196:197], v24 offset:8192
  ds_read_b64_tr_b16 a[198:199], v24 offset:9216
  ds_read_b64_tr_b16 a[200:201], v25 offset:0
  ds_read_b64_tr_b16 a[202:203], v25 offset:1024
  ds_read_b64_tr_b16 a[204:205], v25 offset:8192
  ds_read_b64_tr_b16 a[206:207], v25 offset:9216
  s_waitcnt lgkmcnt(0)
  s_waitcnt vmcnt(28)
  s_barrier
  s_add_u32 m0, s100, 49152
  s_add_u32 s35, s99, 256
  buffer_load_dwordx4 v14, s[48:51], s35 offen lds
  s_add_u32 m0, s100, 50176
  s_add_u32 s35, s99, 9472
  buffer_load_dwordx4 v14, s[48:51], s35 offen lds
  s_add_u32 m0, s100, 51200
  s_add_u32 s35, s99, 18688
  buffer_load_dwordx4 v15, s[48:51], s35 offen lds
  s_add_u32 m0, s100, 52224
  s_add_u32 s35, s99, 27904
  buffer_load_dwordx4 v15, s[48:51], s35 offen lds
  s_mov_b32 s35, 81920
  v_add_u32 v24, s35, v16
  v_add_u32 v25, s35, v17
  ds_read_b64_tr_b16 a[208:209], v24 offset:0
  ds_read_b64_tr_b16 a[210:211], v24 offset:1024
  ds_read_b64_tr_b16 a[212:213], v24 offset:8192
  ds_read_b64_tr_b16 a[214:215], v24 offset:9216
  ds_read_b64_tr_b16 a[216:217], v25 offset:0
  ds_read_b64_tr_b16 a[218:219], v25 offset:1024
  ds_read_b64_tr_b16 a[220:221], v25 offset:8192
  ds_read_b64_tr_b16 a[222:223], v25 offset:9216
  s_waitcnt lgkmcnt(0)
  s_waitcnt vmcnt(28)
  s_barrier
  s_add_u32 m0, s100, 65536
  s_add_u32 s35, s99, 512
  buffer_load_dwordx4 v14, s[48:51], s35 offen lds
  s_add_u32 m0, s100, 66560
  s_add_u32 s35, s99, 9728
  buffer_load_dwordx4 v14, s[48:51], s35 offen lds
  s_add_u32 m0, s100, 67584
  s_add_u32 s35, s99, 18944
  buffer_load_dwordx4 v15, s[48:51], s35 offen lds
  s_add_u32 m0, s100, 68608
  s_add_u32 s35, s99, 28160
  buffer_load_dwordx4 v15, s[48:51], s35 offen lds
  s_mov_b32 s35, 98304
  v_add_u32 v24, s35, v16
  v_add_u32 v25, s35, v17
  ds_read_b64_tr_b16 v[48:49], v24 offset:0
  ds_read_b64_tr_b16 v[50:51], v24 offset:1024
  ds_read_b64_tr_b16 v[52:53], v24 offset:8192
  ds_read_b64_tr_b16 v[54:55], v24 offset:9216
  ds_read_b64_tr_b16 v[56:57], v25 offset:0
  ds_read_b64_tr_b16 v[58:59], v25 offset:1024
  ds_read_b64_tr_b16 v[60:61], v25 offset:8192
  ds_read_b64_tr_b16 v[62:63], v25 offset:9216
  s_waitcnt lgkmcnt(0)
  s_mov_b32 s35, 0x3e0293ee
  v_lshlrev_b32 v26, 16, v48
  v_and_b32 v27, 0xffff0000, v48
  v_mul_f32 v26, s35, v26
  v_mul_f32 v27, s35, v27
  v_cvt_pk_bf16_f32 v48, v26, v27
  v_accvgpr_write_b32 a224, v48
  v_lshlrev_b32 v26, 16, v49
  v_and_b32 v27, 0xffff0000, v49
  v_mul_f32 v26, s35, v26
  v_mul_f32 v27, s35, v27
  v_cvt_pk_bf16_f32 v49, v26, v27
  v_accvgpr_write_b32 a225, v49
  v_lshlrev_b32 v26, 16, v50
  v_and_b32 v27, 0xffff0000, v50
  v_mul_f32 v26, s35, v26
  v_mul_f32 v27, s35, v27
  v_cvt_pk_bf16_f32 v50, v26, v27
  v_accvgpr_write_b32 a226, v50
  v_lshlrev_b32 v26, 16, v51
  v_and_b32 v27, 0xffff0000, v51
  v_mul_f32 v26, s35, v26
  v_mul_f32 v27, s35, v27
  v_cvt_pk_bf16_f32 v51, v26, v27
  v_accvgpr_write_b32 a227, v51
  v_lshlrev_b32 v26, 16, v52
  v_and_b32 v27, 0xffff0000, v52
  v_mul_f32 v26, s35, v26
  v_mul_f32 v27, s35, v27
  v_cvt_pk_bf16_f32 v52, v26, v27
  v_accvgpr_write_b32 a228, v52
  v_lshlrev_b32 v26, 16, v53
  v_and_b32 v27, 0xffff0000, v53
  v_mul_f32 v26, s35, v26
  v_mul_f32 v27, s35, v27
  v_cvt_pk_bf16_f32 v53, v26, v27
  v_accvgpr_write_b32 a229, v53
  v_lshlrev_b32 v26, 16, v54
  v_and_b32 v27, 0xffff0000, v54
  v_mul_f32 v26, s35, v26
  v_mul_f32 v27, s35, v27
  v_cvt_pk_bf16_f32 v54, v26, v27
  v_accvgpr_write_b32 a230, v54
  v_lshlrev_b32 v26, 16, v55
  v_and_b32 v27, 0xffff0000, v55
  v_mul_f32 v26, s35, v26
  v_mul_f32 v27, s35, v27
  v_cvt_pk_bf16_f32 v55, v26, v27
  v_accvgpr_write_b32 a231, v55
  v_lshlrev_b32 v26, 16, v56
  v_and_b32 v27, 0xffff0000, v56
  v_mul_f32 v26, s35, v26
  v_mul_f32 v27, s35, v27
  v_cvt_pk_bf16_f32 v56, v26, v27
  v_accvgpr_write_b32 a232, v56
  v_lshlrev_b32 v26, 16, v57
  v_and_b32 v27, 0xffff0000, v57
  v_mul_f32 v26, s35, v26
  v_mul_f32 v27, s35, v27
  v_cvt_pk_bf16_f32 v57, v26, v27
  v_accvgpr_write_b32 a233, v57
  v_lshlrev_b32 v26, 16, v58
  v_and_b32 v27, 0xffff0000, v58
  v_mul_f32 v26, s35, v26
  v_mul_f32 v27, s35, v27
  v_cvt_pk_bf16_f32 v58, v26, v27
  v_accvgpr_write_b32 a234, v58
  v_lshlrev_b32 v26, 16, v59
  v_and_b32 v27, 0xffff0000, v59
  v_mul_f32 v26, s35, v26
  v_mul_f32 v27, s35, v27
  v_cvt_pk_bf16_f32 v59, v26, v27
  v_accvgpr_write_b32 a235, v59
  v_lshlrev_b32 v26, 16, v60
  v_and_b32 v27, 0xffff0000, v60
  v_mul_f32 v26, s35, v26
  v_mul_f32 v27, s35, v27
  v_cvt_pk_bf16_f32 v60, v26, v27
  v_accvgpr_write_b32 a236, v60
  v_lshlrev_b32 v26, 16, v61
  v_and_b32 v27, 0xffff0000, v61
  v_mul_f32 v26, s35, v26
  v_mul_f32 v27, s35, v27
  v_cvt_pk_bf16_f32 v61, v26, v27
  v_accvgpr_write_b32 a237, v61
  v_lshlrev_b32 v26, 16, v62
  v_and_b32 v27, 0xffff0000, v62
  v_mul_f32 v26, s35, v26
  v_mul_f32 v27, s35, v27
  v_cvt_pk_bf16_f32 v62, v26, v27
  v_accvgpr_write_b32 a238, v62
  v_lshlrev_b32 v26, 16, v63
  v_and_b32 v27, 0xffff0000, v63
  v_mul_f32 v26, s35, v26
  v_mul_f32 v27, s35, v27
  v_cvt_pk_bf16_f32 v63, v26, v27
  v_accvgpr_write_b32 a239, v63
  s_waitcnt vmcnt(28)
  s_barrier
  s_add_u32 m0, s100, 81920
  s_add_u32 s35, s99, 640
  buffer_load_dwordx4 v14, s[48:51], s35 offen lds
  s_add_u32 m0, s100, 82944
  s_add_u32 s35, s99, 9856
  buffer_load_dwordx4 v14, s[48:51], s35 offen lds
  s_add_u32 m0, s100, 83968
  s_add_u32 s35, s99, 19072
  buffer_load_dwordx4 v15, s[48:51], s35 offen lds
  s_add_u32 m0, s100, 84992
  s_add_u32 s35, s99, 28288
  buffer_load_dwordx4 v15, s[48:51], s35 offen lds
  s_mov_b32 s35, 114688
  v_add_u32 v24, s35, v16
  v_add_u32 v25, s35, v17
  ds_read_b64_tr_b16 v[48:49], v24 offset:0
  ds_read_b64_tr_b16 v[50:51], v24 offset:1024
  ds_read_b64_tr_b16 v[52:53], v24 offset:8192
  ds_read_b64_tr_b16 v[54:55], v24 offset:9216
  ds_read_b64_tr_b16 v[56:57], v25 offset:0
  ds_read_b64_tr_b16 v[58:59], v25 offset:1024
  ds_read_b64_tr_b16 v[60:61], v25 offset:8192
  ds_read_b64_tr_b16 v[62:63], v25 offset:9216
  s_waitcnt lgkmcnt(0)
  s_mov_b32 s35, 0x3e0293ee
  v_lshlrev_b32 v26, 16, v48
  v_and_b32 v27, 0xffff0000, v48
  v_mul_f32 v26, s35, v26
  v_mul_f32 v27, s35, v27
  v_cvt_pk_bf16_f32 v48, v26, v27
  v_accvgpr_write_b32 a240, v48
  v_lshlrev_b32 v26, 16, v49
  v_and_b32 v27, 0xffff0000, v49
  v_mul_f32 v26, s35, v26
  v_mul_f32 v27, s35, v27
  v_cvt_pk_bf16_f32 v49, v26, v27
  v_accvgpr_write_b32 a241, v49
  v_lshlrev_b32 v26, 16, v50
  v_and_b32 v27, 0xffff0000, v50
  v_mul_f32 v26, s35, v26
  v_mul_f32 v27, s35, v27
  v_cvt_pk_bf16_f32 v50, v26, v27
  v_accvgpr_write_b32 a242, v50
  v_lshlrev_b32 v26, 16, v51
  v_and_b32 v27, 0xffff0000, v51
  v_mul_f32 v26, s35, v26
  v_mul_f32 v27, s35, v27
  v_cvt_pk_bf16_f32 v51, v26, v27
  v_accvgpr_write_b32 a243, v51
  v_lshlrev_b32 v26, 16, v52
  v_and_b32 v27, 0xffff0000, v52
  v_mul_f32 v26, s35, v26
  v_mul_f32 v27, s35, v27
  v_cvt_pk_bf16_f32 v52, v26, v27
  v_accvgpr_write_b32 a244, v52
  v_lshlrev_b32 v26, 16, v53
  v_and_b32 v27, 0xffff0000, v53
  v_mul_f32 v26, s35, v26
  v_mul_f32 v27, s35, v27
  v_cvt_pk_bf16_f32 v53, v26, v27
  v_accvgpr_write_b32 a245, v53
  v_lshlrev_b32 v26, 16, v54
  v_and_b32 v27, 0xffff0000, v54
  v_mul_f32 v26, s35, v26
  v_mul_f32 v27, s35, v27
  v_cvt_pk_bf16_f32 v54, v26, v27
  v_accvgpr_write_b32 a246, v54
  v_lshlrev_b32 v26, 16, v55
  v_and_b32 v27, 0xffff0000, v55
  v_mul_f32 v26, s35, v26
  v_mul_f32 v27, s35, v27
  v_cvt_pk_bf16_f32 v55, v26, v27
  v_accvgpr_write_b32 a247, v55
  v_lshlrev_b32 v26, 16, v56
  v_and_b32 v27, 0xffff0000, v56
  v_mul_f32 v26, s35, v26
  v_mul_f32 v27, s35, v27
  v_cvt_pk_bf16_f32 v56, v26, v27
  v_accvgpr_write_b32 a248, v56
  v_lshlrev_b32 v26, 16, v57
  v_and_b32 v27, 0xffff0000, v57
  v_mul_f32 v26, s35, v26
  v_mul_f32 v27, s35, v27
  v_cvt_pk_bf16_f32 v57, v26, v27
  v_accvgpr_write_b32 a249, v57
  v_lshlrev_b32 v26, 16, v58
  v_and_b32 v27, 0xffff0000, v58
  v_mul_f32 v26, s35, v26
  v_mul_f32 v27, s35, v27
  v_cvt_pk_bf16_f32 v58, v26, v27
  v_accvgpr_write_b32 a250, v58
  v_lshlrev_b32 v26, 16, v59
  v_and_b32 v27, 0xffff0000, v59
  v_mul_f32 v26, s35, v26
  v_mul_f32 v27, s35, v27
  v_cvt_pk_bf16_f32 v59, v26, v27
  v_accvgpr_write_b32 a251, v59
  v_lshlrev_b32 v26, 16, v60
  v_and_b32 v27, 0xffff0000, v60
  v_mul_f32 v26, s35, v26
  v_mul_f32 v27, s35, v27
  v_cvt_pk_bf16_f32 v60, v26, v27
  v_accvgpr_write_b32 a252, v60
  v_lshlrev_b32 v26, 16, v61
  v_and_b32 v27, 0xffff0000, v61
  v_mul_f32 v26, s35, v26
  v_mul_f32 v27, s35, v27
  v_cvt_pk_bf16_f32 v61, v26, v27
  v_accvgpr_write_b32 a253, v61
  v_lshlrev_b32 v26, 16, v62
  v_and_b32 v27, 0xffff0000, v62
  v_mul_f32 v26, s35, v26
  v_mul_f32 v27, s35, v27
  v_cvt_pk_bf16_f32 v62, v26, v27
  v_accvgpr_write_b32 a254, v62
  v_lshlrev_b32 v26, 16, v63
  v_and_b32 v27, 0xffff0000, v63
  v_mul_f32 v26, s35, v26
  v_mul_f32 v27, s35, v27
  v_cvt_pk_bf16_f32 v63, v26, v27
  v_accvgpr_write_b32 a255, v63
  s_waitcnt vmcnt(28)
  s_barrier
  s_add_u32 m0, s100, 98304
  s_add_u32 s35, s99, 768
  buffer_load_dwordx4 v14, s[48:51], s35 offen lds
  s_add_u32 m0, s100, 99328
  s_add_u32 s35, s99, 9984
  buffer_load_dwordx4 v14, s[48:51], s35 offen lds
  s_add_u32 m0, s100, 100352
  s_add_u32 s35, s99, 19200
  buffer_load_dwordx4 v15, s[48:51], s35 offen lds
  s_add_u32 m0, s100, 101376
  s_add_u32 s35, s99, 28416
  buffer_load_dwordx4 v15, s[48:51], s35 offen lds
  s_mov_b32 s35, 131072
  v_add_u32 v24, s35, v16
  v_add_u32 v25, s35, v17
  ds_read_b64_tr_b16 v[48:49], v24 offset:0
  ds_read_b64_tr_b16 v[50:51], v24 offset:1024
  ds_read_b64_tr_b16 v[52:53], v24 offset:8192
  ds_read_b64_tr_b16 v[54:55], v24 offset:9216
  ds_read_b64_tr_b16 v[56:57], v25 offset:0
  ds_read_b64_tr_b16 v[58:59], v25 offset:1024
  ds_read_b64_tr_b16 v[60:61], v25 offset:8192
  ds_read_b64_tr_b16 v[62:63], v25 offset:9216
  s_waitcnt lgkmcnt(0)
  s_mov_b32 s35, 0x3e0293ee
  v_lshlrev_b32 v26, 16, v48
  v_and_b32 v27, 0xffff0000, v48
  v_mul_f32 v26, s35, v26
  v_mul_f32 v27, s35, v27
  v_cvt_pk_bf16_f32 v48, v26, v27
  v_mov_b32 v80, v48
  v_lshlrev_b32 v26, 16, v49
  v_and_b32 v27, 0xffff0000, v49
  v_mul_f32 v26, s35, v26
  v_mul_f32 v27, s35, v27
  v_cvt_pk_bf16_f32 v49, v26, v27
  v_mov_b32 v81, v49
  v_lshlrev_b32 v26, 16, v50
  v_and_b32 v27, 0xffff0000, v50
  v_mul_f32 v26, s35, v26
  v_mul_f32 v27, s35, v27
  v_cvt_pk_bf16_f32 v50, v26, v27
  v_mov_b32 v82, v50
  v_lshlrev_b32 v26, 16, v51
  v_and_b32 v27, 0xffff0000, v51
  v_mul_f32 v26, s35, v26
  v_mul_f32 v27, s35, v27
  v_cvt_pk_bf16_f32 v51, v26, v27
  v_mov_b32 v83, v51
  v_lshlrev_b32 v26, 16, v52
  v_and_b32 v27, 0xffff0000, v52
  v_mul_f32 v26, s35, v26
  v_mul_f32 v27, s35, v27
  v_cvt_pk_bf16_f32 v52, v26, v27
  v_mov_b32 v84, v52
  v_lshlrev_b32 v26, 16, v53
  v_and_b32 v27, 0xffff0000, v53
  v_mul_f32 v26, s35, v26
  v_mul_f32 v27, s35, v27
  v_cvt_pk_bf16_f32 v53, v26, v27
  v_mov_b32 v85, v53
  v_lshlrev_b32 v26, 16, v54
  v_and_b32 v27, 0xffff0000, v54
  v_mul_f32 v26, s35, v26
  v_mul_f32 v27, s35, v27
  v_cvt_pk_bf16_f32 v54, v26, v27
  v_mov_b32 v86, v54
  v_lshlrev_b32 v26, 16, v55
  v_and_b32 v27, 0xffff0000, v55
  v_mul_f32 v26, s35, v26
  v_mul_f32 v27, s35, v27
  v_cvt_pk_bf16_f32 v55, v26, v27
  v_mov_b32 v87, v55
  v_lshlrev_b32 v26, 16, v56
  v_and_b32 v27, 0xffff0000, v56
  v_mul_f32 v26, s35, v26
  v_mul_f32 v27, s35, v27
  v_cvt_pk_bf16_f32 v56, v26, v27
  v_mov_b32 v88, v56
  v_lshlrev_b32 v26, 16, v57
  v_and_b32 v27, 0xffff0000, v57
  v_mul_f32 v26, s35, v26
  v_mul_f32 v27, s35, v27
  v_cvt_pk_bf16_f32 v57, v26, v27
  v_mov_b32 v89, v57
  v_lshlrev_b32 v26, 16, v58
  v_and_b32 v27, 0xffff0000, v58
  v_mul_f32 v26, s35, v26
  v_mul_f32 v27, s35, v27
  v_cvt_pk_bf16_f32 v58, v26, v27
  v_mov_b32 v90, v58
  v_lshlrev_b32 v26, 16, v59
  v_and_b32 v27, 0xffff0000, v59
  v_mul_f32 v26, s35, v26
  v_mul_f32 v27, s35, v27
  v_cvt_pk_bf16_f32 v59, v26, v27
  v_mov_b32 v91, v59
  v_lshlrev_b32 v26, 16, v60
  v_and_b32 v27, 0xffff0000, v60
  v_mul_f32 v26, s35, v26
  v_mul_f32 v27, s35, v27
  v_cvt_pk_bf16_f32 v60, v26, v27
  v_mov_b32 v92, v60
  v_lshlrev_b32 v26, 16, v61
  v_and_b32 v27, 0xffff0000, v61
  v_mul_f32 v26, s35, v26
  v_mul_f32 v27, s35, v27
  v_cvt_pk_bf16_f32 v61, v26, v27
  v_mov_b32 v93, v61
  v_lshlrev_b32 v26, 16, v62
  v_and_b32 v27, 0xffff0000, v62
  v_mul_f32 v26, s35, v26
  v_mul_f32 v27, s35, v27
  v_cvt_pk_bf16_f32 v62, v26, v27
  v_mov_b32 v94, v62
  v_lshlrev_b32 v26, 16, v63
  v_and_b32 v27, 0xffff0000, v63
  v_mul_f32 v26, s35, v26
  v_mul_f32 v27, s35, v27
  v_cvt_pk_bf16_f32 v63, v26, v27
  v_mov_b32 v95, v63
  s_waitcnt vmcnt(28)
  s_barrier
  s_add_u32 m0, s100, 114688
  s_add_u32 s35, s99, 896
  buffer_load_dwordx4 v14, s[48:51], s35 offen lds
  s_add_u32 m0, s100, 115712
  s_add_u32 s35, s99, 10112
  buffer_load_dwordx4 v14, s[48:51], s35 offen lds
  s_add_u32 m0, s100, 116736
  s_add_u32 s35, s99, 19328
  buffer_load_dwordx4 v15, s[48:51], s35 offen lds
  s_add_u32 m0, s100, 117760
  s_add_u32 s35, s99, 28544
  buffer_load_dwordx4 v15, s[48:51], s35 offen lds
  s_mov_b32 s35, 147456
  v_add_u32 v24, s35, v16
  v_add_u32 v25, s35, v17
  ds_read_b64_tr_b16 v[48:49], v24 offset:0
  ds_read_b64_tr_b16 v[50:51], v24 offset:1024
  ds_read_b64_tr_b16 v[52:53], v24 offset:8192
  ds_read_b64_tr_b16 v[54:55], v24 offset:9216
  ds_read_b64_tr_b16 v[56:57], v25 offset:0
  ds_read_b64_tr_b16 v[58:59], v25 offset:1024
  ds_read_b64_tr_b16 v[60:61], v25 offset:8192
  ds_read_b64_tr_b16 v[62:63], v25 offset:9216
  s_waitcnt lgkmcnt(0)
  s_mov_b32 s35, 0x3e0293ee
  v_lshlrev_b32 v26, 16, v48
  v_and_b32 v27, 0xffff0000, v48
  v_mul_f32 v26, s35, v26
  v_mul_f32 v27, s35, v27
  v_cvt_pk_bf16_f32 v48, v26, v27
  v_mov_b32 v96, v48
  v_lshlrev_b32 v26, 16, v49
  v_and_b32 v27, 0xffff0000, v49
  v_mul_f32 v26, s35, v26
  v_mul_f32 v27, s35, v27
  v_cvt_pk_bf16_f32 v49, v26, v27
  v_mov_b32 v97, v49
  v_lshlrev_b32 v26, 16, v50
  v_and_b32 v27, 0xffff0000, v50
  v_mul_f32 v26, s35, v26
  v_mul_f32 v27, s35, v27
  v_cvt_pk_bf16_f32 v50, v26, v27
  v_mov_b32 v98, v50
  v_lshlrev_b32 v26, 16, v51
  v_and_b32 v27, 0xffff0000, v51
  v_mul_f32 v26, s35, v26
  v_mul_f32 v27, s35, v27
  v_cvt_pk_bf16_f32 v51, v26, v27
  v_mov_b32 v99, v51
  v_lshlrev_b32 v26, 16, v52
  v_and_b32 v27, 0xffff0000, v52
  v_mul_f32 v26, s35, v26
  v_mul_f32 v27, s35, v27
  v_cvt_pk_bf16_f32 v52, v26, v27
  v_mov_b32 v100, v52
  v_lshlrev_b32 v26, 16, v53
  v_and_b32 v27, 0xffff0000, v53
  v_mul_f32 v26, s35, v26
  v_mul_f32 v27, s35, v27
  v_cvt_pk_bf16_f32 v53, v26, v27
  v_mov_b32 v101, v53
  v_lshlrev_b32 v26, 16, v54
  v_and_b32 v27, 0xffff0000, v54
  v_mul_f32 v26, s35, v26
  v_mul_f32 v27, s35, v27
  v_cvt_pk_bf16_f32 v54, v26, v27
  v_mov_b32 v102, v54
  v_lshlrev_b32 v26, 16, v55
  v_and_b32 v27, 0xffff0000, v55
  v_mul_f32 v26, s35, v26
  v_mul_f32 v27, s35, v27
  v_cvt_pk_bf16_f32 v55, v26, v27
  v_mov_b32 v103, v55
  v_lshlrev_b32 v26, 16, v56
  v_and_b32 v27, 0xffff0000, v56
  v_mul_f32 v26, s35, v26
  v_mul_f32 v27, s35, v27
  v_cvt_pk_bf16_f32 v56, v26, v27
  v_mov_b32 v104, v56
  v_lshlrev_b32 v26, 16, v57
  v_and_b32 v27, 0xffff0000, v57
  v_mul_f32 v26, s35, v26
  v_mul_f32 v27, s35, v27
  v_cvt_pk_bf16_f32 v57, v26, v27
  v_mov_b32 v105, v57
  v_lshlrev_b32 v26, 16, v58
  v_and_b32 v27, 0xffff0000, v58
  v_mul_f32 v26, s35, v26
  v_mul_f32 v27, s35, v27
  v_cvt_pk_bf16_f32 v58, v26, v27
  v_mov_b32 v106, v58
  v_lshlrev_b32 v26, 16, v59
  v_and_b32 v27, 0xffff0000, v59
  v_mul_f32 v26, s35, v26
  v_mul_f32 v27, s35, v27
  v_cvt_pk_bf16_f32 v59, v26, v27
  v_mov_b32 v107, v59
  v_lshlrev_b32 v26, 16, v60
  v_and_b32 v27, 0xffff0000, v60
  v_mul_f32 v26, s35, v26
  v_mul_f32 v27, s35, v27
  v_cvt_pk_bf16_f32 v60, v26, v27
  v_mov_b32 v108, v60
  v_lshlrev_b32 v26, 16, v61
  v_and_b32 v27, 0xffff0000, v61
  v_mul_f32 v26, s35, v26
  v_mul_f32 v27, s35, v27
  v_cvt_pk_bf16_f32 v61, v26, v27
  v_mov_b32 v109, v61
  v_lshlrev_b32 v26, 16, v62
  v_and_b32 v27, 0xffff0000, v62
  v_mul_f32 v26, s35, v26
  v_mul_f32 v27, s35, v27
  v_cvt_pk_bf16_f32 v62, v26, v27
  v_mov_b32 v110, v62
  v_lshlrev_b32 v26, 16, v63
  v_and_b32 v27, 0xffff0000, v63
  v_mul_f32 v26, s35, v26
  v_mul_f32 v27, s35, v27
  v_cvt_pk_bf16_f32 v63, v26, v27
  v_mov_b32 v111, v63
  s_waitcnt vmcnt(28)
  s_barrier
  s_add_u32 m0, s100, 131072
  s_add_u32 s35, s99, 1024
  buffer_load_dwordx4 v14, s[48:51], s35 offen lds
  s_add_u32 m0, s100, 132096
  s_add_u32 s35, s99, 10240
  buffer_load_dwordx4 v14, s[48:51], s35 offen lds
  s_add_u32 m0, s100, 133120
  s_add_u32 s35, s99, 19456
  buffer_load_dwordx4 v15, s[48:51], s35 offen lds
  s_add_u32 m0, s100, 134144
  s_add_u32 s35, s99, 28672
  buffer_load_dwordx4 v15, s[48:51], s35 offen lds
  s_mov_b32 s35, 16384
  v_add_u32 v24, s35, v16
  v_add_u32 v25, s35, v17
  ds_read_b64_tr_b16 v[48:49], v24 offset:0
  ds_read_b64_tr_b16 v[50:51], v24 offset:1024
  ds_read_b64_tr_b16 v[52:53], v24 offset:8192
  ds_read_b64_tr_b16 v[54:55], v24 offset:9216
  ds_read_b64_tr_b16 v[56:57], v25 offset:0
  ds_read_b64_tr_b16 v[58:59], v25 offset:1024
  ds_read_b64_tr_b16 v[60:61], v25 offset:8192
  ds_read_b64_tr_b16 v[62:63], v25 offset:9216
  s_waitcnt lgkmcnt(0)
  s_mov_b32 s35, 0x3e0293ee
  v_lshlrev_b32 v26, 16, v48
  v_and_b32 v27, 0xffff0000, v48
  v_mul_f32 v26, s35, v26
  v_mul_f32 v27, s35, v27
  v_cvt_pk_bf16_f32 v48, v26, v27
  v_mov_b32 v112, v48
  v_lshlrev_b32 v26, 16, v49
  v_and_b32 v27, 0xffff0000, v49
  v_mul_f32 v26, s35, v26
  v_mul_f32 v27, s35, v27
  v_cvt_pk_bf16_f32 v49, v26, v27
  v_mov_b32 v113, v49
  v_lshlrev_b32 v26, 16, v50
  v_and_b32 v27, 0xffff0000, v50
  v_mul_f32 v26, s35, v26
  v_mul_f32 v27, s35, v27
  v_cvt_pk_bf16_f32 v50, v26, v27
  v_mov_b32 v114, v50
  v_lshlrev_b32 v26, 16, v51
  v_and_b32 v27, 0xffff0000, v51
  v_mul_f32 v26, s35, v26
  v_mul_f32 v27, s35, v27
  v_cvt_pk_bf16_f32 v51, v26, v27
  v_mov_b32 v115, v51
  v_lshlrev_b32 v26, 16, v52
  v_and_b32 v27, 0xffff0000, v52
  v_mul_f32 v26, s35, v26
  v_mul_f32 v27, s35, v27
  v_cvt_pk_bf16_f32 v52, v26, v27
  v_mov_b32 v116, v52
  v_lshlrev_b32 v26, 16, v53
  v_and_b32 v27, 0xffff0000, v53
  v_mul_f32 v26, s35, v26
  v_mul_f32 v27, s35, v27
  v_cvt_pk_bf16_f32 v53, v26, v27
  v_mov_b32 v117, v53
  v_lshlrev_b32 v26, 16, v54
  v_and_b32 v27, 0xffff0000, v54
  v_mul_f32 v26, s35, v26
  v_mul_f32 v27, s35, v27
  v_cvt_pk_bf16_f32 v54, v26, v27
  v_mov_b32 v118, v54
  v_lshlrev_b32 v26, 16, v55
  v_and_b32 v27, 0xffff0000, v55
  v_mul_f32 v26, s35, v26
  v_mul_f32 v27, s35, v27
  v_cvt_pk_bf16_f32 v55, v26, v27
  v_mov_b32 v119, v55
  v_lshlrev_b32 v26, 16, v56
  v_and_b32 v27, 0xffff0000, v56
  v_mul_f32 v26, s35, v26
  v_mul_f32 v27, s35, v27
  v_cvt_pk_bf16_f32 v56, v26, v27
  v_mov_b32 v120, v56
  v_lshlrev_b32 v26, 16, v57
  v_and_b32 v27, 0xffff0000, v57
  v_mul_f32 v26, s35, v26
  v_mul_f32 v27, s35, v27
  v_cvt_pk_bf16_f32 v57, v26, v27
  v_mov_b32 v121, v57
  v_lshlrev_b32 v26, 16, v58
  v_and_b32 v27, 0xffff0000, v58
  v_mul_f32 v26, s35, v26
  v_mul_f32 v27, s35, v27
  v_cvt_pk_bf16_f32 v58, v26, v27
  v_mov_b32 v122, v58
  v_lshlrev_b32 v26, 16, v59
  v_and_b32 v27, 0xffff0000, v59
  v_mul_f32 v26, s35, v26
  v_mul_f32 v27, s35, v27
  v_cvt_pk_bf16_f32 v59, v26, v27
  v_mov_b32 v123, v59
  v_lshlrev_b32 v26, 16, v60
  v_and_b32 v27, 0xffff0000, v60
  v_mul_f32 v26, s35, v26
  v_mul_f32 v27, s35, v27
  v_cvt_pk_bf16_f32 v60, v26, v27
  v_mov_b32 v124, v60
  v_lshlrev_b32 v26, 16, v61
  v_and_b32 v27, 0xffff0000, v61
  v_mul_f32 v26, s35, v26
  v_mul_f32 v27, s35, v27
  v_cvt_pk_bf16_f32 v61, v26, v27
  v_mov_b32 v125, v61
  v_lshlrev_b32 v26, 16, v62
  v_and_b32 v27, 0xffff0000, v62
  v_mul_f32 v26, s35, v26
  v_mul_f32 v27, s35, v27
  v_cvt_pk_bf16_f32 v62, v26, v27
  v_mov_b32 v126, v62
  v_lshlrev_b32 v26, 16, v63
  v_and_b32 v27, 0xffff0000, v63
  v_mul_f32 v26, s35, v26
  v_mul_f32 v27, s35, v27
  v_cvt_pk_bf16_f32 v63, v26, v27
  v_mov_b32 v127, v63
  s_waitcnt vmcnt(28)
  s_barrier
  s_add_u32 m0, s100, 0
  s_add_u32 s35, s98, 0
  buffer_load_dwordx4 v12, s[36:39], s35 offen lds
  s_add_u32 m0, s100, 1024
  s_add_u32 s35, s98, 32768
  buffer_load_dwordx4 v12, s[36:39], s35 offen lds
  s_add_u32 m0, s100, 2048
  s_add_u32 s35, s98, 65536
  buffer_load_dwordx4 v13, s[36:39], s35 offen lds
  s_add_u32 m0, s100, 3072
  s_add_u32 s35, s98, 98304
  buffer_load_dwordx4 v13, s[36:39], s35 offen lds
  s_mov_b32 s35, 32768
  v_add_u32 v24, s35, v16
  v_add_u32 v25, s35, v17
  ds_read_b64_tr_b16 v[48:49], v24 offset:0
  ds_read_b64_tr_b16 v[50:51], v24 offset:1024
  ds_read_b64_tr_b16 v[52:53], v24 offset:8192
  ds_read_b64_tr_b16 v[54:55], v24 offset:9216
  ds_read_b64_tr_b16 v[56:57], v25 offset:0
  ds_read_b64_tr_b16 v[58:59], v25 offset:1024
  ds_read_b64_tr_b16 v[60:61], v25 offset:8192
  ds_read_b64_tr_b16 v[62:63], v25 offset:9216
  s_waitcnt lgkmcnt(0)
  s_mov_b32 s35, 0x3e0293ee
  v_lshlrev_b32 v26, 16, v48
  v_and_b32 v27, 0xffff0000, v48
  v_mul_f32 v26, s35, v26
  v_mul_f32 v27, s35, v27
  v_cvt_pk_bf16_f32 v48, v26, v27
  v_mov_b32 v128, v48
  v_lshlrev_b32 v26, 16, v49
  v_and_b32 v27, 0xffff0000, v49
  v_mul_f32 v26, s35, v26
  v_mul_f32 v27, s35, v27
  v_cvt_pk_bf16_f32 v49, v26, v27
  v_mov_b32 v129, v49
  v_lshlrev_b32 v26, 16, v50
  v_and_b32 v27, 0xffff0000, v50
  v_mul_f32 v26, s35, v26
  v_mul_f32 v27, s35, v27
  v_cvt_pk_bf16_f32 v50, v26, v27
  v_mov_b32 v130, v50
  v_lshlrev_b32 v26, 16, v51
  v_and_b32 v27, 0xffff0000, v51
  v_mul_f32 v26, s35, v26
  v_mul_f32 v27, s35, v27
  v_cvt_pk_bf16_f32 v51, v26, v27
  v_mov_b32 v131, v51
  v_lshlrev_b32 v26, 16, v52
  v_and_b32 v27, 0xffff0000, v52
  v_mul_f32 v26, s35, v26
  v_mul_f32 v27, s35, v27
  v_cvt_pk_bf16_f32 v52, v26, v27
  v_mov_b32 v132, v52
  v_lshlrev_b32 v26, 16, v53
  v_and_b32 v27, 0xffff0000, v53
  v_mul_f32 v26, s35, v26
  v_mul_f32 v27, s35, v27
  v_cvt_pk_bf16_f32 v53, v26, v27
  v_mov_b32 v133, v53
  v_lshlrev_b32 v26, 16, v54
  v_and_b32 v27, 0xffff0000, v54
  v_mul_f32 v26, s35, v26
  v_mul_f32 v27, s35, v27
  v_cvt_pk_bf16_f32 v54, v26, v27
  v_mov_b32 v134, v54
  v_lshlrev_b32 v26, 16, v55
  v_and_b32 v27, 0xffff0000, v55
  v_mul_f32 v26, s35, v26
  v_mul_f32 v27, s35, v27
  v_cvt_pk_bf16_f32 v55, v26, v27
  v_mov_b32 v135, v55
  v_lshlrev_b32 v26, 16, v56
  v_and_b32 v27, 0xffff0000, v56
  v_mul_f32 v26, s35, v26
  v_mul_f32 v27, s35, v27
  v_cvt_pk_bf16_f32 v56, v26, v27
  v_mov_b32 v136, v56
  v_lshlrev_b32 v26, 16, v57
  v_and_b32 v27, 0xffff0000, v57
  v_mul_f32 v26, s35, v26
  v_mul_f32 v27, s35, v27
  v_cvt_pk_bf16_f32 v57, v26, v27
  v_mov_b32 v137, v57
  v_lshlrev_b32 v26, 16, v58
  v_and_b32 v27, 0xffff0000, v58
  v_mul_f32 v26, s35, v26
  v_mul_f32 v27, s35, v27
  v_cvt_pk_bf16_f32 v58, v26, v27
  v_mov_b32 v138, v58
  v_lshlrev_b32 v26, 16, v59
  v_and_b32 v27, 0xffff0000, v59
  v_mul_f32 v26, s35, v26
  v_mul_f32 v27, s35, v27
  v_cvt_pk_bf16_f32 v59, v26, v27
  v_mov_b32 v139, v59
  v_lshlrev_b32 v26, 16, v60
  v_and_b32 v27, 0xffff0000, v60
  v_mul_f32 v26, s35, v26
  v_mul_f32 v27, s35, v27
  v_cvt_pk_bf16_f32 v60, v26, v27
  v_mov_b32 v140, v60
  v_lshlrev_b32 v26, 16, v61
  v_and_b32 v27, 0xffff0000, v61
  v_mul_f32 v26, s35, v26
  v_mul_f32 v27, s35, v27
  v_cvt_pk_bf16_f32 v61, v26, v27
  v_mov_b32 v141, v61
  v_lshlrev_b32 v26, 16, v62
  v_and_b32 v27, 0xffff0000, v62
  v_mul_f32 v26, s35, v26
  v_mul_f32 v27, s35, v27
  v_cvt_pk_bf16_f32 v62, v26, v27
  v_mov_b32 v142, v62
  v_lshlrev_b32 v26, 16, v63
  v_and_b32 v27, 0xffff0000, v63
  v_mul_f32 v26, s35, v26
  v_mul_f32 v27, s35, v27
  v_cvt_pk_bf16_f32 v63, v26, v27
  v_mov_b32 v143, v63
  s_waitcnt vmcnt(28)
  s_barrier
  s_add_u32 m0, s100, 16384
  s_add_u32 s35, s98, 0
  buffer_load_dwordx4 v12, s[40:43], s35 offen lds
  s_add_u32 m0, s100, 17408
  s_add_u32 s35, s98, 32768
  buffer_load_dwordx4 v12, s[40:43], s35 offen lds
  s_add_u32 m0, s100, 18432
  s_add_u32 s35, s98, 65536
  buffer_load_dwordx4 v13, s[40:43], s35 offen lds
  s_add_u32 m0, s100, 19456
  s_add_u32 s35, s98, 98304
  buffer_load_dwordx4 v13, s[40:43], s35 offen lds
  s_mov_b32 s35, 49152
  v_add_u32 v24, s35, v18
  ds_read_b64_tr_b16 v[144:145], v24 offset:0
  ds_read_b64_tr_b16 v[146:147], v24 offset:256
  ds_read_b64_tr_b16 v[148:149], v24 offset:1024
  ds_read_b64_tr_b16 v[150:151], v24 offset:1280
  ds_read_b64_tr_b16 v[152:153], v24 offset:8192
  ds_read_b64_tr_b16 v[154:155], v24 offset:8448
  ds_read_b64_tr_b16 v[156:157], v24 offset:9216
  ds_read_b64_tr_b16 v[158:159], v24 offset:9472
  s_waitcnt lgkmcnt(0)
  s_waitcnt vmcnt(28)
  s_barrier
  s_add_u32 m0, s100, 32768
  s_add_u32 s35, s98, 1048576
  buffer_load_dwordx4 v12, s[36:39], s35 offen lds
  s_add_u32 m0, s100, 33792
  s_add_u32 s35, s98, 1081344
  buffer_load_dwordx4 v12, s[36:39], s35 offen lds
  s_add_u32 m0, s100, 34816
  s_add_u32 s35, s98, 1114112
  buffer_load_dwordx4 v13, s[36:39], s35 offen lds
  s_add_u32 m0, s100, 35840
  s_add_u32 s35, s98, 1146880
  buffer_load_dwordx4 v13, s[36:39], s35 offen lds
  s_mov_b32 s35, 65536
  v_add_u32 v24, s35, v18
  ds_read_b64_tr_b16 v[160:161], v24 offset:0
  ds_read_b64_tr_b16 v[162:163], v24 offset:256
  ds_read_b64_tr_b16 v[164:165], v24 offset:1024
  ds_read_b64_tr_b16 v[166:167], v24 offset:1280
  ds_read_b64_tr_b16 v[168:169], v24 offset:8192
  ds_read_b64_tr_b16 v[170:171], v24 offset:8448
  ds_read_b64_tr_b16 v[172:173], v24 offset:9216
  ds_read_b64_tr_b16 v[174:175], v24 offset:9472
  s_waitcnt lgkmcnt(0)
  s_waitcnt vmcnt(28)
  s_barrier
  s_add_u32 m0, s100, 49152
  s_add_u32 s35, s98, 1572864
  buffer_load_dwordx4 v12, s[40:43], s35 offen lds
  s_add_u32 m0, s100, 50176
  s_add_u32 s35, s98, 1605632
  buffer_load_dwordx4 v12, s[40:43], s35 offen lds
  s_add_u32 m0, s100, 51200
  s_add_u32 s35, s98, 1638400
  buffer_load_dwordx4 v13, s[40:43], s35 offen lds
  s_add_u32 m0, s100, 52224
  s_add_u32 s35, s98, 1671168
  buffer_load_dwordx4 v13, s[40:43], s35 offen lds
  s_mov_b32 s35, 81920
  v_add_u32 v24, s35, v18
  ds_read_b64_tr_b16 v[176:177], v24 offset:0
  ds_read_b64_tr_b16 v[178:179], v24 offset:256
  ds_read_b64_tr_b16 v[180:181], v24 offset:1024
  ds_read_b64_tr_b16 v[182:183], v24 offset:1280
  ds_read_b64_tr_b16 v[184:185], v24 offset:8192
  ds_read_b64_tr_b16 v[186:187], v24 offset:8448
  ds_read_b64_tr_b16 v[188:189], v24 offset:9216
  ds_read_b64_tr_b16 v[190:191], v24 offset:9472
  s_waitcnt lgkmcnt(0)
  s_waitcnt vmcnt(28)
  s_barrier
  s_add_u32 m0, s100, 65536
  s_add_u32 s35, s98, 2621440
  buffer_load_dwordx4 v12, s[36:39], s35 offen lds
  s_add_u32 m0, s100, 66560
  s_add_u32 s35, s98, 2654208
  buffer_load_dwordx4 v12, s[36:39], s35 offen lds
  s_add_u32 m0, s100, 67584
  s_add_u32 s35, s98, 2686976
  buffer_load_dwordx4 v13, s[36:39], s35 offen lds
  s_add_u32 m0, s100, 68608
  s_add_u32 s35, s98, 2719744
  buffer_load_dwordx4 v13, s[36:39], s35 offen lds
  s_mov_b32 s35, 98304
  v_add_u32 v24, s35, v18
  ds_read_b64_tr_b16 v[192:193], v24 offset:0
  ds_read_b64_tr_b16 v[194:195], v24 offset:256
  ds_read_b64_tr_b16 v[196:197], v24 offset:1024
  ds_read_b64_tr_b16 v[198:199], v24 offset:1280
  ds_read_b64_tr_b16 v[200:201], v24 offset:8192
  ds_read_b64_tr_b16 v[202:203], v24 offset:8448
  ds_read_b64_tr_b16 v[204:205], v24 offset:9216
  ds_read_b64_tr_b16 v[206:207], v24 offset:9472
  s_waitcnt lgkmcnt(0)
  s_waitcnt vmcnt(28)
  s_barrier
  s_add_u32 m0, s100, 81920
  s_add_u32 s35, s98, 3145728
  buffer_load_dwordx4 v12, s[40:43], s35 offen lds
  s_add_u32 m0, s100, 82944
  s_add_u32 s35, s98, 3178496
  buffer_load_dwordx4 v12, s[40:43], s35 offen lds
  s_add_u32 m0, s100, 83968
  s_add_u32 s35, s98, 3211264
  buffer_load_dwordx4 v13, s[40:43], s35 offen lds
  s_add_u32 m0, s100, 84992
  s_add_u32 s35, s98, 3244032
  buffer_load_dwordx4 v13, s[40:43], s35 offen lds
  s_mov_b32 s35, 114688
  v_add_u32 v24, s35, v18
  ds_read_b64_tr_b16 v[208:209], v24 offset:0
  ds_read_b64_tr_b16 v[210:211], v24 offset:256
  ds_read_b64_tr_b16 v[212:213], v24 offset:1024
  ds_read_b64_tr_b16 v[214:215], v24 offset:1280
  ds_read_b64_tr_b16 v[216:217], v24 offset:8192
  ds_read_b64_tr_b16 v[218:219], v24 offset:8448
  ds_read_b64_tr_b16 v[220:221], v24 offset:9216
  ds_read_b64_tr_b16 v[222:223], v24 offset:9472
  s_waitcnt lgkmcnt(0)
  s_waitcnt vmcnt(28)
  s_barrier
  s_add_u32 m0, s100, 98304
  s_add_u32 s35, s98, 4194304
  buffer_load_dwordx4 v12, s[40:43], s35 offen lds
  s_add_u32 m0, s100, 99328
  s_add_u32 s35, s98, 4227072
  buffer_load_dwordx4 v12, s[40:43], s35 offen lds
  s_add_u32 m0, s100, 100352
  s_add_u32 s35, s98, 4259840
  buffer_load_dwordx4 v13, s[40:43], s35 offen lds
  s_add_u32 m0, s100, 101376
  s_add_u32 s35, s98, 4292608
  buffer_load_dwordx4 v13, s[40:43], s35 offen lds
  s_mov_b32 s35, 131072
  v_add_u32 v24, s35, v18
  ds_read_b64_tr_b16 v[224:225], v24 offset:0
  ds_read_b64_tr_b16 v[226:227], v24 offset:256
  ds_read_b64_tr_b16 v[228:229], v24 offset:1024
  ds_read_b64_tr_b16 v[230:231], v24 offset:1280
  ds_read_b64_tr_b16 v[232:233], v24 offset:8192
  ds_read_b64_tr_b16 v[234:235], v24 offset:8448
  ds_read_b64_tr_b16 v[236:237], v24 offset:9216
  ds_read_b64_tr_b16 v[238:239], v24 offset:9472
  s_waitcnt lgkmcnt(0)
  s_waitcnt vmcnt(28)
  s_barrier
  s_add_u32 m0, s100, 114688
  s_add_u32 s35, s99, 128
  buffer_load_dwordx4 v14, s[48:51], s35 offen lds
  s_add_u32 m0, s100, 115712
  s_add_u32 s35, s99, 9344
  buffer_load_dwordx4 v14, s[48:51], s35 offen lds
  s_add_u32 m0, s100, 116736
  s_add_u32 s35, s99, 18560
  buffer_load_dwordx4 v15, s[48:51], s35 offen lds
  s_add_u32 m0, s100, 117760
  s_add_u32 s35, s99, 27776
  buffer_load_dwordx4 v15, s[48:51], s35 offen lds
  s_mov_b32 s35, 147456
  v_add_u32 v24, s35, v18
  ds_read_b64_tr_b16 v[240:241], v24 offset:0
  ds_read_b64_tr_b16 v[242:243], v24 offset:256
  ds_read_b64_tr_b16 v[244:245], v24 offset:1024
  ds_read_b64_tr_b16 v[246:247], v24 offset:1280
  ds_read_b64_tr_b16 v[248:249], v24 offset:8192
  ds_read_b64_tr_b16 v[250:251], v24 offset:8448
  ds_read_b64_tr_b16 v[252:253], v24 offset:9216
  ds_read_b64_tr_b16 v[254:255], v24 offset:9472
  s_waitcnt lgkmcnt(0)
  s_waitcnt vmcnt(28)
  s_barrier
  s_add_u32 m0, s100, 131072
  s_add_u32 s35, s99, 384
  buffer_load_dwordx4 v14, s[48:51], s35 offen lds
  s_add_u32 m0, s100, 132096
  s_add_u32 s35, s99, 9600
  buffer_load_dwordx4 v14, s[48:51], s35 offen lds
  s_add_u32 m0, s100, 133120
  s_add_u32 s35, s99, 18816
  buffer_load_dwordx4 v15, s[48:51], s35 offen lds
  s_add_u32 m0, s100, 134144
  s_add_u32 s35, s99, 28032
  buffer_load_dwordx4 v15, s[48:51], s35 offen lds
  s_mov_b32 s35, 16384
  v_add_u32 v24, s35, v16
  v_add_u32 v25, s35, v17
  ds_read_b64_tr_b16 v[48:49], v24 offset:0
  ds_read_b64_tr_b16 v[50:51], v24 offset:1024
  ds_read_b64_tr_b16 v[52:53], v24 offset:8192
  ds_read_b64_tr_b16 v[54:55], v24 offset:9216
  ds_read_b64_tr_b16 v[56:57], v25 offset:0
  ds_read_b64_tr_b16 v[58:59], v25 offset:1024
  ds_read_b64_tr_b16 v[60:61], v25 offset:8192
  ds_read_b64_tr_b16 v[62:63], v25 offset:9216
  s_waitcnt lgkmcnt(0)
  s_mov_b32 s35, 0x3e0293ee
  v_lshlrev_b32 v26, 16, v48
  v_and_b32 v27, 0xffff0000, v48
  v_mul_f32 v26, s35, v26
  v_mul_f32 v27, s35, v27
  v_cvt_pk_bf16_f32 v48, v26, v27
  v_lshlrev_b32 v26, 16, v49
  v_and_b32 v27, 0xffff0000, v49
  v_mul_f32 v26, s35, v26
  v_mul_f32 v27, s35, v27
  v_cvt_pk_bf16_f32 v49, v26, v27
  v_lshlrev_b32 v26, 16, v50
  v_and_b32 v27, 0xffff0000, v50
  v_mul_f32 v26, s35, v26
  v_mul_f32 v27, s35, v27
  v_cvt_pk_bf16_f32 v50, v26, v27
  v_lshlrev_b32 v26, 16, v51
  v_and_b32 v27, 0xffff0000, v51
  v_mul_f32 v26, s35, v26
  v_mul_f32 v27, s35, v27
  v_cvt_pk_bf16_f32 v51, v26, v27
  v_lshlrev_b32 v26, 16, v52
  v_and_b32 v27, 0xffff0000, v52
  v_mul_f32 v26, s35, v26
  v_mul_f32 v27, s35, v27
  v_cvt_pk_bf16_f32 v52, v26, v27
  v_lshlrev_b32 v26, 16, v53
  v_and_b32 v27, 0xffff0000, v53
  v_mul_f32 v26, s35, v26
  v_mul_f32 v27, s35, v27
  v_cvt_pk_bf16_f32 v53, v26, v27
  v_lshlrev_b32 v26, 16, v54
  v_and_b32 v27, 0xffff0000, v54
  v_mul_f32 v26, s35, v26
  v_mul_f32 v27, s35, v27
  v_cvt_pk_bf16_f32 v54, v26, v27
  v_lshlrev_b32 v26, 16, v55
  v_and_b32 v27, 0xffff0000, v55
  v_mul_f32 v26, s35, v26
  v_mul_f32 v27, s35, v27
  v_cvt_pk_bf16_f32 v55, v26, v27
  v_lshlrev_b32 v26, 16, v56
  v_and_b32 v27, 0xffff0000, v56
  v_mul_f32 v26, s35, v26
  v_mul_f32 v27, s35, v27
  v_cvt_pk_bf16_f32 v56, v26, v27
  v_lshlrev_b32 v26, 16, v57
  v_and_b32 v27, 0xffff0000, v57
  v_mul_f32 v26, s35, v26
  v_mul_f32 v27, s35, v27
  v_cvt_pk_bf16_f32 v57, v26, v27
  v_lshlrev_b32 v26, 16, v58
  v_and_b32 v27, 0xffff0000, v58
  v_mul_f32 v26, s35, v26
  v_mul_f32 v27, s35, v27
  v_cvt_pk_bf16_f32 v58, v26, v27
  v_lshlrev_b32 v26, 16, v59
  v_and_b32 v27, 0xffff0000, v59
  v_mul_f32 v26, s35, v26
  v_mul_f32 v27, s35, v27
  v_cvt_pk_bf16_f32 v59, v26, v27
  v_lshlrev_b32 v26, 16, v60
  v_and_b32 v27, 0xffff0000, v60
  v_mul_f32 v26, s35, v26
  v_mul_f32 v27, s35, v27
  v_cvt_pk_bf16_f32 v60, v26, v27
  v_lshlrev_b32 v26, 16, v61
  v_and_b32 v27, 0xffff0000, v61
  v_mul_f32 v26, s35, v26
  v_mul_f32 v27, s35, v27
  v_cvt_pk_bf16_f32 v61, v26, v27
  v_lshlrev_b32 v26, 16, v62
  v_and_b32 v27, 0xffff0000, v62
  v_mul_f32 v26, s35, v26
  v_mul_f32 v27, s35, v27
  v_cvt_pk_bf16_f32 v62, v26, v27
  v_lshlrev_b32 v26, 16, v63
  v_and_b32 v27, 0xffff0000, v63
  v_mul_f32 v26, s35, v26
  v_mul_f32 v27, s35, v27
  v_cvt_pk_bf16_f32 v63, v26, v27
  s_barrier
  s_lshl_b32 s35, s94, 12
  s_add_u32 s35, s35, 16384
  v_add_u32 v24, s35, v4
  ds_write_b128 v24, v[48:51] offset:0
  ds_write_b128 v24, v[52:55] offset:1024
  ds_write_b128 v24, v[56:59] offset:2048
  ds_write_b128 v24, v[60:63] offset:3072
  s_waitcnt lgkmcnt(0)
  s_waitcnt vmcnt(28)
  s_barrier
  s_mov_b32 s35, 32768
  v_add_u32 v24, s35, v16
  v_add_u32 v25, s35, v17
  ds_read_b64_tr_b16 v[48:49], v24 offset:0
  ds_read_b64_tr_b16 v[50:51], v24 offset:1024
  ds_read_b64_tr_b16 v[52:53], v24 offset:8192
  ds_read_b64_tr_b16 v[54:55], v24 offset:9216
  ds_read_b64_tr_b16 v[56:57], v25 offset:0
  ds_read_b64_tr_b16 v[58:59], v25 offset:1024
  ds_read_b64_tr_b16 v[60:61], v25 offset:8192
  ds_read_b64_tr_b16 v[62:63], v25 offset:9216
  s_waitcnt lgkmcnt(0)
  s_barrier
  s_lshl_b32 s35, s94, 12
  s_add_u32 s35, s35, 32768
  v_add_u32 v24, s35, v4
  ds_write_b128 v24, v[48:51] offset:0
  ds_write_b128 v24, v[52:55] offset:1024
  ds_write_b128 v24, v[56:59] offset:2048
  ds_write_b128 v24, v[60:63] offset:3072
  s_waitcnt lgkmcnt(0)
  s_waitcnt vmcnt(24)
  s_barrier
  s_mov_b32 s35, 49152
  v_add_u32 v24, s35, v16
  v_add_u32 v25, s35, v17
  ds_read_b64_tr_b16 v[48:49], v24 offset:0
  ds_read_b64_tr_b16 v[50:51], v24 offset:1024
  ds_read_b64_tr_b16 v[52:53], v24 offset:8192
  ds_read_b64_tr_b16 v[54:55], v24 offset:9216
  ds_read_b64_tr_b16 v[56:57], v25 offset:0
  ds_read_b64_tr_b16 v[58:59], v25 offset:1024
  ds_read_b64_tr_b16 v[60:61], v25 offset:8192
  ds_read_b64_tr_b16 v[62:63], v25 offset:9216
  s_waitcnt lgkmcnt(0)
  s_mov_b32 s35, 0x3e0293ee
  v_lshlrev_b32 v26, 16, v48
  v_and_b32 v27, 0xffff0000, v48
  v_mul_f32 v26, s35, v26
  v_mul_f32 v27, s35, v27
  v_cvt_pk_bf16_f32 v48, v26, v27
  v_lshlrev_b32 v26, 16, v49
  v_and_b32 v27, 0xffff0000, v49
  v_mul_f32 v26, s35, v26
  v_mul_f32 v27, s35, v27
  v_cvt_pk_bf16_f32 v49, v26, v27
  v_lshlrev_b32 v26, 16, v50
  v_and_b32 v27, 0xffff0000, v50
  v_mul_f32 v26, s35, v26
  v_mul_f32 v27, s35, v27
  v_cvt_pk_bf16_f32 v50, v26, v27
  v_lshlrev_b32 v26, 16, v51
  v_and_b32 v27, 0xffff0000, v51
  v_mul_f32 v26, s35, v26
  v_mul_f32 v27, s35, v27
  v_cvt_pk_bf16_f32 v51, v26, v27
  v_lshlrev_b32 v26, 16, v52
  v_and_b32 v27, 0xffff0000, v52
  v_mul_f32 v26, s35, v26
  v_mul_f32 v27, s35, v27
  v_cvt_pk_bf16_f32 v52, v26, v27
  v_lshlrev_b32 v26, 16, v53
  v_and_b32 v27, 0xffff0000, v53
  v_mul_f32 v26, s35, v26
  v_mul_f32 v27, s35, v27
  v_cvt_pk_bf16_f32 v53, v26, v27
  v_lshlrev_b32 v26, 16, v54
  v_and_b32 v27, 0xffff0000, v54
  v_mul_f32 v26, s35, v26
  v_mul_f32 v27, s35, v27
  v_cvt_pk_bf16_f32 v54, v26, v27
  v_lshlrev_b32 v26, 16, v55
  v_and_b32 v27, 0xffff0000, v55
  v_mul_f32 v26, s35, v26
  v_mul_f32 v27, s35, v27
  v_cvt_pk_bf16_f32 v55, v26, v27
  v_lshlrev_b32 v26, 16, v56
  v_and_b32 v27, 0xffff0000, v56
  v_mul_f32 v26, s35, v26
  v_mul_f32 v27, s35, v27
  v_cvt_pk_bf16_f32 v56, v26, v27
  v_lshlrev_b32 v26, 16, v57
  v_and_b32 v27, 0xffff0000, v57
  v_mul_f32 v26, s35, v26
  v_mul_f32 v27, s35, v27
  v_cvt_pk_bf16_f32 v57, v26, v27
  v_lshlrev_b32 v26, 16, v58
  v_and_b32 v27, 0xffff0000, v58
  v_mul_f32 v26, s35, v26
  v_mul_f32 v27, s35, v27
  v_cvt_pk_bf16_f32 v58, v26, v27
  v_lshlrev_b32 v26, 16, v59
  v_and_b32 v27, 0xffff0000, v59
  v_mul_f32 v26, s35, v26
  v_mul_f32 v27, s35, v27
  v_cvt_pk_bf16_f32 v59, v26, v27
  v_lshlrev_b32 v26, 16, v60
  v_and_b32 v27, 0xffff0000, v60
  v_mul_f32 v26, s35, v26
  v_mul_f32 v27, s35, v27
  v_cvt_pk_bf16_f32 v60, v26, v27
  v_lshlrev_b32 v26, 16, v61
  v_and_b32 v27, 0xffff0000, v61
  v_mul_f32 v26, s35, v26
  v_mul_f32 v27, s35, v27
  v_cvt_pk_bf16_f32 v61, v26, v27
  v_lshlrev_b32 v26, 16, v62
  v_and_b32 v27, 0xffff0000, v62
  v_mul_f32 v26, s35, v26
  v_mul_f32 v27, s35, v27
  v_cvt_pk_bf16_f32 v62, v26, v27
  v_lshlrev_b32 v26, 16, v63
  v_and_b32 v27, 0xffff0000, v63
  v_mul_f32 v26, s35, v26
  v_mul_f32 v27, s35, v27
  v_cvt_pk_bf16_f32 v63, v26, v27
  s_barrier
  s_lshl_b32 s35, s94, 12
  s_add_u32 s35, s35, 49152
  v_add_u32 v24, s35, v4
  ds_write_b128 v24, v[48:51] offset:0
  ds_write_b128 v24, v[52:55] offset:1024
  ds_write_b128 v24, v[56:59] offset:2048
  ds_write_b128 v24, v[60:63] offset:3072
  s_waitcnt lgkmcnt(0)
  s_waitcnt vmcnt(20)
  s_barrier
  s_mov_b32 s35, 65536
  v_add_u32 v24, s35, v16
  v_add_u32 v25, s35, v17
  ds_read_b64_tr_b16 v[48:49], v24 offset:0
  ds_read_b64_tr_b16 v[50:51], v24 offset:1024
  ds_read_b64_tr_b16 v[52:53], v24 offset:8192
  ds_read_b64_tr_b16 v[54:55], v24 offset:9216
  ds_read_b64_tr_b16 v[56:57], v25 offset:0
  ds_read_b64_tr_b16 v[58:59], v25 offset:1024
  ds_read_b64_tr_b16 v[60:61], v25 offset:8192
  ds_read_b64_tr_b16 v[62:63], v25 offset:9216
  s_waitcnt lgkmcnt(0)
  s_barrier
  s_lshl_b32 s35, s94, 12
  s_add_u32 s35, s35, 65536
  v_add_u32 v24, s35, v4
  ds_write_b128 v24, v[48:51] offset:0
  ds_write_b128 v24, v[52:55] offset:1024
  ds_write_b128 v24, v[56:59] offset:2048
  ds_write_b128 v24, v[60:63] offset:3072
  s_waitcnt lgkmcnt(0)
  s_waitcnt vmcnt(16)
  s_barrier
  s_mov_b32 s35, 81920
  v_add_u32 v24, s35, v16
  v_add_u32 v25, s35, v17
  ds_read_b64_tr_b16 v[48:49], v24 offset:0
  ds_read_b64_tr_b16 v[50:51], v24 offset:1024
  ds_read_b64_tr_b16 v[52:53], v24 offset:8192
  ds_read_b64_tr_b16 v[54:55], v24 offset:9216
  ds_read_b64_tr_b16 v[56:57], v25 offset:0
  ds_read_b64_tr_b16 v[58:59], v25 offset:1024
  ds_read_b64_tr_b16 v[60:61], v25 offset:8192
  ds_read_b64_tr_b16 v[62:63], v25 offset:9216
  s_waitcnt lgkmcnt(0)
  s_mov_b32 s35, 0x3e0293ee
  v_lshlrev_b32 v26, 16, v48
  v_and_b32 v27, 0xffff0000, v48
  v_mul_f32 v26, s35, v26
  v_mul_f32 v27, s35, v27
  v_cvt_pk_bf16_f32 v48, v26, v27
  v_lshlrev_b32 v26, 16, v49
  v_and_b32 v27, 0xffff0000, v49
  v_mul_f32 v26, s35, v26
  v_mul_f32 v27, s35, v27
  v_cvt_pk_bf16_f32 v49, v26, v27
  v_lshlrev_b32 v26, 16, v50
  v_and_b32 v27, 0xffff0000, v50
  v_mul_f32 v26, s35, v26
  v_mul_f32 v27, s35, v27
  v_cvt_pk_bf16_f32 v50, v26, v27
  v_lshlrev_b32 v26, 16, v51
  v_and_b32 v27, 0xffff0000, v51
  v_mul_f32 v26, s35, v26
  v_mul_f32 v27, s35, v27
  v_cvt_pk_bf16_f32 v51, v26, v27
  v_lshlrev_b32 v26, 16, v52
  v_and_b32 v27, 0xffff0000, v52
  v_mul_f32 v26, s35, v26
  v_mul_f32 v27, s35, v27
  v_cvt_pk_bf16_f32 v52, v26, v27
  v_lshlrev_b32 v26, 16, v53
  v_and_b32 v27, 0xffff0000, v53
  v_mul_f32 v26, s35, v26
  v_mul_f32 v27, s35, v27
  v_cvt_pk_bf16_f32 v53, v26, v27
  v_lshlrev_b32 v26, 16, v54
  v_and_b32 v27, 0xffff0000, v54
  v_mul_f32 v26, s35, v26
  v_mul_f32 v27, s35, v27
  v_cvt_pk_bf16_f32 v54, v26, v27
  v_lshlrev_b32 v26, 16, v55
  v_and_b32 v27, 0xffff0000, v55
  v_mul_f32 v26, s35, v26
  v_mul_f32 v27, s35, v27
  v_cvt_pk_bf16_f32 v55, v26, v27
  v_lshlrev_b32 v26, 16, v56
  v_and_b32 v27, 0xffff0000, v56
  v_mul_f32 v26, s35, v26
  v_mul_f32 v27, s35, v27
  v_cvt_pk_bf16_f32 v56, v26, v27
  v_lshlrev_b32 v26, 16, v57
  v_and_b32 v27, 0xffff0000, v57
  v_mul_f32 v26, s35, v26
  v_mul_f32 v27, s35, v27
  v_cvt_pk_bf16_f32 v57, v26, v27
  v_lshlrev_b32 v26, 16, v58
  v_and_b32 v27, 0xffff0000, v58
  v_mul_f32 v26, s35, v26
  v_mul_f32 v27, s35, v27
  v_cvt_pk_bf16_f32 v58, v26, v27
  v_lshlrev_b32 v26, 16, v59
  v_and_b32 v27, 0xffff0000, v59
  v_mul_f32 v26, s35, v26
  v_mul_f32 v27, s35, v27
  v_cvt_pk_bf16_f32 v59, v26, v27
  v_lshlrev_b32 v26, 16, v60
  v_and_b32 v27, 0xffff0000, v60
  v_mul_f32 v26, s35, v26
  v_mul_f32 v27, s35, v27
  v_cvt_pk_bf16_f32 v60, v26, v27
  v_lshlrev_b32 v26, 16, v61
  v_and_b32 v27, 0xffff0000, v61
  v_mul_f32 v26, s35, v26
  v_mul_f32 v27, s35, v27
  v_cvt_pk_bf16_f32 v61, v26, v27
  v_lshlrev_b32 v26, 16, v62
  v_and_b32 v27, 0xffff0000, v62
  v_mul_f32 v26, s35, v26
  v_mul_f32 v27, s35, v27
  v_cvt_pk_bf16_f32 v62, v26, v27
  v_lshlrev_b32 v26, 16, v63
  v_and_b32 v27, 0xffff0000, v63
  v_mul_f32 v26, s35, v26
  v_mul_f32 v27, s35, v27
  v_cvt_pk_bf16_f32 v63, v26, v27
  s_barrier
  s_lshl_b32 s35, s94, 12
  s_add_u32 s35, s35, 81920
  v_add_u32 v24, s35, v4
  ds_write_b128 v24, v[48:51] offset:0
  ds_write_b128 v24, v[52:55] offset:1024
  ds_write_b128 v24, v[56:59] offset:2048
  ds_write_b128 v24, v[60:63] offset:3072
  s_waitcnt lgkmcnt(0)
  s_waitcnt vmcnt(12)
  s_barrier
  s_mov_b32 s35, 98304
  v_add_u32 v24, s35, v16
  v_add_u32 v25, s35, v17
  ds_read_b64_tr_b16 v[48:49], v24 offset:0
  ds_read_b64_tr_b16 v[50:51], v24 offset:1024
  ds_read_b64_tr_b16 v[52:53], v24 offset:8192
  ds_read_b64_tr_b16 v[54:55], v24 offset:9216
  ds_read_b64_tr_b16 v[56:57], v25 offset:0
  ds_read_b64_tr_b16 v[58:59], v25 offset:1024
  ds_read_b64_tr_b16 v[60:61], v25 offset:8192
  ds_read_b64_tr_b16 v[62:63], v25 offset:9216
  s_waitcnt lgkmcnt(0)
  s_barrier
  s_lshl_b32 s35, s94, 12
  s_add_u32 s35, s35, 98304
  v_add_u32 v24, s35, v4
  ds_write_b128 v24, v[48:51] offset:0
  ds_write_b128 v24, v[52:55] offset:1024
  ds_write_b128 v24, v[56:59] offset:2048
  ds_write_b128 v24, v[60:63] offset:3072
  s_waitcnt lgkmcnt(0)
  s_waitcnt vmcnt(8)
  s_barrier
  s_mov_b32 s35, 114688
  v_add_u32 v24, s35, v16
  v_add_u32 v25, s35, v17
  ds_read_b64_tr_b16 v[48:49], v24 offset:0
  ds_read_b64_tr_b16 v[50:51], v24 offset:1024
  ds_read_b64_tr_b16 v[52:53], v24 offset:8192
  ds_read_b64_tr_b16 v[54:55], v24 offset:9216
  ds_read_b64_tr_b16 v[56:57], v25 offset:0
  ds_read_b64_tr_b16 v[58:59], v25 offset:1024
  ds_read_b64_tr_b16 v[60:61], v25 offset:8192
  ds_read_b64_tr_b16 v[62:63], v25 offset:9216
  s_waitcnt lgkmcnt(0)
  s_barrier
  s_lshl_b32 s35, s94, 12
  s_add_u32 s35, s35, 114688
  v_add_u32 v24, s35, v4
  ds_write_b128 v24, v[48:51] offset:0
  ds_write_b128 v24, v[52:55] offset:1024
  ds_write_b128 v24, v[56:59] offset:2048
  ds_write_b128 v24, v[60:63] offset:3072
  s_waitcnt lgkmcnt(0)
  s_waitcnt vmcnt(4)
  s_barrier
  s_mov_b32 s35, 131072
  v_add_u32 v24, s35, v18
  ds_read_b64_tr_b16 v[48:49], v24 offset:0
  ds_read_b64_tr_b16 v[50:51], v24 offset:256
  ds_read_b64_tr_b16 v[52:53], v24 offset:1024
  ds_read_b64_tr_b16 v[54:55], v24 offset:1280
  ds_read_b64_tr_b16 v[56:57], v24 offset:8192
  ds_read_b64_tr_b16 v[58:59], v24 offset:8448
  ds_read_b64_tr_b16 v[60:61], v24 offset:9216
  ds_read_b64_tr_b16 v[62:63], v24 offset:9472
  s_waitcnt lgkmcnt(0)
  s_barrier
  s_lshl_b32 s35, s94, 12
  s_add_u32 s35, s35, 131072
  v_add_u32 v24, s35, v4
  ds_write_b128 v24, v[48:51] offset:0
  ds_write_b128 v24, v[52:55] offset:1024
  ds_write_b128 v24, v[56:59] offset:2048
  ds_write_b128 v24, v[60:63] offset:3072
  s_waitcnt lgkmcnt(0)
  s_waitcnt vmcnt(0)
  s_barrier
  s_mov_b32 s35, 147456
  v_add_u32 v24, s35, v18
  ds_read_b64_tr_b16 v[48:49], v24 offset:0
  ds_read_b64_tr_b16 v[50:51], v24 offset:256
  ds_read_b64_tr_b16 v[52:53], v24 offset:1024
  ds_read_b64_tr_b16 v[54:55], v24 offset:1280
  ds_read_b64_tr_b16 v[56:57], v24 offset:8192
  ds_read_b64_tr_b16 v[58:59], v24 offset:8448
  ds_read_b64_tr_b16 v[60:61], v24 offset:9216
  ds_read_b64_tr_b16 v[62:63], v24 offset:9472
  s_waitcnt lgkmcnt(0)
  s_barrier
  s_lshl_b32 s35, s94, 12
  s_add_u32 s35, s35, 147456
  v_add_u32 v24, s35, v4
  ds_write_b128 v24, v[48:51] offset:0
  ds_write_b128 v24, v[52:55] offset:1024
  ds_write_b128 v24, v[56:59] offset:2048
  ds_write_b128 v24, v[60:63] offset:3072
  s_waitcnt lgkmcnt(0)
  v_and_b32 v12, 2, v0
  v_mov_b32 v13, 0x4444
  v_mov_b32 v14, 0xeeee
  v_cmp_eq_u32 vcc, 2, v12
  s_nop 1
  v_cndmask_b32 v1, v13, v14, vcc
  v_and_b32 v12, 15, v0
  v_lshrrev_b32 v13, 2, v12
  v_lshlrev_b32 v13, 1, v13
  v_and_b32 v12, 1, v12
  v_or_b32 v12, v12, v13
  v_lshrrev_b32 v13, 4, v0
  v_lshlrev_b32 v13, 1, v13
  v_sub_u32 v12, v12, v13
  v_mov_b32 v13, 0
  v_mov_b32 v14, 0x3f80
  v_cmp_eq_u32 vcc, 0, v12
  s_nop 1
  v_cndmask_b32 v13, v13, v14, vcc
  v_mov_b32 v14, 0x3f800000
  v_cmp_eq_u32 vcc, 1, v12
  s_nop 1
  v_cndmask_b32 v2, v13, v14, vcc
  v_mov_b32 v3, v2
  s_lshl_b32 s35, s94, 12
  s_add_u32 s35, s35, 16384
  v_add_u32 v8, s35, v4
  v_and_b32 v12, 0xffffffdf, v4
  s_lshl_b32 s35, s94, 10
  s_add_u32 s35, s35, 9216
  v_add_u32 v5, s35, v12
  v_and_b32 v12, 0xfffffff7, v7
  s_lshl_b32 s35, s94, 8
  s_add_u32 s35, s35, 13312
  v_add_u32 v6, s35, v12
  v_add_u32 v7, 13312, v7
  v_lshrrev_b32 v12, 4, v0
  v_and_b32 v13, 15, v0
  v_lshlrev_b32 v13, 4, v13
  v_lshl_add_u32 v9, v12, 9, v13
  s_lshl_b32 s56, s32, 13
  s_lshl_b32 s35, s94, 11
  s_add_u32 s56, s56, s35
  s_lshl_b32 s57, s32, 13
  s_lshl_b32 s35, s94, 10
  s_add_u32 s57, s57, s35
  s_lshl_b32 s58, s94, 16
  s_lshl_b32 s35, s32, 9
  s_add_u32 s58, s58, s35
  s_lshr_b32 s62, s94, 1
  s_add_u32 s62, s62, 16
  s_lshl_b32 s62, s62, 14
  s_add_u32 s62, s62, s35
  s_and_b32 s35, s94, 1
  s_lshl_b32 s35, s35, 2
  s_add_u32 s62, s62, s35
  s_mov_b32 s61, 0
  s_mov_b32 s45, 0
  s_mov_b32 s59, 0
  s_mov_b32 s60, 0
  s_mov_b32 s63, 0
  s_mov_b32 s35, s32
  s_cmp_eq_u32 s94, 0
  s_cbranch_scc1 CH_RED_YES
  s_cmp_eq_u32 s94, 1
  s_cbranch_scc0 CH_RED_NO
  s_and_b32 s98, s32, 7
  s_cmp_eq_u32 s98, 0
  s_cbranch_scc0 CH_RED_NO
  s_lshr_b32 s35, s32, 3
  s_add_u32 s35, s35, 32
  s_mov_b32 s61, 1
CH_RED_YES:
  s_add_u32 s61, s61, 1
  s_lshr_b32 s98, s35, 1
  s_and_b32 s35, s35, 1
  s_lshl_b32 s59, s98, 14
  s_lshl_b32 s99, s35, 8
  s_add_u32 s59, s59, s99
  s_cmp_lt_u32 s98, 16
  s_cbranch_scc0 CH_RED_HI
  s_and_b32 s99, s98, 3
  s_min_u32 s45, s99, 2
  s_lshl_b32 s99, s99, 3
  s_lshr_b32 s98, s98, 2
  s_add_u32 s99, s99, s98
  s_mov_b32 s63, 1024
  s_branch CH_RED_AB
CH_RED_HI:
  s_sub_u32 s99, s98, 16
  s_lshl_b32 s99, s99, 1
  s_add_u32 s99, s99, 32
  s_mov_b32 s63, 256
CH_RED_AB:
  s_lshl_b32 s60, s99, 8
  s_lshl_b32 s35, s35, 7
  s_add_u32 s60, s60, s35
CH_RED_NO:
  v_and_b32 v12, 15, v0
  v_lshrrev_b32 v13, 4, v0
  v_lshlrev_b32 v13, 5, v13
  v_and_b32 v14, 1, v12
  v_lshl_or_b32 v13, v14, 4, v13
  v_bfe_u32 v14, v12, 2, 1
  v_lshl_or_b32 v13, v14, 3, v13
  v_bfe_u32 v14, v12, 1, 1
  v_mul_lo_u32 v14, v14, s63
  v_add_u32 v10, v13, v14
  s_cmp_lt_u32 s94, 2
  s_cbranch_scc1 CH_W23_DONE
  v_lshlrev_b32 v10, 7, v0
  v_mov_b32 v9, 0
CH_W23_DONE:
  s_add_u32 s36, s59, 0
  s_add_u32 s40, s58, 0
  s_add_u32 s37, s59, 4096
  s_add_u32 s41, s58, 16384
  s_add_u32 s38, s59, 8192
  s_add_u32 s42, s58, 32768
  s_add_u32 s39, s59, 12288
  s_add_u32 s43, s58, 49152
  s_lshl_b32 s44, s94, 9
  s_add_u32 s44, s44, 14336
  s_mov_b32 s46, 0x3e0293ee
  s_mov_b32 s47, 0x3e0293ee
  s_mov_b32 s64, s56
  s_add_u32 s65, s56, 16777216
  s_mov_b32 s66, s57
  s_add_u32 s67, s57, 4096
  s_lshl_b32 s68, s32, 8
  s_add_u32 s68, s68, 8192
  s_mov_b32 s69, 0x3f803f80
  s_lshl_b32 s71, s32, 4
  s_lshl_b32 s35, s94, 2
  s_add_u32 s71, s71, s35
  s_add_u32 s71, s71, 20480
  s_lshl_b32 s81, s32, 13
  s_and_b32 s35, s94, 1
  s_lshl_b32 s35, s35, 24
  s_add_u32 s81, s81, s35
  s_add_u32 s82, s81, 16515072
  s_add_u32 s81, s81, 262144
  s_add_u32 s84, s92, 393216
  s_addc_u32 s85, s93, 0
  s_mov_b32 s70, 0x3f80
  v_bfe_u32 v12, v0, 1, 3
  v_cmp_eq_u32 s[72:73], 0, v12
  v_cmp_eq_u32 s[74:75], 1, v12
  v_cmp_eq_u32 s[76:77], 2, v12
  v_cmp_eq_u32 s[78:79], 3, v12
  v_and_b32 v12, 8, v0
  v_cmp_eq_u32 vcc, 0, v12
  s_nop 0
  s_and_b64 s[72:73], s[72:73], vcc
  s_and_b64 s[74:75], s[74:75], vcc
  s_and_b64 s[76:77], s[76:77], vcc
  s_and_b64 s[78:79], s[78:79], vcc
  s_lshl_b32 s48, s94, 10
  s_add_u32 s49, s48, 4096
  s_lshl_b32 s83, s94, 8
  s_add_u32 s50, s83, 8192
  s_mov_b32 s4, 0x05040100
  s_mov_b32 s5, 0x07060302
  s_add_u32 s35, s94, 0
  s_lshl_b32 s98, s35, 10
  v_add_u32 v14, s98, v4
  v_perm_b32 v20, v65, v64, s4
  v_perm_b32 v21, v67, v66, s4
  v_perm_b32 v22, v65, v64, s5
  v_perm_b32 v23, v67, v66, s5
  ds_write_b128 v14, v[20:23] offset:0
  s_nop 1
  s_add_u32 s35, s94, 4
  s_lshl_b32 s98, s35, 10
  v_add_u32 v14, s98, v4
  v_perm_b32 v20, v69, v68, s4
  v_perm_b32 v21, v71, v70, s4
  v_perm_b32 v22, v69, v68, s5
  v_perm_b32 v23, v71, v70, s5
  ds_write_b128 v14, v[20:23] offset:0
  s_nop 1
  s_cmp_eq_u32 s94, 0
  s_cbranch_scc0 CH_M0_DONE
  s_add_u32 s35, s94, 8
  s_lshl_b32 s98, s35, 10
  v_add_u32 v14, s98, v4
  v_perm_b32 v20, v73, v72, s4
  v_perm_b32 v21, v75, v74, s4
  v_perm_b32 v22, v73, v72, s5
  v_perm_b32 v23, v75, v74, s5
  ds_write_b128 v14, v[20:23] offset:0
  s_nop 1
CH_M0_DONE:
  s_waitcnt lgkmcnt(0)
  v_mov_b32 v11, 12
  s_mov_b32 s96, 0
CH_CI_14:
  buffer_load_dword v0, v11, s[28:31], 0 offen sc1
  s_waitcnt vmcnt(0)
  v_readfirstlane_b32 s3, v0
  s_nop 0
  s_cmp_eq_u32 s3, 32
  s_cbranch_scc1 CH_CI_14_ok
  s_sleep 2
  s_add_u32 s96, s96, 1
  s_cmp_lt_u32 s96, 60000
  s_cbranch_scc1 CH_CI_14
  s_branch CH_FAIL
CH_CI_14_ok:
  v_mov_b32 v11, 8
  buffer_load_dword v0, v11, s[28:31], 0 offen sc1
  s_waitcnt vmcnt(0)
  v_readfirstlane_b32 s97, v0
  s_mov_b32 s33, 0
  s_lshl_b32 s51, s32, 8
  s_add_u32 s51, s51, 0
  v_mov_b32 v11, s51
  s_mov_b32 s96, 0
CH_F0_15:
  buffer_load_dword v0, v11, s[24:27], 0 offen sc1
  s_waitcnt vmcnt(0)
  v_readfirstlane_b32 s3, v0
  s_nop 0
  s_cmp_eq_u32 s3, 1
  s_cbranch_scc1 CH_F0_15_ok
  s_sleep 1
  s_add_u32 s96, s96, 1
  s_cmp_lt_u32 s96, 60000
  s_cbranch_scc1 CH_F0_15
  s_branch CH_FAIL
CH_F0_15_ok:
  s_add_u32 s51, s51, 4
  v_mov_b32 v11, s51
  s_mov_b32 s96, 0
CH_F1_16:
  buffer_load_dword v0, v11, s[24:27], 0 offen sc1
  s_waitcnt vmcnt(0)
  v_readfirstlane_b32 s3, v0
  s_nop 0
  s_cmp_eq_u32 s3, 1
  s_cbranch_scc1 CH_F1_16_ok
  s_sleep 1
  s_add_u32 s96, s96, 1
  s_cmp_lt_u32 s96, 60000
  s_cbranch_scc1 CH_F1_16
  s_branch CH_FAIL
CH_F1_16_ok:
  s_add_u32 s51, s51, 4
  ds_read_b128 v[48:51], v8 offset:0
  ds_read_b128 v[52:55], v8 offset:1024
  ds_read_b128 v[56:59], v8 offset:2048
  ds_read_b128 v[60:63], v8 offset:3072
  ds_read_b128 v[64:67], v8 offset:16384
  ds_read_b128 v[68:71], v8 offset:17408
  ds_read_b128 v[72:75], v8 offset:18432
  ds_read_b128 v[76:79], v8 offset:19456
  ds_read_b128 v[40:43], v8 offset:32768
  ds_read_b128 v[44:47], v8 offset:33792
  v_mov_b64 v[24:25], 0
  v_mov_b64 v[26:27], 0
  v_mov_b64 v[28:29], 0
  v_mov_b64 v[30:31], 0
  v_mov_b64 v[32:33], 0
  v_mov_b64 v[34:35], 0
  v_mov_b64 v[36:37], 0
  v_mov_b64 v[38:39], 0
  s_waitcnt lgkmcnt(0)
  s_barrier
  ds_read_b128 v[12:15], v4 offset:0
  ds_read_b128 v[16:19], v4 offset:1024
  ds_read_b128 v[20:23], v4 offset:2048
  s_cmp_eq_u32 s97, 0
  s_cbranch_scc0 CH_STEP_S1
CH_STEP_F1:
  s_waitcnt lgkmcnt(2)
  v_smfmac_f32_16x16x64_bf16 v[24:27], v[12:15], v[48:55], v1
  v_add_u32 v11, 65536, v8
  v_smfmac_f32_16x16x64_bf16 v[28:31], v[12:15], v[56:63], v1
  ds_read_b128 v[48:51], v8 offset:34816
  v_smfmac_f32_16x16x64_bf16 v[32:35], v[12:15], v[64:71], v1
  ds_read_b128 v[52:55], v8 offset:35840
  v_smfmac_f32_16x16x64_bf16 v[36:39], v[12:15], v[72:79], v1
  ds_read_b128 v[12:15], v4 offset:3072
  s_waitcnt lgkmcnt(4)
  v_smfmac_f32_16x16x64_bf16 v[24:27], v[16:19], a[224:231], v1
  ds_read_b128 v[56:59], v8 offset:49152
  v_smfmac_f32_16x16x64_bf16 v[28:31], v[16:19], a[232:239], v1
  ds_read_b128 v[60:63], v8 offset:50176
  v_smfmac_f32_16x16x64_bf16 v[32:35], v[16:19], a[0:7], v1
  buffer_load_dwordx4 v[64:67], v4, s[16:19], s64 offen sc1
  v_smfmac_f32_16x16x64_bf16 v[36:39], v[16:19], a[8:15], v1
  ds_read_b128 v[16:19], v4 offset:4096
  s_waitcnt lgkmcnt(6)
  v_smfmac_f32_16x16x64_bf16 v[24:27], v[20:23], v[40:47], v1
  ds_read_b128 v[40:43], v8 offset:51200
  s_waitcnt lgkmcnt(5)
  v_smfmac_f32_16x16x64_bf16 v[28:31], v[20:23], v[48:55], v1
  ds_read_b128 v[44:47], v8 offset:52224
  v_smfmac_f32_16x16x64_bf16 v[32:35], v[20:23], a[16:23], v1
  buffer_load_dwordx4 v[68:71], v4, s[16:19], s64 offen offset:1024 sc1
  v_smfmac_f32_16x16x64_bf16 v[36:39], v[20:23], a[24:31], v1
  ds_read_b128 v[20:23], v4 offset:5120
  s_waitcnt lgkmcnt(6)
  v_smfmac_f32_16x16x64_bf16 v[24:27], v[12:15], a[240:247], v1
  buffer_load_dwordx4 v[72:75], v4, s[16:19], s65 offen sc1
  v_smfmac_f32_16x16x64_bf16 v[28:31], v[12:15], a[248:255], v1
  buffer_load_dwordx4 v[76:79], v4, s[16:19], s65 offen offset:1024 sc1
  ds_read_b128 v[48:51], v11 offset:0
  s_waitcnt lgkmcnt(5)
  v_smfmac_f32_16x16x64_bf16 v[32:35], v[12:15], v[56:63], v1
  s_cmp_lt_u32 s94, 2
  s_cbranch_scc1 CH_WARM_17_s
  buffer_load_dword v9, v10, s[16:19], s81 offen sc1
  s_branch CH_WARM_17
CH_WARM_17_s:
  buffer_store_dword v4, off, s[24:27], s71
CH_WARM_17:
  ds_read_b128 v[52:55], v11 offset:1024
  ds_read_b128 v[56:59], v11 offset:2048
  s_waitcnt lgkmcnt(4)
  v_smfmac_f32_16x16x64_bf16 v[36:39], v[12:15], v[40:47], v1
  ds_read_b128 v[12:15], v4 offset:6144
  ds_read_b128 v[60:63], v11 offset:3072
  v_smfmac_f32_16x16x64_bf16 v[24:27], v[16:19], v[80:87], v1
  ds_read_b128 v[40:43], v11 offset:16384
  v_smfmac_f32_16x16x64_bf16 v[28:31], v[16:19], v[88:95], v1
  ds_read_b128 v[44:47], v11 offset:17408
  v_smfmac_f32_16x16x64_bf16 v[32:35], v[16:19], a[32:39], v1
  v_smfmac_f32_16x16x64_bf16 v[36:39], v[16:19], a[40:47], v1
  ds_read_b128 v[16:19], v4 offset:7168
  s_waitcnt lgkmcnt(6)
  v_smfmac_f32_16x16x64_bf16 v[24:27], v[20:23], v[48:55], v1
  ds_read_b128 v[48:51], v11 offset:18432
  s_waitcnt lgkmcnt(4)
  v_smfmac_f32_16x16x64_bf16 v[28:31], v[20:23], v[56:63], v1
  ds_read_b128 v[52:55], v11 offset:19456
  v_smfmac_f32_16x16x64_bf16 v[32:35], v[20:23], a[48:55], v1
  ds_read_b128 v[56:59], v11 offset:32768
  v_smfmac_f32_16x16x64_bf16 v[36:39], v[20:23], a[56:63], v1
  ds_read_b128 v[20:23], v4 offset:8192
  v_smfmac_f32_16x16x64_bf16 v[24:27], v[12:15], v[96:103], v1
  ds_read_b128 v[60:63], v11 offset:33792
  v_smfmac_f32_16x16x64_bf16 v[28:31], v[12:15], v[104:111], v1
  s_waitcnt lgkmcnt(6)
  v_smfmac_f32_16x16x64_bf16 v[32:35], v[12:15], v[40:47], v1
  v_mov_b64 v[40:41], 0
  s_waitcnt lgkmcnt(3)
  v_smfmac_f32_16x16x64_bf16 v[36:39], v[12:15], v[48:55], v1
  ds_read_b128 v[12:15], v4 offset:0
  v_smfmac_f32_16x16x64_bf16 v[24:27], v[16:19], v[112:119], v1
  ds_read_b128 v[48:51], v11 offset:34816
  v_smfmac_f32_16x16x64_bf16 v[28:31], v[16:19], v[120:127], v1
  ds_read_b128 v[52:55], v11 offset:35840
  v_smfmac_f32_16x16x64_bf16 v[32:35], v[16:19], a[64:71], v1
  v_mov_b64 v[42:43], 0
  v_smfmac_f32_16x16x64_bf16 v[36:39], v[16:19], a[72:79], v1
  ds_read_b128 v[16:19], v4 offset:1024
  s_waitcnt lgkmcnt(5)
  v_smfmac_f32_16x16x64_bf16 v[24:27], v[20:23], v[128:135], v1
  v_mov_b64 v[44:45], 0
  v_smfmac_f32_16x16x64_bf16 v[28:31], v[20:23], v[136:143], v1
  v_mov_b64 v[46:47], 0
  s_waitcnt lgkmcnt(4)
  v_smfmac_f32_16x16x64_bf16 v[32:35], v[20:23], v[56:63], v1
  s_waitcnt lgkmcnt(1)
  v_smfmac_f32_16x16x64_bf16 v[36:39], v[20:23], v[48:55], v1
  ds_read_b128 v[20:23], v4 offset:2048
  v_smfmac_f32_16x16x64_bf16 v[40:43], v[12:15], a[80:87], v1
  v_smfmac_f32_16x16x64_bf16 v[44:47], v[12:15], a[88:95], v1
  ds_read_b128 v[12:15], v4 offset:3072
  v_cvt_pk_bf16_f32 v24, v24, v25
  v_cvt_pk_bf16_f32 v25, v26, v27
  v_cvt_pk_bf16_f32 v26, v28, v29
  v_cvt_pk_bf16_f32 v27, v30, v31
  v_mfma_f32_16x16x16_bf16 v[28:31], v[24:25], v[2:3], 0
  v_cvt_pk_bf16_f32 v32, v32, v33
  v_cvt_pk_bf16_f32 v33, v34, v35
  v_cvt_pk_bf16_f32 v34, v36, v37
  v_cvt_pk_bf16_f32 v35, v38, v39
  v_mfma_f32_16x16x16_bf16 v[36:39], v[26:27], v[2:3], 0
  v_mfma_f32_16x16x16_bf16 v[48:51], v[32:33], v[2:3], 0
  v_mfma_f32_16x16x16_bf16 v[52:55], v[34:35], v[2:3], 0
  s_waitcnt lgkmcnt(2)
  v_smfmac_f32_16x16x64_bf16 v[40:43], v[16:19], a[96:103], v1
  v_smfmac_f32_16x16x64_bf16 v[44:47], v[16:19], a[104:111], v1
  ds_read_b128 v[16:19], v4 offset:4096
  v_cvt_pk_bf16_f32 v24, v28, v29
  v_cvt_pk_bf16_f32 v25, v30, v31
  v_cvt_pk_bf16_f32 v26, v36, v37
  v_cvt_pk_bf16_f32 v27, v38, v39
  s_waitcnt vmcnt(3)
  s_nop 0
  v_mfma_f32_16x16x32_bf16 v[28:31], v[64:67], v[24:27], 0
  v_cvt_pk_bf16_f32 v32, v48, v49
  v_cvt_pk_bf16_f32 v33, v50, v51
  v_mfma_f32_16x16x32_bf16 v[36:39], v[68:71], v[24:27], 0
  v_cvt_pk_bf16_f32 v34, v52, v53
  v_cvt_pk_bf16_f32 v35, v54, v55
  s_nop 1
  v_mfma_f32_16x16x32_bf16 v[64:67], v[32:35], v[24:27], 0
  buffer_store_dwordx4 v[32:35], v4, s[20:23], s66 offen sc1
  s_waitcnt lgkmcnt(2)
  v_smfmac_f32_16x16x64_bf16 v[40:43], v[20:23], a[112:119], v1
  v_smfmac_f32_16x16x64_bf16 v[44:47], v[20:23], a[120:127], v1
  ds_write2_b64 v5, v[28:29], v[30:31] offset0:0 offset1:4
  ds_write2_b64 v5, v[36:37], v[38:39] offset0:1 offset1:5
  s_nop 1
  ds_write2_b32 v6, v64, v65 offset0:0 offset1:2
  ds_read_b128 v[20:23], v4 offset:5120
  ds_read_b128 v[56:59], v11 offset:49152
  ds_read_b128 v[60:63], v11 offset:50176
  ds_read_b128 v[48:51], v11 offset:51200
  ds_read_b128 v[52:55], v11 offset:52224
  s_waitcnt lgkmcnt(9)
  v_smfmac_f32_16x16x64_bf16 v[40:43], v[12:15], a[128:135], v1
  v_smfmac_f32_16x16x64_bf16 v[44:47], v[12:15], a[136:143], v1
  ds_read_b128 v[12:15], v4 offset:6144
  s_waitcnt lgkmcnt(6)
  s_barrier
  ds_read_b128 v[24:27], v4 offset:9216
  ds_read_b128 v[28:31], v4 offset:10240
  ds_read_b128 v[32:35], v4 offset:11264
  ds_read_b128 v[36:39], v4 offset:12288
  ds_read2st64_b32 v[64:65], v7 offset0:0 offset1:1
  ds_read2st64_b32 v[66:67], v7 offset0:2 offset1:3
  v_smfmac_f32_16x16x64_bf16 v[40:43], v[16:19], a[144:151], v1
  v_smfmac_f32_16x16x64_bf16 v[44:47], v[16:19], a[152:159], v1
  ds_read_b128 v[16:19], v4 offset:7168
  s_waitcnt lgkmcnt(12)
  v_smfmac_f32_16x16x64_bf16 v[40:43], v[20:23], a[160:167], v1
  v_smfmac_f32_16x16x64_bf16 v[44:47], v[20:23], a[168:175], v1
  ds_read_b128 v[20:23], v4 offset:8192
  s_waitcnt lgkmcnt(2)
  v_pk_add_f32 v[24:25], v[24:25], v[28:29]
  v_pk_add_f32 v[26:27], v[26:27], v[30:31]
  v_pk_add_f32 v[32:33], v[32:33], v[36:37]
  v_pk_add_f32 v[34:35], v[34:35], v[38:39]
  v_pk_add_f32 v[64:65], v[64:65], v[66:67]
  v_pk_add_f32 v[24:25], v[24:25], v[32:33]
  v_pk_add_f32 v[26:27], v[26:27], v[34:35]
  v_add_f32 v64, v64, v65
  v_max3_f32 v0, |v24|, |v25|, |v26|
  v_exp_f32 v24, v24
  v_max3_f32 v0, v0, |v27|, |v64|
  v_exp_f32 v25, v25
  v_cmp_lt_f32 vcc, 0x42700000, v0
  v_exp_f32 v26, v26
  v_exp_f32 v27, v27
  v_exp_f32 v64, v64
  s_cbranch_vccnz CH_FB_18
  v_cvt_pk_bf16_f32 v28, v24, v25
  v_cvt_pk_bf16_f32 v30, v26, v27
  v_mov_b32_dpp v65, v64 quad_perm:[2,3,0,1] row_mask:0xf bank_mask:0xf
  v_mov_b32_dpp v29, v28 quad_perm:[2,3,0,1] row_mask:0xf bank_mask:0xf
  v_mov_b32_dpp v31, v30 quad_perm:[2,3,0,1] row_mask:0xf bank_mask:0xf
  v_cvt_pk_bf16_f32 v66, v64, v65
  v_cvt_pk_bf16_f32 v67, v64, v65
CH_FB_18_join:
  s_waitcnt vmcnt(2)
  v_mfma_f32_16x16x32_bf16 v[32:35], v[72:75], v[28:31], 0
  v_mfma_f32_16x16x32_bf16 v[36:39], v[76:79], v[28:31], 0
  v_dot2_f32_bf16 v68, v28, s69, v64
  v_dot2_f32_bf16 v68, v30, s69, v68
  v_add_u32 v0, 131072, v8
  v_smfmac_f32_16x16x64_bf16 v[40:43], v[12:15], a[176:183], v1
  v_smfmac_f32_16x16x64_bf16 v[44:47], v[12:15], a[184:191], v1
  v_add_f32_dpp v68, v68, v68 quad_perm:[2,3,0,1] row_mask:0xf bank_mask:0xf
  ds_read_b128 v[72:75], v0 offset:0
  ds_read_b128 v[76:79], v0 offset:1024
  v_mov_b32 v69, v68
  ds_read_b128 v[24:27], v0 offset:2048
  ds_read_b128 v[28:31], v0 offset:3072
  v_permlane16_swap_b32 v68, v69
  v_add_f32 v68, v68, v69
  s_waitcnt lgkmcnt(5)
  v_smfmac_f32_16x16x64_bf16 v[40:43], v[16:19], a[192:199], v1
  v_mov_b32 v69, v68
  v_smfmac_f32_16x16x64_bf16 v[44:47], v[16:19], a[200:207], v1
  s_nop 0
  v_permlane32_swap_b32 v68, v69
  v_add_f32 v68, v68, v69
  s_waitcnt lgkmcnt(4)
  v_smfmac_f32_16x16x64_bf16 v[40:43], v[20:23], a[208:215], v1
  v_smfmac_f32_16x16x64_bf16 v[44:47], v[20:23], a[216:223], v1
  v_rcp_f32 v68, v68
  s_nop 5
  v_cvt_pk_bf16_f32 v40, v40, v41
  v_cvt_pk_bf16_f32 v41, v42, v43
  v_cvt_pk_bf16_f32 v42, v44, v45
  v_cvt_pk_bf16_f32 v43, v46, v47
  v_lshrrev_b32 v11, 1, v4
  v_mfma_f32_16x16x16_bf16 v[32:35], v[40:41], v[66:67], v[32:35]
  v_mfma_f32_16x16x16_bf16 v[36:39], v[42:43], v[66:67], v[36:39]
  buffer_store_dwordx4 v[40:43], v4, s[20:23], s67 offen sc1
  v_mov_b64 v[20:21], 0
  v_mov_b64 v[22:23], 0
  v_mov_b64 v[44:45], 0
  v_mov_b64 v[46:47], 0
  v_add_u32 v0, s44, v11
  s_mov_b32 vcc_lo, 0x33333333
  s_mov_b32 vcc_hi, 0x33333333
  v_pk_mul_f32 v[32:33], v[32:33], v[68:69] op_sel_hi:[1,0]
  v_pk_mul_f32 v[34:35], v[34:35], v[68:69] op_sel_hi:[1,0]
  v_pk_mul_f32 v[36:37], v[36:37], v[68:69] op_sel_hi:[1,0]
  v_pk_mul_f32 v[38:39], v[38:39], v[68:69] op_sel_hi:[1,0]
  v_cvt_pk_bf16_f32 v32, v32, v33
  v_cvt_pk_bf16_f32 v33, v34, v35
  v_cvt_pk_bf16_f32 v34, v36, v37
  v_cvt_pk_bf16_f32 v35, v38, v39
  s_nop 0
  v_cndmask_b32_dpp v32, v34, v32, vcc quad_perm:[0,1,0,1] row_mask:0xf bank_mask:0xf
  v_cndmask_b32_dpp v33, v35, v33, vcc quad_perm:[0,1,0,1] row_mask:0xf bank_mask:0xf
  s_cmp_eq_u32 s33, 63
  s_cbranch_scc1 CH_LAST
  ds_write_b64 v0, v[32:33]
  v_mov_b64 v[40:41], 0
  v_mov_b64 v[42:43], 0
  v_mov_b64 v[64:65], 0
  v_mov_b64 v[66:67], 0
  v_mov_b64 v[68:69], 0
  v_mov_b64 v[70:71], 0
  v_mov_b64 v[36:37], 0
  v_mov_b64 v[38:39], 0
  s_waitcnt lgkmcnt(0)
  s_barrier
  ds_read2st64_b64 v[12:15], v11 offset0:28 offset1:29
  ds_read2st64_b64 v[16:19], v11 offset0:30 offset1:31
  v_mov_b64 v[32:33], 0
  v_mov_b64 v[34:35], 0
  s_waitcnt lgkmcnt(0)
  v_smfmac_f32_16x16x64_bf16 v[20:23], v[12:15], v[240:247], v1
  v_smfmac_f32_16x16x64_bf16 v[20:23], v[16:19], v[248:255], v1
  v_smfmac_f32_16x16x64_bf16 v[44:47], v[12:15], v[144:151], v1
  v_smfmac_f32_16x16x64_bf16 v[44:47], v[16:19], v[152:159], v1
  v_smfmac_f32_16x16x64_bf16 v[40:43], v[12:15], v[56:63], v1
  v_smfmac_f32_16x16x64_bf16 v[40:43], v[16:19], v[48:55], v1
  v_smfmac_f32_16x16x64_bf16 v[64:67], v[12:15], v[160:167], v1
  s_nop 2
  v_add_f32 v20, v20, v22
  v_add_f32 v21, v21, v23
  v_smfmac_f32_16x16x64_bf16 v[64:67], v[16:19], v[168:175], v1
  v_cvt_pk_bf16_f32 v20, v20, v21
  v_or_b32 v20, 1, v20
  v_smfmac_f32_16x16x64_bf16 v[68:71], v[12:15], v[72:79], v1
  buffer_store_dword v20, v11, s[8:11], s62 offen
  v_mov_b64 v[20:21], 0
  v_smfmac_f32_16x16x64_bf16 v[68:71], v[16:19], v[24:31], v1
  v_mov_b64 v[22:23], 0
  v_smfmac_f32_16x16x64_bf16 v[36:39], v[12:15], v[176:183], v1
  v_add_f32 v44, v44, v46
  v_add_f32 v45, v45, v47
  v_smfmac_f32_16x16x64_bf16 v[36:39], v[16:19], v[184:191], v1
  v_cvt_pk_bf16_f32 v44, v44, v45
  v_or_b32 v44, 1, v44
  v_smfmac_f32_16x16x64_bf16 v[32:35], v[12:15], v[192:199], v1
  v_add_f32 v40, v40, v42
  v_add_f32 v41, v41, v43
  v_smfmac_f32_16x16x64_bf16 v[32:35], v[16:19], v[200:207], v1
  v_cvt_pk_bf16_f32 v45, v40, v41
  buffer_store_dwordx2 v[44:45], v11, s[8:11], s40 offen
  v_smfmac_f32_16x16x64_bf16 v[20:23], v[12:15], v[208:215], v1
  v_mov_b64 v[40:41], 0
  v_mov_b64 v[42:43], 0
  v_smfmac_f32_16x16x64_bf16 v[20:23], v[16:19], v[216:223], v1
  v_add_f32 v64, v64, v66
  v_add_f32 v65, v65, v67
  v_smfmac_f32_16x16x64_bf16 v[40:43], v[12:15], v[224:231], v1
  v_cvt_pk_bf16_f32 v64, v64, v65
  v_or_b32 v64, 1, v64
  v_smfmac_f32_16x16x64_bf16 v[40:43], v[16:19], v[232:239], v1
  v_add_f32 v68, v68, v70
  v_add_f32 v69, v69, v71
  v_cvt_pk_bf16_f32 v65, v68, v69
  buffer_store_dwordx2 v[64:65], v11, s[8:11], s41 offen
  v_add_f32 v36, v36, v38
  v_add_f32 v37, v37, v39
  v_cvt_pk_bf16_f32 v36, v36, v37
  v_or_b32 v36, 1, v36
  v_add_f32 v32, v32, v34
  v_add_f32 v33, v33, v35
  v_cvt_pk_bf16_f32 v37, v32, v33
  buffer_store_dwordx2 v[36:37], v11, s[8:11], s42 offen
  v_add_f32 v20, v20, v22
  v_add_f32 v21, v21, v23
  v_cvt_pk_bf16_f32 v20, v20, v21
  v_or_b32 v20, 1, v20
  v_add_f32 v40, v40, v42
  v_add_f32 v41, v41, v43
  v_cvt_pk_bf16_f32 v21, v40, v41
  buffer_store_dwordx2 v[20:21], v11, s[8:11], s43 offen
  s_load_dword s80, s[84:85], s51 glc
  s_cmp_eq_u32 s61, 0
  s_cbranch_scc1 CH_RED_19_skip
  v_and_b32 v64, 16, v4
  v_lshlrev_b32_e64 v64, v64, s70
  v_cndmask_b32 v60, 0, v64, s[72:73]
  v_cndmask_b32 v61, 0, v64, s[74:75]
  v_cndmask_b32 v62, 0, v64, s[76:77]
  v_cndmask_b32 v63, 0, v64, s[78:79]
  s_cmp_eq_u32 s45, 0
  s_cbranch_scc1 CH_RS_20
  s_cmp_eq_u32 s45, 1
  s_cbranch_scc1 CH_RS_20_1
  s_sleep 5
  s_branch CH_RS_20
CH_RS_20_1:
  s_sleep 4
CH_RS_20:
  s_mov_b32 s96, 0
  s_cmp_eq_u32 s61, 2
  s_cbranch_scc1 CH_RED_19_v1
CH_RED_19_v0:
  buffer_load_dwordx4 v[24:27], v9, s[8:11], s36 offen offset:0 sc1
  buffer_load_dwordx4 v[28:31], v9, s[8:11], s36 offen offset:2048 sc1
  buffer_load_dwordx4 v[32:35], v9, s[8:11], s37 offen offset:0 sc1
  buffer_load_dwordx4 v[36:39], v9, s[8:11], s37 offen offset:2048 sc1
  buffer_load_dwordx4 v[44:47], v9, s[8:11], s38 offen offset:0 sc1
  buffer_load_dwordx4 v[48:51], v9, s[8:11], s38 offen offset:2048 sc1
  buffer_load_dwordx4 v[52:55], v9, s[8:11], s39 offen offset:0 sc1
  buffer_load_dwordx4 v[56:59], v9, s[8:11], s39 offen offset:2048 sc1
  v_mov_b32 v12, 0
  s_waitcnt vmcnt(6)
  v_mfma_f32_16x16x32_bf16 v[64:67], v[24:27], v[60:63], 0
  v_bitop3_b32 v12, v12, v24, v26 bitop3:0xf7
  v_mfma_f32_16x16x32_bf16 v[64:67], v[28:31], v[60:63], v[64:67]
  v_bitop3_b32 v12, v12, v28, v30 bitop3:0xf7
  s_waitcnt vmcnt(4)
  v_mfma_f32_16x16x32_bf16 v[64:67], v[32:35], v[60:63], v[64:67]
  v_bitop3_b32 v12, v12, v32, v34 bitop3:0xf7
  v_mfma_f32_16x16x32_bf16 v[64:67], v[36:39], v[60:63], v[64:67]
  v_bitop3_b32 v12, v12, v36, v38 bitop3:0xf7
  s_waitcnt vmcnt(2)
  v_mfma_f32_16x16x32_bf16 v[64:67], v[44:47], v[60:63], v[64:67]
  v_bitop3_b32 v12, v12, v44, v46 bitop3:0xf7
  v_mfma_f32_16x16x32_bf16 v[64:67], v[48:51], v[60:63], v[64:67]
  v_bitop3_b32 v12, v12, v48, v50 bitop3:0xf7
  s_waitcnt vmcnt(0)
  v_mfma_f32_16x16x32_bf16 v[64:67], v[52:55], v[60:63], v[64:67]
  v_bitop3_b32 v12, v12, v52, v54 bitop3:0xf7
  v_mfma_f32_16x16x32_bf16 v[64:67], v[56:59], v[60:63], v[64:67]
  v_bitop3_b32 v12, v12, v56, v58 bitop3:0xf7
  v_and_b32 v12, 1, v12
  v_cmp_ne_u32 vcc, 0, v12
  s_nop 0
  s_nop 0
  s_cbranch_vccz CH_RED_19_ok
  s_add_u32 s96, s96, 1
  s_cmp_lt_u32 s96, 60000
  s_cbranch_scc1 CH_RED_19_v0
  s_branch CH_FAIL
CH_RED_19_v1:
  buffer_load_dwordx4 v[24:27], v9, s[8:11], s36 offen offset:0 sc1
  buffer_load_dwordx4 v[28:31], v9, s[8:11], s36 offen offset:2048 sc1
  buffer_load_dwordx4 v[32:35], v9, s[8:11], s37 offen offset:0 sc1
  buffer_load_dwordx4 v[36:39], v9, s[8:11], s37 offen offset:2048 sc1
  buffer_load_dwordx4 v[44:47], v9, s[8:11], s38 offen offset:0 sc1
  buffer_load_dwordx4 v[48:51], v9, s[8:11], s38 offen offset:2048 sc1
  buffer_load_dwordx4 v[52:55], v9, s[8:11], s39 offen offset:0 sc1
  buffer_load_dwordx4 v[56:59], v9, s[8:11], s39 offen offset:2048 sc1
  v_mov_b32 v12, 0
  s_waitcnt vmcnt(6)
  v_mfma_f32_16x16x32_bf16 v[64:67], v[24:27], v[60:63], 0
  v_bitop3_b32 v12, v12, v24, v25 bitop3:0xf7
  v_bitop3_b32 v12, v12, v26, v27 bitop3:0xf7
  v_mfma_f32_16x16x32_bf16 v[64:67], v[28:31], v[60:63], v[64:67]
  v_bitop3_b32 v12, v12, v28, v29 bitop3:0xf7
  v_bitop3_b32 v12, v12, v30, v31 bitop3:0xf7
  s_waitcnt vmcnt(4)
  v_mfma_f32_16x16x32_bf16 v[64:67], v[32:35], v[60:63], v[64:67]
  v_bitop3_b32 v12, v12, v32, v33 bitop3:0xf7
  v_bitop3_b32 v12, v12, v34, v35 bitop3:0xf7
  v_mfma_f32_16x16x32_bf16 v[64:67], v[36:39], v[60:63], v[64:67]
  v_bitop3_b32 v12, v12, v36, v37 bitop3:0xf7
  v_bitop3_b32 v12, v12, v38, v39 bitop3:0xf7
  s_waitcnt vmcnt(2)
  v_mfma_f32_16x16x32_bf16 v[64:67], v[44:47], v[60:63], v[64:67]
  v_bitop3_b32 v12, v12, v44, v45 bitop3:0xf7
  v_bitop3_b32 v12, v12, v46, v47 bitop3:0xf7
  v_mfma_f32_16x16x32_bf16 v[64:67], v[48:51], v[60:63], v[64:67]
  v_bitop3_b32 v12, v12, v48, v49 bitop3:0xf7
  v_bitop3_b32 v12, v12, v50, v51 bitop3:0xf7
  s_waitcnt vmcnt(0)
  v_mfma_f32_16x16x32_bf16 v[64:67], v[52:55], v[60:63], v[64:67]
  v_bitop3_b32 v12, v12, v52, v53 bitop3:0xf7
  v_bitop3_b32 v12, v12, v54, v55 bitop3:0xf7
  v_mfma_f32_16x16x32_bf16 v[64:67], v[56:59], v[60:63], v[64:67]
  v_bitop3_b32 v12, v12, v56, v57 bitop3:0xf7
  v_bitop3_b32 v12, v12, v58, v59 bitop3:0xf7
  v_and_b32 v12, 1, v12
  v_cmp_ne_u32 vcc, 0, v12
  s_nop 0
  s_cbranch_vccz CH_RED_19_ok
  s_add_u32 s96, s96, 1
  s_cmp_lt_u32 s96, 60000
  s_cbranch_scc1 CH_RED_19_v1
  s_branch CH_FAIL
CH_RED_19_ok:
  s_mov_b32 exec_lo, 0x00ff00ff
  s_mov_b32 exec_hi, 0x00ff00ff
  v_cvt_pk_bf16_f32 v60, v64, v65
  v_cvt_pk_bf16_f32 v61, v66, v67
  v_or_b32 v60, 1, v60
  buffer_store_dwordx2 v[60:61], v10, s[12:15], s60 offen
  s_mov_b64 exec, -1
CH_RED_19_skip:
  ds_read_b128 v[48:51], v8 offset:0
  ds_read_b128 v[52:55], v8 offset:1024
  ds_read_b128 v[56:59], v8 offset:2048
  ds_read_b128 v[60:63], v8 offset:3072
  ds_read_b128 v[64:67], v8 offset:16384
  ds_read_b128 v[68:71], v8 offset:17408
  ds_read_b128 v[72:75], v8 offset:18432
  ds_read_b128 v[76:79], v8 offset:19456
  ds_read_b128 v[40:43], v8 offset:32768
  ds_read_b128 v[44:47], v8 offset:33792
  v_mov_b64 v[24:25], 0
  v_mov_b64 v[26:27], 0
  v_mov_b64 v[28:29], 0
  v_mov_b64 v[30:31], 0
  v_mov_b64 v[32:33], 0
  v_mov_b64 v[34:35], 0
  v_mov_b64 v[36:37], 0
  v_mov_b64 v[38:39], 0
  s_add_u32 s64, s64, 262144
  s_add_u32 s65, s65, 262144
  s_add_u32 s66, s66, 262144
  s_add_u32 s67, s67, 262144
  s_add_u32 s81, s81, 262144
  s_min_u32 s81, s81, s82
  s_cmp_eq_u32 s61, 0
  s_cbranch_scc0 CH_NW_21
  s_waitcnt vmcnt(0)
CH_NW_21:
  s_barrier
  s_mov_b32 s96, 0
  v_add_u32 v11, s48, v4
CH_GAT_22:
  v_mov_b32 v20, 1
  v_mov_b32 v22, 1
  buffer_load_dwordx4 v[12:15], v4, s[12:15], s48 offen sc1
  buffer_load_dwordx4 v[16:19], v4, s[12:15], s49 offen sc1
  s_mov_b64 exec, 0xffff
  buffer_load_dwordx4 v[20:23], v4, s[12:15], s50 offen sc1
  s_mov_b64 exec, -1
  s_waitcnt vmcnt(0)
  v_bitop3_b32 v0, 0, v12, v14 bitop3:0xf7
  v_bitop3_b32 v0, v0, v16, v18 bitop3:0xf7
  v_bitop3_b32 v0, v0, v20, v22 bitop3:0xf7
  v_and_b32 v0, 1, v0
  v_cmp_ne_u32 vcc, 0, v0
  s_nop 0
  s_cbranch_vccz CH_GAT_22_okA
  s_add_u32 s96, s96, 1
  s_cmp_lt_u32 s96, 60000
  s_cbranch_scc1 CH_GAT_22
  s_branch CH_FAIL
CH_GAT_22_okA:
  ds_write_b128 v11, v[12:15] offset:0
  ds_write_b128 v11, v[16:19] offset:4096
  v_add_u32 v11, s83, v4
  s_mov_b64 exec, 0xffff
  ds_write_b128 v11, v[20:23] offset:8192
  s_mov_b64 exec, -1
  s_cmp_eq_u32 s94, 3
  s_cbranch_scc0 CH_NF_23
  s_mov_b64 exec, 1
  v_mov_b32 v0, 1
  buffer_store_dword v0, off, s[24:27], s68 sc1
  s_mov_b64 exec, -1
CH_NF_23:
  s_waitcnt lgkmcnt(0)
  s_cmp_eq_u32 s80, 1
  s_cbranch_scc1 CH_FK_24
  s_cmp_eq_u32 s94, 3
  s_cbranch_scc0 CH_FK_24
  s_cmp_ge_u32 s33, 62
  s_cbranch_scc1 CH_FK_24
  v_mov_b32 v11, s51
  s_mov_b32 s96, 0
CH_FKV_F1_25:
  buffer_load_dword v0, v11, s[24:27], 0 offen sc1
  s_waitcnt vmcnt(0)
  v_readfirstlane_b32 s3, v0
  s_nop 0
  s_cmp_eq_u32 s3, 1
  s_cbranch_scc1 CH_FKV_F1_25_ok
  s_sleep 1
  s_add_u32 s96, s96, 1
  s_cmp_lt_u32 s96, 60000
  s_cbranch_scc1 CH_FKV_F1_25
  s_branch CH_FAIL
CH_FKV_F1_25_ok:
CH_FK_24:
  s_add_u32 s51, s51, 4
  s_barrier
  ds_read_b128 v[12:15], v4 offset:0
  ds_read_b128 v[16:19], v4 offset:1024
  ds_read_b128 v[20:23], v4 offset:2048
  s_add_u32 s68, s68, 4
  s_add_u32 s33, s33, 1
  s_cmp_lt_u32 s33, 64
  s_cbranch_scc0 CH_DONE
CH_STEP_F0:
  s_waitcnt lgkmcnt(2)
  v_smfmac_f32_16x16x64_bf16 v[24:27], v[12:15], v[48:55], v1
  v_add_u32 v11, 65536, v8
  v_smfmac_f32_16x16x64_bf16 v[28:31], v[12:15], v[56:63], v1
  ds_read_b128 v[48:51], v8 offset:34816
  v_smfmac_f32_16x16x64_bf16 v[32:35], v[12:15], v[64:71], v1
  ds_read_b128 v[52:55], v8 offset:35840
  v_smfmac_f32_16x16x64_bf16 v[36:39], v[12:15], v[72:79], v1
  ds_read_b128 v[12:15], v4 offset:3072
  s_waitcnt lgkmcnt(4)
  v_smfmac_f32_16x16x64_bf16 v[24:27], v[16:19], a[224:231], v1
  ds_read_b128 v[56:59], v8 offset:49152
  v_smfmac_f32_16x16x64_bf16 v[28:31], v[16:19], a[232:239], v1
  ds_read_b128 v[60:63], v8 offset:50176
  v_smfmac_f32_16x16x64_bf16 v[32:35], v[16:19], a[0:7], v1
  buffer_load_dwordx4 v[64:67], v4, s[16:19], s64 offen sc1
  v_smfmac_f32_16x16x64_bf16 v[36:39], v[16:19], a[8:15], v1
  ds_read_b128 v[16:19], v4 offset:4096
  s_waitcnt lgkmcnt(6)
  v_smfmac_f32_16x16x64_bf16 v[24:27], v[20:23], v[40:47], v1
  ds_read_b128 v[40:43], v8 offset:51200
  s_waitcnt lgkmcnt(5)
  v_smfmac_f32_16x16x64_bf16 v[28:31], v[20:23], v[48:55], v1
  ds_read_b128 v[44:47], v8 offset:52224
  v_smfmac_f32_16x16x64_bf16 v[32:35], v[20:23], a[16:23], v1
  buffer_load_dwordx4 v[68:71], v4, s[16:19], s64 offen offset:1024 sc1
  v_smfmac_f32_16x16x64_bf16 v[36:39], v[20:23], a[24:31], v1
  ds_read_b128 v[20:23], v4 offset:5120
  s_waitcnt lgkmcnt(6)
  v_smfmac_f32_16x16x64_bf16 v[24:27], v[12:15], a[240:247], v1
  buffer_load_dwordx4 v[72:75], v4, s[16:19], s65 offen sc1
  v_smfmac_f32_16x16x64_bf16 v[28:31], v[12:15], a[248:255], v1
  buffer_load_dwordx4 v[76:79], v4, s[16:19], s65 offen offset:1024 sc1
  ds_read_b128 v[48:51], v11 offset:0
  s_waitcnt lgkmcnt(5)
  v_smfmac_f32_16x16x64_bf16 v[32:35], v[12:15], v[56:63], v1
  s_cmp_lt_u32 s94, 2
  s_cbranch_scc1 CH_WARM_26_s
  buffer_load_dword v9, v10, s[16:19], s81 offen sc1
  s_branch CH_WARM_26
CH_WARM_26_s:
  buffer_store_dword v4, off, s[24:27], s71
CH_WARM_26:
  ds_read_b128 v[52:55], v11 offset:1024
  ds_read_b128 v[56:59], v11 offset:2048
  s_waitcnt lgkmcnt(4)
  v_smfmac_f32_16x16x64_bf16 v[36:39], v[12:15], v[40:47], v1
  ds_read_b128 v[12:15], v4 offset:6144
  ds_read_b128 v[60:63], v11 offset:3072
  v_smfmac_f32_16x16x64_bf16 v[24:27], v[16:19], v[80:87], v1
  ds_read_b128 v[40:43], v11 offset:16384
  v_smfmac_f32_16x16x64_bf16 v[28:31], v[16:19], v[88:95], v1
  ds_read_b128 v[44:47], v11 offset:17408
  v_smfmac_f32_16x16x64_bf16 v[32:35], v[16:19], a[32:39], v1
  v_smfmac_f32_16x16x64_bf16 v[36:39], v[16:19], a[40:47], v1
  ds_read_b128 v[16:19], v4 offset:7168
  s_waitcnt lgkmcnt(6)
  v_smfmac_f32_16x16x64_bf16 v[24:27], v[20:23], v[48:55], v1
  ds_read_b128 v[48:51], v11 offset:18432
  s_waitcnt lgkmcnt(4)
  v_smfmac_f32_16x16x64_bf16 v[28:31], v[20:23], v[56:63], v1
  ds_read_b128 v[52:55], v11 offset:19456
  v_smfmac_f32_16x16x64_bf16 v[32:35], v[20:23], a[48:55], v1
  ds_read_b128 v[56:59], v11 offset:32768
  v_smfmac_f32_16x16x64_bf16 v[36:39], v[20:23], a[56:63], v1
  ds_read_b128 v[20:23], v4 offset:8192
  v_smfmac_f32_16x16x64_bf16 v[24:27], v[12:15], v[96:103], v1
  ds_read_b128 v[60:63], v11 offset:33792
  v_smfmac_f32_16x16x64_bf16 v[28:31], v[12:15], v[104:111], v1
  s_waitcnt lgkmcnt(6)
  v_smfmac_f32_16x16x64_bf16 v[32:35], v[12:15], v[40:47], v1
  v_mov_b64 v[40:41], 0
  s_waitcnt lgkmcnt(3)
  v_smfmac_f32_16x16x64_bf16 v[36:39], v[12:15], v[48:55], v1
  ds_read_b128 v[12:15], v4 offset:0
  v_smfmac_f32_16x16x64_bf16 v[24:27], v[16:19], v[112:119], v1
  ds_read_b128 v[48:51], v11 offset:34816
  v_smfmac_f32_16x16x64_bf16 v[28:31], v[16:19], v[120:127], v1
  ds_read_b128 v[52:55], v11 offset:35840
  v_smfmac_f32_16x16x64_bf16 v[32:35], v[16:19], a[64:71], v1
  v_mov_b64 v[42:43], 0
  v_smfmac_f32_16x16x64_bf16 v[36:39], v[16:19], a[72:79], v1
  ds_read_b128 v[16:19], v4 offset:1024
  s_waitcnt lgkmcnt(5)
  v_smfmac_f32_16x16x64_bf16 v[24:27], v[20:23], v[128:135], v1
  v_mov_b64 v[44:45], 0
  v_smfmac_f32_16x16x64_bf16 v[28:31], v[20:23], v[136:143], v1
  v_mov_b64 v[46:47], 0
  s_waitcnt lgkmcnt(4)
  v_smfmac_f32_16x16x64_bf16 v[32:35], v[20:23], v[56:63], v1
  s_waitcnt lgkmcnt(1)
  v_smfmac_f32_16x16x64_bf16 v[36:39], v[20:23], v[48:55], v1
  ds_read_b128 v[20:23], v4 offset:2048
  v_smfmac_f32_16x16x64_bf16 v[40:43], v[12:15], a[80:87], v1
  v_smfmac_f32_16x16x64_bf16 v[44:47], v[12:15], a[88:95], v1
  ds_read_b128 v[12:15], v4 offset:3072
  v_cvt_pk_bf16_f32 v24, v24, v25
  v_cvt_pk_bf16_f32 v25, v26, v27
  v_cvt_pk_bf16_f32 v26, v28, v29
  v_cvt_pk_bf16_f32 v27, v30, v31
  v_mfma_f32_16x16x16_bf16 v[28:31], v[24:25], v[2:3], 0
  v_cvt_pk_bf16_f32 v32, v32, v33
  v_cvt_pk_bf16_f32 v33, v34, v35
  v_cvt_pk_bf16_f32 v34, v36, v37
  v_cvt_pk_bf16_f32 v35, v38, v39
  v_mfma_f32_16x16x16_bf16 v[36:39], v[26:27], v[2:3], 0
  v_mfma_f32_16x16x16_bf16 v[48:51], v[32:33], v[2:3], 0
  v_mfma_f32_16x16x16_bf16 v[52:55], v[34:35], v[2:3], 0
  s_waitcnt lgkmcnt(2)
  v_smfmac_f32_16x16x64_bf16 v[40:43], v[16:19], a[96:103], v1
  v_smfmac_f32_16x16x64_bf16 v[44:47], v[16:19], a[104:111], v1
  ds_read_b128 v[16:19], v4 offset:4096
  v_cvt_pk_bf16_f32 v24, v28, v29
  v_cvt_pk_bf16_f32 v25, v30, v31
  v_cvt_pk_bf16_f32 v26, v36, v37
  v_cvt_pk_bf16_f32 v27, v38, v39
  s_waitcnt vmcnt(3)
  s_nop 0
  v_mfma_f32_16x16x32_bf16 v[28:31], v[64:67], v[24:27], 0
  v_cvt_pk_bf16_f32 v32, v48, v49
  v_cvt_pk_bf16_f32 v33, v50, v51
  v_mfma_f32_16x16x32_bf16 v[36:39], v[68:71], v[24:27], 0
  v_cvt_pk_bf16_f32 v34, v52, v53
  v_cvt_pk_bf16_f32 v35, v54, v55
  s_nop 1
  v_mfma_f32_16x16x32_bf16 v[64:67], v[32:35], v[24:27], 0
  buffer_store_dwordx4 v[32:35], v4, s[20:23], s66 offen sc1
  s_waitcnt lgkmcnt(2)
  v_smfmac_f32_16x16x64_bf16 v[40:43], v[20:23], a[112:119], v1
  v_smfmac_f32_16x16x64_bf16 v[44:47], v[20:23], a[120:127], v1
  ds_write2_b64 v5, v[28:29], v[30:31] offset0:0 offset1:4
  ds_write2_b64 v5, v[36:37], v[38:39] offset0:1 offset1:5
  s_nop 1
  ds_write2_b32 v6, v64, v65 offset0:0 offset1:2
  ds_read_b128 v[20:23], v4 offset:5120
  ds_read_b128 v[56:59], v11 offset:49152
  ds_read_b128 v[60:63], v11 offset:50176
  ds_read_b128 v[48:51], v11 offset:51200
  ds_read_b128 v[52:55], v11 offset:52224
  s_waitcnt lgkmcnt(9)
  v_smfmac_f32_16x16x64_bf16 v[40:43], v[12:15], a[128:135], v1
  v_smfmac_f32_16x16x64_bf16 v[44:47], v[12:15], a[136:143], v1
  ds_read_b128 v[12:15], v4 offset:6144
  s_waitcnt lgkmcnt(6)
  s_barrier
  ds_read_b128 v[24:27], v4 offset:9216
  ds_read_b128 v[28:31], v4 offset:10240
  ds_read_b128 v[32:35], v4 offset:11264
  ds_read_b128 v[36:39], v4 offset:12288
  ds_read2st64_b32 v[64:65], v7 offset0:0 offset1:1
  ds_read2st64_b32 v[66:67], v7 offset0:2 offset1:3
  v_smfmac_f32_16x16x64_bf16 v[40:43], v[16:19], a[144:151], v1
  v_smfmac_f32_16x16x64_bf16 v[44:47], v[16:19], a[152:159], v1
  ds_read_b128 v[16:19], v4 offset:7168
  s_waitcnt lgkmcnt(12)
  v_smfmac_f32_16x16x64_bf16 v[40:43], v[20:23], a[160:167], v1
  v_smfmac_f32_16x16x64_bf16 v[44:47], v[20:23], a[168:175], v1
  ds_read_b128 v[20:23], v4 offset:8192
  s_waitcnt lgkmcnt(2)
  v_pk_add_f32 v[24:25], v[24:25], v[28:29]
  v_pk_add_f32 v[26:27], v[26:27], v[30:31]
  v_pk_add_f32 v[32:33], v[32:33], v[36:37]
  v_pk_add_f32 v[34:35], v[34:35], v[38:39]
  v_pk_add_f32 v[64:65], v[64:65], v[66:67]
  v_pk_add_f32 v[24:25], v[24:25], v[32:33]
  v_pk_add_f32 v[26:27], v[26:27], v[34:35]
  v_add_f32 v64, v64, v65
  v_max3_f32 v0, |v24|, |v25|, |v26|
  v_exp_f32 v24, v24
  v_max3_f32 v0, v0, |v27|, |v64|
  v_exp_f32 v25, v25
  v_cmp_lt_f32 vcc, 0x42700000, v0
  v_exp_f32 v26, v26
  v_exp_f32 v27, v27
  v_exp_f32 v64, v64
  s_cbranch_vccnz CH_FB_27
  v_cvt_pk_bf16_f32 v28, v24, v25
  v_cvt_pk_bf16_f32 v30, v26, v27
  v_mov_b32_dpp v65, v64 quad_perm:[2,3,0,1] row_mask:0xf bank_mask:0xf
  v_mov_b32_dpp v29, v28 quad_perm:[2,3,0,1] row_mask:0xf bank_mask:0xf
  v_mov_b32_dpp v31, v30 quad_perm:[2,3,0,1] row_mask:0xf bank_mask:0xf
  v_cvt_pk_bf16_f32 v66, v64, v65
  v_cvt_pk_bf16_f32 v67, v64, v65
CH_FB_27_join:
  s_waitcnt vmcnt(2)
  v_mfma_f32_16x16x32_bf16 v[32:35], v[72:75], v[28:31], 0
  v_mfma_f32_16x16x32_bf16 v[36:39], v[76:79], v[28:31], 0
  v_dot2_f32_bf16 v68, v28, s69, v64
  v_dot2_f32_bf16 v68, v30, s69, v68
  v_add_u32 v0, 131072, v8
  v_smfmac_f32_16x16x64_bf16 v[40:43], v[12:15], a[176:183], v1
  v_smfmac_f32_16x16x64_bf16 v[44:47], v[12:15], a[184:191], v1
  v_add_f32_dpp v68, v68, v68 quad_perm:[2,3,0,1] row_mask:0xf bank_mask:0xf
  ds_read_b128 v[72:75], v0 offset:0
  ds_read_b128 v[76:79], v0 offset:1024
  v_mov_b32 v69, v68
  ds_read_b128 v[24:27], v0 offset:2048
  ds_read_b128 v[28:31], v0 offset:3072
  v_permlane16_swap_b32 v68, v69
  v_add_f32 v68, v68, v69
  s_waitcnt lgkmcnt(5)
  v_smfmac_f32_16x16x64_bf16 v[40:43], v[16:19], a[192:199], v1
  v_mov_b32 v69, v68
  v_smfmac_f32_16x16x64_bf16 v[44:47], v[16:19], a[200:207], v1
  s_nop 0
  v_permlane32_swap_b32 v68, v69
  v_add_f32 v68, v68, v69
  s_waitcnt lgkmcnt(4)
  v_smfmac_f32_16x16x64_bf16 v[40:43], v[20:23], a[208:215], v1
  v_smfmac_f32_16x16x64_bf16 v[44:47], v[20:23], a[216:223], v1
  v_rcp_f32 v68, v68
  s_nop 5
  v_cvt_pk_bf16_f32 v40, v40, v41
  v_cvt_pk_bf16_f32 v41, v42, v43
  v_cvt_pk_bf16_f32 v42, v44, v45
  v_cvt_pk_bf16_f32 v43, v46, v47
  v_lshrrev_b32 v11, 1, v4
  v_mfma_f32_16x16x16_bf16 v[32:35], v[40:41], v[66:67], v[32:35]
  v_mfma_f32_16x16x16_bf16 v[36:39], v[42:43], v[66:67], v[36:39]
  buffer_store_dwordx4 v[40:43], v4, s[20:23], s67 offen sc1
  v_mov_b64 v[20:21], 0
  v_mov_b64 v[22:23], 0
  v_mov_b64 v[44:45], 0
  v_mov_b64 v[46:47], 0
  v_add_u32 v0, s44, v11
  s_mov_b32 vcc_lo, 0x33333333
  s_mov_b32 vcc_hi, 0x33333333
  v_pk_mul_f32 v[32:33], v[32:33], v[68:69] op_sel_hi:[1,0]
  v_pk_mul_f32 v[34:35], v[34:35], v[68:69] op_sel_hi:[1,0]
  v_pk_mul_f32 v[36:37], v[36:37], v[68:69] op_sel_hi:[1,0]
  v_pk_mul_f32 v[38:39], v[38:39], v[68:69] op_sel_hi:[1,0]
  v_cvt_pk_bf16_f32 v32, v32, v33
  v_cvt_pk_bf16_f32 v33, v34, v35
  v_cvt_pk_bf16_f32 v34, v36, v37
  v_cvt_pk_bf16_f32 v35, v38, v39
  s_nop 0
  v_cndmask_b32_dpp v32, v34, v32, vcc quad_perm:[0,1,0,1] row_mask:0xf bank_mask:0xf
  v_cndmask_b32_dpp v33, v35, v33, vcc quad_perm:[0,1,0,1] row_mask:0xf bank_mask:0xf
  s_cmp_eq_u32 s33, 63
  s_cbranch_scc1 CH_LAST
  ds_write_b64 v0, v[32:33]
  v_mov_b64 v[40:41], 0
  v_mov_b64 v[42:43], 0
  v_mov_b64 v[64:65], 0
  v_mov_b64 v[66:67], 0
  v_mov_b64 v[68:69], 0
  v_mov_b64 v[70:71], 0
  v_mov_b64 v[36:37], 0
  v_mov_b64 v[38:39], 0
  s_waitcnt lgkmcnt(0)
  s_barrier
  ds_read2st64_b64 v[12:15], v11 offset0:28 offset1:29
  ds_read2st64_b64 v[16:19], v11 offset0:30 offset1:31
  v_mov_b64 v[32:33], 0
  v_mov_b64 v[34:35], 0
  s_waitcnt lgkmcnt(0)
  v_smfmac_f32_16x16x64_bf16 v[20:23], v[12:15], v[240:247], v1
  v_smfmac_f32_16x16x64_bf16 v[20:23], v[16:19], v[248:255], v1
  v_smfmac_f32_16x16x64_bf16 v[44:47], v[12:15], v[144:151], v1
  v_smfmac_f32_16x16x64_bf16 v[44:47], v[16:19], v[152:159], v1
  v_smfmac_f32_16x16x64_bf16 v[40:43], v[12:15], v[56:63], v1
  v_smfmac_f32_16x16x64_bf16 v[40:43], v[16:19], v[48:55], v1
  v_smfmac_f32_16x16x64_bf16 v[64:67], v[12:15], v[160:167], v1
  s_nop 2
  v_add_f32 v20, v20, v22
  v_add_f32 v21, v21, v23
  v_smfmac_f32_16x16x64_bf16 v[64:67], v[16:19], v[168:175], v1
  v_cvt_pk_bf16_f32 v20, v20, v21
  v_and_b32 v20, -2, v20
  v_smfmac_f32_16x16x64_bf16 v[68:71], v[12:15], v[72:79], v1
  buffer_store_dword v20, v11, s[8:11], s62 offen
  v_mov_b64 v[20:21], 0
  v_smfmac_f32_16x16x64_bf16 v[68:71], v[16:19], v[24:31], v1
  v_mov_b64 v[22:23], 0
  v_smfmac_f32_16x16x64_bf16 v[36:39], v[12:15], v[176:183], v1
  v_add_f32 v44, v44, v46
  v_add_f32 v45, v45, v47
  v_smfmac_f32_16x16x64_bf16 v[36:39], v[16:19], v[184:191], v1
  v_cvt_pk_bf16_f32 v44, v44, v45
  v_and_b32 v44, -2, v44
  v_smfmac_f32_16x16x64_bf16 v[32:35], v[12:15], v[192:199], v1
  v_add_f32 v40, v40, v42
  v_add_f32 v41, v41, v43
  v_smfmac_f32_16x16x64_bf16 v[32:35], v[16:19], v[200:207], v1
  v_cvt_pk_bf16_f32 v45, v40, v41
  buffer_store_dwordx2 v[44:45], v11, s[8:11], s40 offen
  v_smfmac_f32_16x16x64_bf16 v[20:23], v[12:15], v[208:215], v1
  v_mov_b64 v[40:41], 0
  v_mov_b64 v[42:43], 0
  v_smfmac_f32_16x16x64_bf16 v[20:23], v[16:19], v[216:223], v1
  v_add_f32 v64, v64, v66
  v_add_f32 v65, v65, v67
  v_smfmac_f32_16x16x64_bf16 v[40:43], v[12:15], v[224:231], v1
  v_cvt_pk_bf16_f32 v64, v64, v65
  v_and_b32 v64, -2, v64
  v_smfmac_f32_16x16x64_bf16 v[40:43], v[16:19], v[232:239], v1
  v_add_f32 v68, v68, v70
  v_add_f32 v69, v69, v71
  v_cvt_pk_bf16_f32 v65, v68, v69
  buffer_store_dwordx2 v[64:65], v11, s[8:11], s41 offen
  v_add_f32 v36, v36, v38
  v_add_f32 v37, v37, v39
  v_cvt_pk_bf16_f32 v36, v36, v37
  v_and_b32 v36, -2, v36
  v_add_f32 v32, v32, v34
  v_add_f32 v33, v33, v35
  v_cvt_pk_bf16_f32 v37, v32, v33
  buffer_store_dwordx2 v[36:37], v11, s[8:11], s42 offen
  v_add_f32 v20, v20, v22
  v_add_f32 v21, v21, v23
  v_cvt_pk_bf16_f32 v20, v20, v21
  v_and_b32 v20, -2, v20
  v_add_f32 v40, v40, v42
  v_add_f32 v41, v41, v43
  v_cvt_pk_bf16_f32 v21, v40, v41
  buffer_store_dwordx2 v[20:21], v11, s[8:11], s43 offen
  s_load_dword s80, s[84:85], s51 glc
  s_cmp_eq_u32 s61, 0
  s_cbranch_scc1 CH_RED_28_skip
  v_and_b32 v64, 16, v4
  v_lshlrev_b32_e64 v64, v64, s70
  v_cndmask_b32 v60, 0, v64, s[72:73]
  v_cndmask_b32 v61, 0, v64, s[74:75]
  v_cndmask_b32 v62, 0, v64, s[76:77]
  v_cndmask_b32 v63, 0, v64, s[78:79]
  s_cmp_eq_u32 s45, 0
  s_cbranch_scc1 CH_RS_29
  s_cmp_eq_u32 s45, 1
  s_cbranch_scc1 CH_RS_29_1
  s_sleep 5
  s_branch CH_RS_29
CH_RS_29_1:
  s_sleep 4
CH_RS_29:
  s_mov_b32 s96, 0
  s_cmp_eq_u32 s61, 2
  s_cbranch_scc1 CH_RED_28_v1
CH_RED_28_v0:
  buffer_load_dwordx4 v[24:27], v9, s[8:11], s36 offen offset:0 sc1
  buffer_load_dwordx4 v[28:31], v9, s[8:11], s36 offen offset:2048 sc1
  buffer_load_dwordx4 v[32:35], v9, s[8:11], s37 offen offset:0 sc1
  buffer_load_dwordx4 v[36:39], v9, s[8:11], s37 offen offset:2048 sc1
  buffer_load_dwordx4 v[44:47], v9, s[8:11], s38 offen offset:0 sc1
  buffer_load_dwordx4 v[48:51], v9, s[8:11], s38 offen offset:2048 sc1
  buffer_load_dwordx4 v[52:55], v9, s[8:11], s39 offen offset:0 sc1
  buffer_load_dwordx4 v[56:59], v9, s[8:11], s39 offen offset:2048 sc1
  v_mov_b32 v12, 0
  s_waitcnt vmcnt(6)
  v_mfma_f32_16x16x32_bf16 v[64:67], v[24:27], v[60:63], 0
  v_bitop3_b32 v12, v12, v24, v26 bitop3:0xfe
  v_mfma_f32_16x16x32_bf16 v[64:67], v[28:31], v[60:63], v[64:67]
  v_bitop3_b32 v12, v12, v28, v30 bitop3:0xfe
  s_waitcnt vmcnt(4)
  v_mfma_f32_16x16x32_bf16 v[64:67], v[32:35], v[60:63], v[64:67]
  v_bitop3_b32 v12, v12, v32, v34 bitop3:0xfe
  v_mfma_f32_16x16x32_bf16 v[64:67], v[36:39], v[60:63], v[64:67]
  v_bitop3_b32 v12, v12, v36, v38 bitop3:0xfe
  s_waitcnt vmcnt(2)
  v_mfma_f32_16x16x32_bf16 v[64:67], v[44:47], v[60:63], v[64:67]
  v_bitop3_b32 v12, v12, v44, v46 bitop3:0xfe
  v_mfma_f32_16x16x32_bf16 v[64:67], v[48:51], v[60:63], v[64:67]
  v_bitop3_b32 v12, v12, v48, v50 bitop3:0xfe
  s_waitcnt vmcnt(0)
  v_mfma_f32_16x16x32_bf16 v[64:67], v[52:55], v[60:63], v[64:67]
  v_bitop3_b32 v12, v12, v52, v54 bitop3:0xfe
  v_mfma_f32_16x16x32_bf16 v[64:67], v[56:59], v[60:63], v[64:67]
  v_bitop3_b32 v12, v12, v56, v58 bitop3:0xfe
  v_and_b32 v12, 1, v12
  v_cmp_ne_u32 vcc, 0, v12
  s_nop 0
  s_nop 0
  s_cbranch_vccz CH_RED_28_ok
  s_add_u32 s96, s96, 1
  s_cmp_lt_u32 s96, 60000
  s_cbranch_scc1 CH_RED_28_v0
  s_branch CH_FAIL
CH_RED_28_v1:
  buffer_load_dwordx4 v[24:27], v9, s[8:11], s36 offen offset:0 sc1
  buffer_load_dwordx4 v[28:31], v9, s[8:11], s36 offen offset:2048 sc1
  buffer_load_dwordx4 v[32:35], v9, s[8:11], s37 offen offset:0 sc1
  buffer_load_dwordx4 v[36:39], v9, s[8:11], s37 offen offset:2048 sc1
  buffer_load_dwordx4 v[44:47], v9, s[8:11], s38 offen offset:0 sc1
  buffer_load_dwordx4 v[48:51], v9, s[8:11], s38 offen offset:2048 sc1
  buffer_load_dwordx4 v[52:55], v9, s[8:11], s39 offen offset:0 sc1
  buffer_load_dwordx4 v[56:59], v9, s[8:11], s39 offen offset:2048 sc1
  v_mov_b32 v12, 0
  s_waitcnt vmcnt(6)
  v_mfma_f32_16x16x32_bf16 v[64:67], v[24:27], v[60:63], 0
  v_bitop3_b32 v12, v12, v24, v25 bitop3:0xfe
  v_bitop3_b32 v12, v12, v26, v27 bitop3:0xfe
  v_mfma_f32_16x16x32_bf16 v[64:67], v[28:31], v[60:63], v[64:67]
  v_bitop3_b32 v12, v12, v28, v29 bitop3:0xfe
  v_bitop3_b32 v12, v12, v30, v31 bitop3:0xfe
  s_waitcnt vmcnt(4)
  v_mfma_f32_16x16x32_bf16 v[64:67], v[32:35], v[60:63], v[64:67]
  v_bitop3_b32 v12, v12, v32, v33 bitop3:0xfe
  v_bitop3_b32 v12, v12, v34, v35 bitop3:0xfe
  v_mfma_f32_16x16x32_bf16 v[64:67], v[36:39], v[60:63], v[64:67]
  v_bitop3_b32 v12, v12, v36, v37 bitop3:0xfe
  v_bitop3_b32 v12, v12, v38, v39 bitop3:0xfe
  s_waitcnt vmcnt(2)
  v_mfma_f32_16x16x32_bf16 v[64:67], v[44:47], v[60:63], v[64:67]
  v_bitop3_b32 v12, v12, v44, v45 bitop3:0xfe
  v_bitop3_b32 v12, v12, v46, v47 bitop3:0xfe
  v_mfma_f32_16x16x32_bf16 v[64:67], v[48:51], v[60:63], v[64:67]
  v_bitop3_b32 v12, v12, v48, v49 bitop3:0xfe
  v_bitop3_b32 v12, v12, v50, v51 bitop3:0xfe
  s_waitcnt vmcnt(0)
  v_mfma_f32_16x16x32_bf16 v[64:67], v[52:55], v[60:63], v[64:67]
  v_bitop3_b32 v12, v12, v52, v53 bitop3:0xfe
  v_bitop3_b32 v12, v12, v54, v55 bitop3:0xfe
  v_mfma_f32_16x16x32_bf16 v[64:67], v[56:59], v[60:63], v[64:67]
  v_bitop3_b32 v12, v12, v56, v57 bitop3:0xfe
  v_bitop3_b32 v12, v12, v58, v59 bitop3:0xfe
  v_and_b32 v12, 1, v12
  v_cmp_ne_u32 vcc, 0, v12
  s_nop 0
  s_cbranch_vccz CH_RED_28_ok
  s_add_u32 s96, s96, 1
  s_cmp_lt_u32 s96, 60000
  s_cbranch_scc1 CH_RED_28_v1
  s_branch CH_FAIL
CH_RED_28_ok:
  s_mov_b32 exec_lo, 0x00ff00ff
  s_mov_b32 exec_hi, 0x00ff00ff
  v_cvt_pk_bf16_f32 v60, v64, v65
  v_cvt_pk_bf16_f32 v61, v66, v67
  v_and_b32 v60, -2, v60
  buffer_store_dwordx2 v[60:61], v10, s[12:15], s60 offen
  s_mov_b64 exec, -1
CH_RED_28_skip:
  ds_read_b128 v[48:51], v8 offset:0
  ds_read_b128 v[52:55], v8 offset:1024
  ds_read_b128 v[56:59], v8 offset:2048
  ds_read_b128 v[60:63], v8 offset:3072
  ds_read_b128 v[64:67], v8 offset:16384
  ds_read_b128 v[68:71], v8 offset:17408
  ds_read_b128 v[72:75], v8 offset:18432
  ds_read_b128 v[76:79], v8 offset:19456
  ds_read_b128 v[40:43], v8 offset:32768
  ds_read_b128 v[44:47], v8 offset:33792
  v_mov_b64 v[24:25], 0
  v_mov_b64 v[26:27], 0
  v_mov_b64 v[28:29], 0
  v_mov_b64 v[30:31], 0
  v_mov_b64 v[32:33], 0
  v_mov_b64 v[34:35], 0
  v_mov_b64 v[36:37], 0
  v_mov_b64 v[38:39], 0
  s_add_u32 s64, s64, 262144
  s_add_u32 s65, s65, 262144
  s_add_u32 s66, s66, 262144
  s_add_u32 s67, s67, 262144
  s_add_u32 s81, s81, 262144
  s_min_u32 s81, s81, s82
  s_cmp_eq_u32 s61, 0
  s_cbranch_scc0 CH_NW_30
  s_waitcnt vmcnt(0)
CH_NW_30:
  s_barrier
  s_mov_b32 s96, 0
  v_add_u32 v11, s48, v4
CH_GAT_31:
  v_mov_b32 v20, 0
  v_mov_b32 v22, 0
  buffer_load_dwordx4 v[12:15], v4, s[12:15], s48 offen sc1
  buffer_load_dwordx4 v[16:19], v4, s[12:15], s49 offen sc1
  s_mov_b64 exec, 0xffff
  buffer_load_dwordx4 v[20:23], v4, s[12:15], s50 offen sc1
  s_mov_b64 exec, -1
  s_waitcnt vmcnt(0)
  v_bitop3_b32 v0, 0, v12, v14 bitop3:0xfe
  v_bitop3_b32 v0, v0, v16, v18 bitop3:0xfe
  v_bitop3_b32 v0, v0, v20, v22 bitop3:0xfe
  v_and_b32 v0, 1, v0
  v_cmp_ne_u32 vcc, 0, v0
  s_nop 0
  s_cbranch_vccz CH_GAT_31_okA
  s_add_u32 s96, s96, 1
  s_cmp_lt_u32 s96, 60000
  s_cbranch_scc1 CH_GAT_31
  s_branch CH_FAIL
CH_GAT_31_okA:
  ds_write_b128 v11, v[12:15] offset:0
  ds_write_b128 v11, v[16:19] offset:4096
  v_add_u32 v11, s83, v4
  s_mov_b64 exec, 0xffff
  ds_write_b128 v11, v[20:23] offset:8192
  s_mov_b64 exec, -1
  s_cmp_eq_u32 s94, 3
  s_cbranch_scc0 CH_NF_32
  s_mov_b64 exec, 1
  v_mov_b32 v0, 1
  buffer_store_dword v0, off, s[24:27], s68 sc1
  s_mov_b64 exec, -1
CH_NF_32:
  s_waitcnt lgkmcnt(0)
  s_cmp_eq_u32 s80, 1
  s_cbranch_scc1 CH_FK_33
  s_cmp_eq_u32 s94, 3
  s_cbranch_scc0 CH_FK_33
  s_cmp_ge_u32 s33, 62
  s_cbranch_scc1 CH_FK_33
  v_mov_b32 v11, s51
  s_mov_b32 s96, 0
CH_FKV_F0_34:
  buffer_load_dword v0, v11, s[24:27], 0 offen sc1
  s_waitcnt vmcnt(0)
  v_readfirstlane_b32 s3, v0
  s_nop 0
  s_cmp_eq_u32 s3, 1
  s_cbranch_scc1 CH_FKV_F0_34_ok
  s_sleep 1
  s_add_u32 s96, s96, 1
  s_cmp_lt_u32 s96, 60000
  s_cbranch_scc1 CH_FKV_F0_34
  s_branch CH_FAIL
CH_FKV_F0_34_ok:
CH_FK_33:
  s_add_u32 s51, s51, 4
  s_barrier
  ds_read_b128 v[12:15], v4 offset:0
  ds_read_b128 v[16:19], v4 offset:1024
  ds_read_b128 v[20:23], v4 offset:2048
  s_add_u32 s68, s68, 4
  s_add_u32 s33, s33, 1
  s_cmp_lt_u32 s33, 64
  s_cbranch_scc0 CH_DONE
  s_branch CH_STEP_F1
CH_STEP_S1:
  s_waitcnt lgkmcnt(2)
  v_smfmac_f32_16x16x64_bf16 v[24:27], v[12:15], v[48:55], v1
  v_add_u32 v11, 65536, v8
  v_smfmac_f32_16x16x64_bf16 v[28:31], v[12:15], v[56:63], v1
  ds_read_b128 v[48:51], v8 offset:34816
  v_smfmac_f32_16x16x64_bf16 v[32:35], v[12:15], v[64:71], v1
  ds_read_b128 v[52:55], v8 offset:35840
  v_smfmac_f32_16x16x64_bf16 v[36:39], v[12:15], v[72:79], v1
  ds_read_b128 v[12:15], v4 offset:3072
  s_waitcnt lgkmcnt(4)
  v_smfmac_f32_16x16x64_bf16 v[24:27], v[16:19], a[224:231], v1
  ds_read_b128 v[56:59], v8 offset:49152
  v_smfmac_f32_16x16x64_bf16 v[28:31], v[16:19], a[232:239], v1
  ds_read_b128 v[60:63], v8 offset:50176
  v_smfmac_f32_16x16x64_bf16 v[32:35], v[16:19], a[0:7], v1
  buffer_load_dwordx4 v[64:67], v4, s[16:19], s64 offen sc1
  v_smfmac_f32_16x16x64_bf16 v[36:39], v[16:19], a[8:15], v1
  ds_read_b128 v[16:19], v4 offset:4096
  s_waitcnt lgkmcnt(6)
  v_smfmac_f32_16x16x64_bf16 v[24:27], v[20:23], v[40:47], v1
  ds_read_b128 v[40:43], v8 offset:51200
  s_waitcnt lgkmcnt(5)
  v_smfmac_f32_16x16x64_bf16 v[28:31], v[20:23], v[48:55], v1
  ds_read_b128 v[44:47], v8 offset:52224
  v_smfmac_f32_16x16x64_bf16 v[32:35], v[20:23], a[16:23], v1
  buffer_load_dwordx4 v[68:71], v4, s[16:19], s64 offen offset:1024 sc1
  v_smfmac_f32_16x16x64_bf16 v[36:39], v[20:23], a[24:31], v1
  ds_read_b128 v[20:23], v4 offset:5120
  s_waitcnt lgkmcnt(6)
  v_smfmac_f32_16x16x64_bf16 v[24:27], v[12:15], a[240:247], v1
  buffer_load_dwordx4 v[72:75], v4, s[16:19], s65 offen sc1
  v_smfmac_f32_16x16x64_bf16 v[28:31], v[12:15], a[248:255], v1
  buffer_load_dwordx4 v[76:79], v4, s[16:19], s65 offen offset:1024 sc1
  ds_read_b128 v[48:51], v11 offset:0
  s_waitcnt lgkmcnt(5)
  v_smfmac_f32_16x16x64_bf16 v[32:35], v[12:15], v[56:63], v1
  s_cmp_lt_u32 s94, 2
  s_cbranch_scc1 CH_WARM_35_s
  buffer_load_dword v9, v10, s[16:19], s81 offen sc1
  s_branch CH_WARM_35
CH_WARM_35_s:
  buffer_store_dword v4, off, s[24:27], s71
CH_WARM_35:
  ds_read_b128 v[52:55], v11 offset:1024
  ds_read_b128 v[56:59], v11 offset:2048
  s_waitcnt lgkmcnt(4)
  v_smfmac_f32_16x16x64_bf16 v[36:39], v[12:15], v[40:47], v1
  ds_read_b128 v[12:15], v4 offset:6144
  ds_read_b128 v[60:63], v11 offset:3072
  v_smfmac_f32_16x16x64_bf16 v[24:27], v[16:19], v[80:87], v1
  ds_read_b128 v[40:43], v11 offset:16384
  v_smfmac_f32_16x16x64_bf16 v[28:31], v[16:19], v[88:95], v1
  ds_read_b128 v[44:47], v11 offset:17408
  v_smfmac_f32_16x16x64_bf16 v[32:35], v[16:19], a[32:39], v1
  v_smfmac_f32_16x16x64_bf16 v[36:39], v[16:19], a[40:47], v1
  ds_read_b128 v[16:19], v4 offset:7168
  s_waitcnt lgkmcnt(6)
  v_smfmac_f32_16x16x64_bf16 v[24:27], v[20:23], v[48:55], v1
  ds_read_b128 v[48:51], v11 offset:18432
  s_waitcnt lgkmcnt(4)
  v_smfmac_f32_16x16x64_bf16 v[28:31], v[20:23], v[56:63], v1
  ds_read_b128 v[52:55], v11 offset:19456
  v_smfmac_f32_16x16x64_bf16 v[32:35], v[20:23], a[48:55], v1
  ds_read_b128 v[56:59], v11 offset:32768
  v_smfmac_f32_16x16x64_bf16 v[36:39], v[20:23], a[56:63], v1
  ds_read_b128 v[20:23], v4 offset:8192
  v_smfmac_f32_16x16x64_bf16 v[24:27], v[12:15], v[96:103], v1
  ds_read_b128 v[60:63], v11 offset:33792
  v_smfmac_f32_16x16x64_bf16 v[28:31], v[12:15], v[104:111], v1
  s_waitcnt lgkmcnt(6)
  v_smfmac_f32_16x16x64_bf16 v[32:35], v[12:15], v[40:47], v1
  v_mov_b64 v[40:41], 0
  s_waitcnt lgkmcnt(3)
  v_smfmac_f32_16x16x64_bf16 v[36:39], v[12:15], v[48:55], v1
  ds_read_b128 v[12:15], v4 offset:0
  v_smfmac_f32_16x16x64_bf16 v[24:27], v[16:19], v[112:119], v1
  ds_read_b128 v[48:51], v11 offset:34816
  v_smfmac_f32_16x16x64_bf16 v[28:31], v[16:19], v[120:127], v1
  ds_read_b128 v[52:55], v11 offset:35840
  v_smfmac_f32_16x16x64_bf16 v[32:35], v[16:19], a[64:71], v1
  v_mov_b64 v[42:43], 0
  v_smfmac_f32_16x16x64_bf16 v[36:39], v[16:19], a[72:79], v1
  ds_read_b128 v[16:19], v4 offset:1024
  s_waitcnt lgkmcnt(5)
  v_smfmac_f32_16x16x64_bf16 v[24:27], v[20:23], v[128:135], v1
  v_mov_b64 v[44:45], 0
  v_smfmac_f32_16x16x64_bf16 v[28:31], v[20:23], v[136:143], v1
  v_mov_b64 v[46:47], 0
  s_waitcnt lgkmcnt(4)
  v_smfmac_f32_16x16x64_bf16 v[32:35], v[20:23], v[56:63], v1
  s_waitcnt lgkmcnt(1)
  v_smfmac_f32_16x16x64_bf16 v[36:39], v[20:23], v[48:55], v1
  ds_read_b128 v[20:23], v4 offset:2048
  v_smfmac_f32_16x16x64_bf16 v[40:43], v[12:15], a[80:87], v1
  v_smfmac_f32_16x16x64_bf16 v[44:47], v[12:15], a[88:95], v1
  ds_read_b128 v[12:15], v4 offset:3072
  v_cvt_pk_bf16_f32 v24, v24, v25
  v_cvt_pk_bf16_f32 v25, v26, v27
  v_cvt_pk_bf16_f32 v26, v28, v29
  v_cvt_pk_bf16_f32 v27, v30, v31
  v_mfma_f32_16x16x16_bf16 v[28:31], v[24:25], v[2:3], 0
  v_cvt_pk_bf16_f32 v32, v32, v33
  v_cvt_pk_bf16_f32 v33, v34, v35
  v_cvt_pk_bf16_f32 v34, v36, v37
  v_cvt_pk_bf16_f32 v35, v38, v39
  v_mfma_f32_16x16x16_bf16 v[36:39], v[26:27], v[2:3], 0
  v_mfma_f32_16x16x16_bf16 v[48:51], v[32:33], v[2:3], 0
  v_mfma_f32_16x16x16_bf16 v[52:55], v[34:35], v[2:3], 0
  s_waitcnt lgkmcnt(2)
  v_smfmac_f32_16x16x64_bf16 v[40:43], v[16:19], a[96:103], v1
  v_smfmac_f32_16x16x64_bf16 v[44:47], v[16:19], a[104:111], v1
  ds_read_b128 v[16:19], v4 offset:4096
  v_cvt_pk_bf16_f32 v24, v28, v29
  v_cvt_pk_bf16_f32 v25, v30, v31
  v_cvt_pk_bf16_f32 v26, v36, v37
  v_cvt_pk_bf16_f32 v27, v38, v39
  s_waitcnt vmcnt(3)
  s_nop 0
  v_mfma_f32_16x16x32_bf16 v[28:31], v[64:67], v[24:27], 0
  v_cvt_pk_bf16_f32 v32, v48, v49
  v_cvt_pk_bf16_f32 v33, v50, v51
  v_mfma_f32_16x16x32_bf16 v[36:39], v[68:71], v[24:27], 0
  v_cvt_pk_bf16_f32 v34, v52, v53
  v_cvt_pk_bf16_f32 v35, v54, v55
  s_nop 1
  v_mfma_f32_16x16x32_bf16 v[64:67], v[32:35], v[24:27], 0
  buffer_store_dwordx4 v[32:35], v4, s[20:23], s66 offen sc1
  s_waitcnt lgkmcnt(2)
  v_smfmac_f32_16x16x64_bf16 v[40:43], v[20:23], a[112:119], v1
  v_smfmac_f32_16x16x64_bf16 v[44:47], v[20:23], a[120:127], v1
  ds_write2_b64 v5, v[28:29], v[30:31] offset0:0 offset1:4
  ds_write2_b64 v5, v[36:37], v[38:39] offset0:1 offset1:5
  s_nop 1
  ds_write2_b32 v6, v64, v65 offset0:0 offset1:2
  ds_read_b128 v[20:23], v4 offset:5120
  ds_read_b128 v[56:59], v11 offset:49152
  ds_read_b128 v[60:63], v11 offset:50176
  ds_read_b128 v[48:51], v11 offset:51200
  ds_read_b128 v[52:55], v11 offset:52224
  s_waitcnt lgkmcnt(9)
  v_smfmac_f32_16x16x64_bf16 v[40:43], v[12:15], a[128:135], v1
  v_smfmac_f32_16x16x64_bf16 v[44:47], v[12:15], a[136:143], v1
  ds_read_b128 v[12:15], v4 offset:6144
  s_waitcnt lgkmcnt(6)
  s_barrier
  ds_read_b128 v[24:27], v4 offset:9216
  ds_read_b128 v[28:31], v4 offset:10240
  ds_read_b128 v[32:35], v4 offset:11264
  ds_read_b128 v[36:39], v4 offset:12288
  ds_read2st64_b32 v[64:65], v7 offset0:0 offset1:1
  ds_read2st64_b32 v[66:67], v7 offset0:2 offset1:3
  v_smfmac_f32_16x16x64_bf16 v[40:43], v[16:19], a[144:151], v1
  v_smfmac_f32_16x16x64_bf16 v[44:47], v[16:19], a[152:159], v1
  ds_read_b128 v[16:19], v4 offset:7168
  s_waitcnt lgkmcnt(12)
  v_smfmac_f32_16x16x64_bf16 v[40:43], v[20:23], a[160:167], v1
  v_smfmac_f32_16x16x64_bf16 v[44:47], v[20:23], a[168:175], v1
  ds_read_b128 v[20:23], v4 offset:8192
  s_waitcnt lgkmcnt(2)
  v_pk_add_f32 v[24:25], v[24:25], v[28:29]
  v_pk_add_f32 v[26:27], v[26:27], v[30:31]
  v_pk_add_f32 v[32:33], v[32:33], v[36:37]
  v_pk_add_f32 v[34:35], v[34:35], v[38:39]
  v_pk_add_f32 v[64:65], v[64:65], v[66:67]
  v_pk_add_f32 v[24:25], v[24:25], v[32:33]
  v_pk_add_f32 v[26:27], v[26:27], v[34:35]
  v_add_f32 v64, v64, v65
  v_max3_f32 v0, |v24|, |v25|, |v26|
  v_exp_f32 v24, v24
  v_max3_f32 v0, v0, |v27|, |v64|
  v_exp_f32 v25, v25
  v_cmp_lt_f32 vcc, 0x42700000, v0
  v_exp_f32 v26, v26
  v_exp_f32 v27, v27
  v_exp_f32 v64, v64
  s_cbranch_vccnz CH_FB_36
  v_cvt_pk_bf16_f32 v28, v24, v25
  v_cvt_pk_bf16_f32 v30, v26, v27
  v_mov_b32_dpp v65, v64 quad_perm:[2,3,0,1] row_mask:0xf bank_mask:0xf
  v_mov_b32_dpp v29, v28 quad_perm:[2,3,0,1] row_mask:0xf bank_mask:0xf
  v_mov_b32_dpp v31, v30 quad_perm:[2,3,0,1] row_mask:0xf bank_mask:0xf
  v_cvt_pk_bf16_f32 v66, v64, v65
  v_cvt_pk_bf16_f32 v67, v64, v65
CH_FB_36_join:
  s_waitcnt vmcnt(2)
  v_mfma_f32_16x16x32_bf16 v[32:35], v[72:75], v[28:31], 0
  v_mfma_f32_16x16x32_bf16 v[36:39], v[76:79], v[28:31], 0
  v_dot2_f32_bf16 v68, v28, s69, v64
  v_dot2_f32_bf16 v68, v30, s69, v68
  v_add_u32 v0, 131072, v8
  v_smfmac_f32_16x16x64_bf16 v[40:43], v[12:15], a[176:183], v1
  v_smfmac_f32_16x16x64_bf16 v[44:47], v[12:15], a[184:191], v1
  v_add_f32_dpp v68, v68, v68 quad_perm:[2,3,0,1] row_mask:0xf bank_mask:0xf
  ds_read_b128 v[72:75], v0 offset:0
  ds_read_b128 v[76:79], v0 offset:1024
  v_mov_b32 v69, v68
  ds_read_b128 v[24:27], v0 offset:2048
  ds_read_b128 v[28:31], v0 offset:3072
  v_permlane16_swap_b32 v68, v69
  v_add_f32 v68, v68, v69
  s_waitcnt lgkmcnt(5)
  v_smfmac_f32_16x16x64_bf16 v[40:43], v[16:19], a[192:199], v1
  v_mov_b32 v69, v68
  v_smfmac_f32_16x16x64_bf16 v[44:47], v[16:19], a[200:207], v1
  s_nop 0
  v_permlane32_swap_b32 v68, v69
  v_add_f32 v68, v68, v69
  s_waitcnt lgkmcnt(4)
  v_smfmac_f32_16x16x64_bf16 v[40:43], v[20:23], a[208:215], v1
  v_smfmac_f32_16x16x64_bf16 v[44:47], v[20:23], a[216:223], v1
  v_rcp_f32 v68, v68
  s_nop 5
  v_cvt_pk_bf16_f32 v40, v40, v41
  v_cvt_pk_bf16_f32 v41, v42, v43
  v_cvt_pk_bf16_f32 v42, v44, v45
  v_cvt_pk_bf16_f32 v43, v46, v47
  v_lshrrev_b32 v11, 1, v4
  v_mfma_f32_16x16x16_bf16 v[32:35], v[40:41], v[66:67], v[32:35]
  v_mfma_f32_16x16x16_bf16 v[36:39], v[42:43], v[66:67], v[36:39]
  buffer_store_dwordx4 v[40:43], v4, s[20:23], s67 offen sc1
  v_mov_b64 v[20:21], 0
  v_mov_b64 v[22:23], 0
  v_mov_b64 v[44:45], 0
  v_mov_b64 v[46:47], 0
  v_add_u32 v0, s44, v11
  s_mov_b32 vcc_lo, 0x33333333
  s_mov_b32 vcc_hi, 0x33333333
  v_pk_mul_f32 v[32:33], v[32:33], v[68:69] op_sel_hi:[1,0]
  v_pk_mul_f32 v[34:35], v[34:35], v[68:69] op_sel_hi:[1,0]
  v_pk_mul_f32 v[36:37], v[36:37], v[68:69] op_sel_hi:[1,0]
  v_pk_mul_f32 v[38:39], v[38:39], v[68:69] op_sel_hi:[1,0]
  v_cvt_pk_bf16_f32 v32, v32, v33
  v_cvt_pk_bf16_f32 v33, v34, v35
  v_cvt_pk_bf16_f32 v34, v36, v37
  v_cvt_pk_bf16_f32 v35, v38, v39
  s_nop 0
  v_cndmask_b32_dpp v32, v34, v32, vcc quad_perm:[0,1,0,1] row_mask:0xf bank_mask:0xf
  v_cndmask_b32_dpp v33, v35, v33, vcc quad_perm:[0,1,0,1] row_mask:0xf bank_mask:0xf
  s_cmp_eq_u32 s33, 63
  s_cbranch_scc1 CH_LAST
  ds_write_b64 v0, v[32:33]
  v_mov_b64 v[40:41], 0
  v_mov_b64 v[42:43], 0
  v_mov_b64 v[64:65], 0
  v_mov_b64 v[66:67], 0
  v_mov_b64 v[68:69], 0
  v_mov_b64 v[70:71], 0
  v_mov_b64 v[36:37], 0
  v_mov_b64 v[38:39], 0
  s_waitcnt lgkmcnt(0)
  s_barrier
  ds_read2st64_b64 v[12:15], v11 offset0:28 offset1:29
  ds_read2st64_b64 v[16:19], v11 offset0:30 offset1:31
  v_mov_b64 v[32:33], 0
  v_mov_b64 v[34:35], 0
  s_waitcnt lgkmcnt(0)
  v_smfmac_f32_16x16x64_bf16 v[20:23], v[12:15], v[240:247], v1
  v_smfmac_f32_16x16x64_bf16 v[20:23], v[16:19], v[248:255], v1
  v_smfmac_f32_16x16x64_bf16 v[44:47], v[12:15], v[144:151], v1
  v_smfmac_f32_16x16x64_bf16 v[44:47], v[16:19], v[152:159], v1
  v_smfmac_f32_16x16x64_bf16 v[40:43], v[12:15], v[56:63], v1
  v_smfmac_f32_16x16x64_bf16 v[40:43], v[16:19], v[48:55], v1
  v_smfmac_f32_16x16x64_bf16 v[64:67], v[12:15], v[160:167], v1
  s_nop 2
  v_add_f32 v20, v20, v22
  v_add_f32 v21, v21, v23
  v_smfmac_f32_16x16x64_bf16 v[64:67], v[16:19], v[168:175], v1
  v_cvt_pk_bf16_f32 v20, v20, v21
  v_or_b32 v20, 1, v20
  v_smfmac_f32_16x16x64_bf16 v[68:71], v[12:15], v[72:79], v1
  buffer_store_dword v20, v11, s[8:11], s62 offen sc1
  v_mov_b64 v[20:21], 0
  v_smfmac_f32_16x16x64_bf16 v[68:71], v[16:19], v[24:31], v1
  v_mov_b64 v[22:23], 0
  v_smfmac_f32_16x16x64_bf16 v[36:39], v[12:15], v[176:183], v1
  v_add_f32 v44, v44, v46
  v_add_f32 v45, v45, v47
  v_smfmac_f32_16x16x64_bf16 v[36:39], v[16:19], v[184:191], v1
  v_cvt_pk_bf16_f32 v44, v44, v45
  v_or_b32 v44, 1, v44
  v_smfmac_f32_16x16x64_bf16 v[32:35], v[12:15], v[192:199], v1
  v_add_f32 v40, v40, v42
  v_add_f32 v41, v41, v43
  v_smfmac_f32_16x16x64_bf16 v[32:35], v[16:19], v[200:207], v1
  v_cvt_pk_bf16_f32 v45, v40, v41
  buffer_store_dwordx2 v[44:45], v11, s[8:11], s40 offen sc1
  v_smfmac_f32_16x16x64_bf16 v[20:23], v[12:15], v[208:215], v1
  v_mov_b64 v[40:41], 0
  v_mov_b64 v[42:43], 0
  v_smfmac_f32_16x16x64_bf16 v[20:23], v[16:19], v[216:223], v1
  v_add_f32 v64, v64, v66
  v_add_f32 v65, v65, v67
  v_smfmac_f32_16x16x64_bf16 v[40:43], v[12:15], v[224:231], v1
  v_cvt_pk_bf16_f32 v64, v64, v65
  v_or_b32 v64, 1, v64
  v_smfmac_f32_16x16x64_bf16 v[40:43], v[16:19], v[232:239], v1
  v_add_f32 v68, v68, v70
  v_add_f32 v69, v69, v71
  v_cvt_pk_bf16_f32 v65, v68, v69
  buffer_store_dwordx2 v[64:65], v11, s[8:11], s41 offen sc1
  v_add_f32 v36, v36, v38
  v_add_f32 v37, v37, v39
  v_cvt_pk_bf16_f32 v36, v36, v37
  v_or_b32 v36, 1, v36
  v_add_f32 v32, v32, v34
  v_add_f32 v33, v33, v35
  v_cvt_pk_bf16_f32 v37, v32, v33
  buffer_store_dwordx2 v[36:37], v11, s[8:11], s42 offen sc1
  v_add_f32 v20, v20, v22
  v_add_f32 v21, v21, v23
  v_cvt_pk_bf16_f32 v20, v20, v21
  v_or_b32 v20, 1, v20
  v_add_f32 v40, v40, v42
  v_add_f32 v41, v41, v43
  v_cvt_pk_bf16_f32 v21, v40, v41
  buffer_store_dwordx2 v[20:21], v11, s[8:11], s43 offen sc1
  s_load_dword s80, s[84:85], s51 glc
  s_cmp_eq_u32 s61, 0
  s_cbranch_scc1 CH_RED_37_skip
  v_and_b32 v64, 16, v4
  v_lshlrev_b32_e64 v64, v64, s70
  v_cndmask_b32 v60, 0, v64, s[72:73]
  v_cndmask_b32 v61, 0, v64, s[74:75]
  v_cndmask_b32 v62, 0, v64, s[76:77]
  v_cndmask_b32 v63, 0, v64, s[78:79]
  s_cmp_eq_u32 s45, 0
  s_cbranch_scc1 CH_RS_38
  s_cmp_eq_u32 s45, 1
  s_cbranch_scc1 CH_RS_38_1
  s_sleep 5
  s_branch CH_RS_38
CH_RS_38_1:
  s_sleep 4
CH_RS_38:
  s_mov_b32 s96, 0
  s_cmp_eq_u32 s61, 2
  s_cbranch_scc1 CH_RED_37_v1
CH_RED_37_v0:
  buffer_load_dwordx4 v[24:27], v9, s[8:11], s36 offen offset:0 sc1
  buffer_load_dwordx4 v[28:31], v9, s[8:11], s36 offen offset:2048 sc1
  buffer_load_dwordx4 v[32:35], v9, s[8:11], s37 offen offset:0 sc1
  buffer_load_dwordx4 v[36:39], v9, s[8:11], s37 offen offset:2048 sc1
  buffer_load_dwordx4 v[44:47], v9, s[8:11], s38 offen offset:0 sc1
  buffer_load_dwordx4 v[48:51], v9, s[8:11], s38 offen offset:2048 sc1
  buffer_load_dwordx4 v[52:55], v9, s[8:11], s39 offen offset:0 sc1
  buffer_load_dwordx4 v[56:59], v9, s[8:11], s39 offen offset:2048 sc1
  v_mov_b32 v12, 0
  s_waitcnt vmcnt(6)
  v_mfma_f32_16x16x32_bf16 v[64:67], v[24:27], v[60:63], 0
  v_bitop3_b32 v12, v12, v24, v26 bitop3:0xf7
  v_mfma_f32_16x16x32_bf16 v[64:67], v[28:31], v[60:63], v[64:67]
  v_bitop3_b32 v12, v12, v28, v30 bitop3:0xf7
  s_waitcnt vmcnt(4)
  v_mfma_f32_16x16x32_bf16 v[64:67], v[32:35], v[60:63], v[64:67]
  v_bitop3_b32 v12, v12, v32, v34 bitop3:0xf7
  v_mfma_f32_16x16x32_bf16 v[64:67], v[36:39], v[60:63], v[64:67]
  v_bitop3_b32 v12, v12, v36, v38 bitop3:0xf7
  s_waitcnt vmcnt(2)
  v_mfma_f32_16x16x32_bf16 v[64:67], v[44:47], v[60:63], v[64:67]
  v_bitop3_b32 v12, v12, v44, v46 bitop3:0xf7
  v_mfma_f32_16x16x32_bf16 v[64:67], v[48:51], v[60:63], v[64:67]
  v_bitop3_b32 v12, v12, v48, v50 bitop3:0xf7
  s_waitcnt vmcnt(0)
  v_mfma_f32_16x16x32_bf16 v[64:67], v[52:55], v[60:63], v[64:67]
  v_bitop3_b32 v12, v12, v52, v54 bitop3:0xf7
  v_mfma_f32_16x16x32_bf16 v[64:67], v[56:59], v[60:63], v[64:67]
  v_bitop3_b32 v12, v12, v56, v58 bitop3:0xf7
  v_and_b32 v12, 1, v12
  v_cmp_ne_u32 vcc, 0, v12
  s_nop 0
  s_nop 0
  s_cbranch_vccz CH_RED_37_ok
  s_add_u32 s96, s96, 1
  s_cmp_lt_u32 s96, 60000
  s_cbranch_scc1 CH_RED_37_v0
  s_branch CH_FAIL
CH_RED_37_v1:
  buffer_load_dwordx4 v[24:27], v9, s[8:11], s36 offen offset:0 sc1
  buffer_load_dwordx4 v[28:31], v9, s[8:11], s36 offen offset:2048 sc1
  buffer_load_dwordx4 v[32:35], v9, s[8:11], s37 offen offset:0 sc1
  buffer_load_dwordx4 v[36:39], v9, s[8:11], s37 offen offset:2048 sc1
  buffer_load_dwordx4 v[44:47], v9, s[8:11], s38 offen offset:0 sc1
  buffer_load_dwordx4 v[48:51], v9, s[8:11], s38 offen offset:2048 sc1
  buffer_load_dwordx4 v[52:55], v9, s[8:11], s39 offen offset:0 sc1
  buffer_load_dwordx4 v[56:59], v9, s[8:11], s39 offen offset:2048 sc1
  v_mov_b32 v12, 0
  s_waitcnt vmcnt(6)
  v_mfma_f32_16x16x32_bf16 v[64:67], v[24:27], v[60:63], 0
  v_bitop3_b32 v12, v12, v24, v25 bitop3:0xf7
  v_bitop3_b32 v12, v12, v26, v27 bitop3:0xf7
  v_mfma_f32_16x16x32_bf16 v[64:67], v[28:31], v[60:63], v[64:67]
  v_bitop3_b32 v12, v12, v28, v29 bitop3:0xf7
  v_bitop3_b32 v12, v12, v30, v31 bitop3:0xf7
  s_waitcnt vmcnt(4)
  v_mfma_f32_16x16x32_bf16 v[64:67], v[32:35], v[60:63], v[64:67]
  v_bitop3_b32 v12, v12, v32, v33 bitop3:0xf7
  v_bitop3_b32 v12, v12, v34, v35 bitop3:0xf7
  v_mfma_f32_16x16x32_bf16 v[64:67], v[36:39], v[60:63], v[64:67]
  v_bitop3_b32 v12, v12, v36, v37 bitop3:0xf7
  v_bitop3_b32 v12, v12, v38, v39 bitop3:0xf7
  s_waitcnt vmcnt(2)
  v_mfma_f32_16x16x32_bf16 v[64:67], v[44:47], v[60:63], v[64:67]
  v_bitop3_b32 v12, v12, v44, v45 bitop3:0xf7
  v_bitop3_b32 v12, v12, v46, v47 bitop3:0xf7
  v_mfma_f32_16x16x32_bf16 v[64:67], v[48:51], v[60:63], v[64:67]
  v_bitop3_b32 v12, v12, v48, v49 bitop3:0xf7
  v_bitop3_b32 v12, v12, v50, v51 bitop3:0xf7
  s_waitcnt vmcnt(0)
  v_mfma_f32_16x16x32_bf16 v[64:67], v[52:55], v[60:63], v[64:67]
  v_bitop3_b32 v12, v12, v52, v53 bitop3:0xf7
  v_bitop3_b32 v12, v12, v54, v55 bitop3:0xf7
  v_mfma_f32_16x16x32_bf16 v[64:67], v[56:59], v[60:63], v[64:67]
  v_bitop3_b32 v12, v12, v56, v57 bitop3:0xf7
  v_bitop3_b32 v12, v12, v58, v59 bitop3:0xf7
  v_and_b32 v12, 1, v12
  v_cmp_ne_u32 vcc, 0, v12
  s_nop 0
  s_cbranch_vccz CH_RED_37_ok
  s_add_u32 s96, s96, 1
  s_cmp_lt_u32 s96, 60000
  s_cbranch_scc1 CH_RED_37_v1
  s_branch CH_FAIL
CH_RED_37_ok:
  s_mov_b32 exec_lo, 0x00ff00ff
  s_mov_b32 exec_hi, 0x00ff00ff
  v_cvt_pk_bf16_f32 v60, v64, v65
  v_cvt_pk_bf16_f32 v61, v66, v67
  v_or_b32 v60, 1, v60
  buffer_store_dwordx2 v[60:61], v10, s[12:15], s60 offen sc1
  s_mov_b64 exec, -1
CH_RED_37_skip:
  ds_read_b128 v[48:51], v8 offset:0
  ds_read_b128 v[52:55], v8 offset:1024
  ds_read_b128 v[56:59], v8 offset:2048
  ds_read_b128 v[60:63], v8 offset:3072
  ds_read_b128 v[64:67], v8 offset:16384
  ds_read_b128 v[68:71], v8 offset:17408
  ds_read_b128 v[72:75], v8 offset:18432
  ds_read_b128 v[76:79], v8 offset:19456
  ds_read_b128 v[40:43], v8 offset:32768
  ds_read_b128 v[44:47], v8 offset:33792
  v_mov_b64 v[24:25], 0
  v_mov_b64 v[26:27], 0
  v_mov_b64 v[28:29], 0
  v_mov_b64 v[30:31], 0
  v_mov_b64 v[32:33], 0
  v_mov_b64 v[34:35], 0
  v_mov_b64 v[36:37], 0
  v_mov_b64 v[38:39], 0
  s_add_u32 s64, s64, 262144
  s_add_u32 s65, s65, 262144
  s_add_u32 s66, s66, 262144
  s_add_u32 s67, s67, 262144
  s_add_u32 s81, s81, 262144
  s_min_u32 s81, s81, s82
  s_cmp_eq_u32 s61, 0
  s_cbranch_scc0 CH_NW_39
  s_waitcnt vmcnt(0)
CH_NW_39:
  s_barrier
  s_mov_b32 s96, 0
  v_add_u32 v11, s48, v4
CH_GAT_40:
  v_mov_b32 v20, 1
  v_mov_b32 v22, 1
  buffer_load_dwordx4 v[12:15], v4, s[12:15], s48 offen sc1
  buffer_load_dwordx4 v[16:19], v4, s[12:15], s49 offen sc1
  s_mov_b64 exec, 0xffff
  buffer_load_dwordx4 v[20:23], v4, s[12:15], s50 offen sc1
  s_mov_b64 exec, -1
  s_waitcnt vmcnt(0)
  v_bitop3_b32 v0, 0, v12, v14 bitop3:0xf7
  v_bitop3_b32 v0, v0, v16, v18 bitop3:0xf7
  v_bitop3_b32 v0, v0, v20, v22 bitop3:0xf7
  v_and_b32 v0, 1, v0
  v_cmp_ne_u32 vcc, 0, v0
  s_nop 0
  s_cbranch_vccz CH_GAT_40_okA
  s_add_u32 s96, s96, 1
  s_cmp_lt_u32 s96, 60000
  s_cbranch_scc1 CH_GAT_40
  s_branch CH_FAIL
CH_GAT_40_okA:
  ds_write_b128 v11, v[12:15] offset:0
  ds_write_b128 v11, v[16:19] offset:4096
  v_add_u32 v11, s83, v4
  s_mov_b64 exec, 0xffff
  ds_write_b128 v11, v[20:23] offset:8192
  s_mov_b64 exec, -1
  s_cmp_eq_u32 s94, 3
  s_cbranch_scc0 CH_NF_41
  s_mov_b64 exec, 1
  v_mov_b32 v0, 1
  buffer_store_dword v0, off, s[24:27], s68 sc1
  s_mov_b64 exec, -1
CH_NF_41:
  s_waitcnt lgkmcnt(0)
  s_cmp_eq_u32 s80, 1
  s_cbranch_scc1 CH_FK_42
  s_cmp_eq_u32 s94, 3
  s_cbranch_scc0 CH_FK_42
  s_cmp_ge_u32 s33, 62
  s_cbranch_scc1 CH_FK_42
  v_mov_b32 v11, s51
  s_mov_b32 s96, 0
CH_FKV_S1_43:
  buffer_load_dword v0, v11, s[24:27], 0 offen sc1
  s_waitcnt vmcnt(0)
  v_readfirstlane_b32 s3, v0
  s_nop 0
  s_cmp_eq_u32 s3, 1
  s_cbranch_scc1 CH_FKV_S1_43_ok
  s_sleep 1
  s_add_u32 s96, s96, 1
  s_cmp_lt_u32 s96, 60000
  s_cbranch_scc1 CH_FKV_S1_43
  s_branch CH_FAIL
CH_FKV_S1_43_ok:
CH_FK_42:
  s_add_u32 s51, s51, 4
  s_barrier
  ds_read_b128 v[12:15], v4 offset:0
  ds_read_b128 v[16:19], v4 offset:1024
  ds_read_b128 v[20:23], v4 offset:2048
  s_add_u32 s68, s68, 4
  s_add_u32 s33, s33, 1
  s_cmp_lt_u32 s33, 64
  s_cbranch_scc0 CH_DONE
CH_STEP_S0:
  s_waitcnt lgkmcnt(2)
  v_smfmac_f32_16x16x64_bf16 v[24:27], v[12:15], v[48:55], v1
  v_add_u32 v11, 65536, v8
  v_smfmac_f32_16x16x64_bf16 v[28:31], v[12:15], v[56:63], v1
  ds_read_b128 v[48:51], v8 offset:34816
  v_smfmac_f32_16x16x64_bf16 v[32:35], v[12:15], v[64:71], v1
  ds_read_b128 v[52:55], v8 offset:35840
  v_smfmac_f32_16x16x64_bf16 v[36:39], v[12:15], v[72:79], v1
  ds_read_b128 v[12:15], v4 offset:3072
  s_waitcnt lgkmcnt(4)
  v_smfmac_f32_16x16x64_bf16 v[24:27], v[16:19], a[224:231], v1
  ds_read_b128 v[56:59], v8 offset:49152
  v_smfmac_f32_16x16x64_bf16 v[28:31], v[16:19], a[232:239], v1
  ds_read_b128 v[60:63], v8 offset:50176
  v_smfmac_f32_16x16x64_bf16 v[32:35], v[16:19], a[0:7], v1
  buffer_load_dwordx4 v[64:67], v4, s[16:19], s64 offen sc1
  v_smfmac_f32_16x16x64_bf16 v[36:39], v[16:19], a[8:15], v1
  ds_read_b128 v[16:19], v4 offset:4096
  s_waitcnt lgkmcnt(6)
  v_smfmac_f32_16x16x64_bf16 v[24:27], v[20:23], v[40:47], v1
  ds_read_b128 v[40:43], v8 offset:51200
  s_waitcnt lgkmcnt(5)
  v_smfmac_f32_16x16x64_bf16 v[28:31], v[20:23], v[48:55], v1
  ds_read_b128 v[44:47], v8 offset:52224
  v_smfmac_f32_16x16x64_bf16 v[32:35], v[20:23], a[16:23], v1
  buffer_load_dwordx4 v[68:71], v4, s[16:19], s64 offen offset:1024 sc1
  v_smfmac_f32_16x16x64_bf16 v[36:39], v[20:23], a[24:31], v1
  ds_read_b128 v[20:23], v4 offset:5120
  s_waitcnt lgkmcnt(6)
  v_smfmac_f32_16x16x64_bf16 v[24:27], v[12:15], a[240:247], v1
  buffer_load_dwordx4 v[72:75], v4, s[16:19], s65 offen sc1
  v_smfmac_f32_16x16x64_bf16 v[28:31], v[12:15], a[248:255], v1
  buffer_load_dwordx4 v[76:79], v4, s[16:19], s65 offen offset:1024 sc1
  ds_read_b128 v[48:51], v11 offset:0
  s_waitcnt lgkmcnt(5)
  v_smfmac_f32_16x16x64_bf16 v[32:35], v[12:15], v[56:63], v1
  s_cmp_lt_u32 s94, 2
  s_cbranch_scc1 CH_WARM_44_s
  buffer_load_dword v9, v10, s[16:19], s81 offen sc1
  s_branch CH_WARM_44
CH_WARM_44_s:
  buffer_store_dword v4, off, s[24:27], s71
CH_WARM_44:
  ds_read_b128 v[52:55], v11 offset:1024
  ds_read_b128 v[56:59], v11 offset:2048
  s_waitcnt lgkmcnt(4)
  v_smfmac_f32_16x16x64_bf16 v[36:39], v[12:15], v[40:47], v1
  ds_read_b128 v[12:15], v4 offset:6144
  ds_read_b128 v[60:63], v11 offset:3072
  v_smfmac_f32_16x16x64_bf16 v[24:27], v[16:19], v[80:87], v1
  ds_read_b128 v[40:43], v11 offset:16384
  v_smfmac_f32_16x16x64_bf16 v[28:31], v[16:19], v[88:95], v1
  ds_read_b128 v[44:47], v11 offset:17408
  v_smfmac_f32_16x16x64_bf16 v[32:35], v[16:19], a[32:39], v1
  v_smfmac_f32_16x16x64_bf16 v[36:39], v[16:19], a[40:47], v1
  ds_read_b128 v[16:19], v4 offset:7168
  s_waitcnt lgkmcnt(6)
  v_smfmac_f32_16x16x64_bf16 v[24:27], v[20:23], v[48:55], v1
  ds_read_b128 v[48:51], v11 offset:18432
  s_waitcnt lgkmcnt(4)
  v_smfmac_f32_16x16x64_bf16 v[28:31], v[20:23], v[56:63], v1
  ds_read_b128 v[52:55], v11 offset:19456
  v_smfmac_f32_16x16x64_bf16 v[32:35], v[20:23], a[48:55], v1
  ds_read_b128 v[56:59], v11 offset:32768
  v_smfmac_f32_16x16x64_bf16 v[36:39], v[20:23], a[56:63], v1
  ds_read_b128 v[20:23], v4 offset:8192
  v_smfmac_f32_16x16x64_bf16 v[24:27], v[12:15], v[96:103], v1
  ds_read_b128 v[60:63], v11 offset:33792
  v_smfmac_f32_16x16x64_bf16 v[28:31], v[12:15], v[104:111], v1
  s_waitcnt lgkmcnt(6)
  v_smfmac_f32_16x16x64_bf16 v[32:35], v[12:15], v[40:47], v1
  v_mov_b64 v[40:41], 0
  s_waitcnt lgkmcnt(3)
  v_smfmac_f32_16x16x64_bf16 v[36:39], v[12:15], v[48:55], v1
  ds_read_b128 v[12:15], v4 offset:0
  v_smfmac_f32_16x16x64_bf16 v[24:27], v[16:19], v[112:119], v1
  ds_read_b128 v[48:51], v11 offset:34816
  v_smfmac_f32_16x16x64_bf16 v[28:31], v[16:19], v[120:127], v1
  ds_read_b128 v[52:55], v11 offset:35840
  v_smfmac_f32_16x16x64_bf16 v[32:35], v[16:19], a[64:71], v1
  v_mov_b64 v[42:43], 0
  v_smfmac_f32_16x16x64_bf16 v[36:39], v[16:19], a[72:79], v1
  ds_read_b128 v[16:19], v4 offset:1024
  s_waitcnt lgkmcnt(5)
  v_smfmac_f32_16x16x64_bf16 v[24:27], v[20:23], v[128:135], v1
  v_mov_b64 v[44:45], 0
  v_smfmac_f32_16x16x64_bf16 v[28:31], v[20:23], v[136:143], v1
  v_mov_b64 v[46:47], 0
  s_waitcnt lgkmcnt(4)
  v_smfmac_f32_16x16x64_bf16 v[32:35], v[20:23], v[56:63], v1
  s_waitcnt lgkmcnt(1)
  v_smfmac_f32_16x16x64_bf16 v[36:39], v[20:23], v[48:55], v1
  ds_read_b128 v[20:23], v4 offset:2048
  v_smfmac_f32_16x16x64_bf16 v[40:43], v[12:15], a[80:87], v1
  v_smfmac_f32_16x16x64_bf16 v[44:47], v[12:15], a[88:95], v1
  ds_read_b128 v[12:15], v4 offset:3072
  v_cvt_pk_bf16_f32 v24, v24, v25
  v_cvt_pk_bf16_f32 v25, v26, v27
  v_cvt_pk_bf16_f32 v26, v28, v29
  v_cvt_pk_bf16_f32 v27, v30, v31
  v_mfma_f32_16x16x16_bf16 v[28:31], v[24:25], v[2:3], 0
  v_cvt_pk_bf16_f32 v32, v32, v33
  v_cvt_pk_bf16_f32 v33, v34, v35
  v_cvt_pk_bf16_f32 v34, v36, v37
  v_cvt_pk_bf16_f32 v35, v38, v39
  v_mfma_f32_16x16x16_bf16 v[36:39], v[26:27], v[2:3], 0
  v_mfma_f32_16x16x16_bf16 v[48:51], v[32:33], v[2:3], 0
  v_mfma_f32_16x16x16_bf16 v[52:55], v[34:35], v[2:3], 0
  s_waitcnt lgkmcnt(2)
  v_smfmac_f32_16x16x64_bf16 v[40:43], v[16:19], a[96:103], v1
  v_smfmac_f32_16x16x64_bf16 v[44:47], v[16:19], a[104:111], v1
  ds_read_b128 v[16:19], v4 offset:4096
  v_cvt_pk_bf16_f32 v24, v28, v29
  v_cvt_pk_bf16_f32 v25, v30, v31
  v_cvt_pk_bf16_f32 v26, v36, v37
  v_cvt_pk_bf16_f32 v27, v38, v39
  s_waitcnt vmcnt(3)
  s_nop 0
  v_mfma_f32_16x16x32_bf16 v[28:31], v[64:67], v[24:27], 0
  v_cvt_pk_bf16_f32 v32, v48, v49
  v_cvt_pk_bf16_f32 v33, v50, v51
  v_mfma_f32_16x16x32_bf16 v[36:39], v[68:71], v[24:27], 0
  v_cvt_pk_bf16_f32 v34, v52, v53
  v_cvt_pk_bf16_f32 v35, v54, v55
  s_nop 1
  v_mfma_f32_16x16x32_bf16 v[64:67], v[32:35], v[24:27], 0
  buffer_store_dwordx4 v[32:35], v4, s[20:23], s66 offen sc1
  s_waitcnt lgkmcnt(2)
  v_smfmac_f32_16x16x64_bf16 v[40:43], v[20:23], a[112:119], v1
  v_smfmac_f32_16x16x64_bf16 v[44:47], v[20:23], a[120:127], v1
  ds_write2_b64 v5, v[28:29], v[30:31] offset0:0 offset1:4
  ds_write2_b64 v5, v[36:37], v[38:39] offset0:1 offset1:5
  s_nop 1
  ds_write2_b32 v6, v64, v65 offset0:0 offset1:2
  ds_read_b128 v[20:23], v4 offset:5120
  ds_read_b128 v[56:59], v11 offset:49152
  ds_read_b128 v[60:63], v11 offset:50176
  ds_read_b128 v[48:51], v11 offset:51200
  ds_read_b128 v[52:55], v11 offset:52224
  s_waitcnt lgkmcnt(9)
  v_smfmac_f32_16x16x64_bf16 v[40:43], v[12:15], a[128:135], v1
  v_smfmac_f32_16x16x64_bf16 v[44:47], v[12:15], a[136:143], v1
  ds_read_b128 v[12:15], v4 offset:6144
  s_waitcnt lgkmcnt(6)
  s_barrier
  ds_read_b128 v[24:27], v4 offset:9216
  ds_read_b128 v[28:31], v4 offset:10240
  ds_read_b128 v[32:35], v4 offset:11264
  ds_read_b128 v[36:39], v4 offset:12288
  ds_read2st64_b32 v[64:65], v7 offset0:0 offset1:1
  ds_read2st64_b32 v[66:67], v7 offset0:2 offset1:3
  v_smfmac_f32_16x16x64_bf16 v[40:43], v[16:19], a[144:151], v1
  v_smfmac_f32_16x16x64_bf16 v[44:47], v[16:19], a[152:159], v1
  ds_read_b128 v[16:19], v4 offset:7168
  s_waitcnt lgkmcnt(12)
  v_smfmac_f32_16x16x64_bf16 v[40:43], v[20:23], a[160:167], v1
  v_smfmac_f32_16x16x64_bf16 v[44:47], v[20:23], a[168:175], v1
  ds_read_b128 v[20:23], v4 offset:8192
  s_waitcnt lgkmcnt(2)
  v_pk_add_f32 v[24:25], v[24:25], v[28:29]
  v_pk_add_f32 v[26:27], v[26:27], v[30:31]
  v_pk_add_f32 v[32:33], v[32:33], v[36:37]
  v_pk_add_f32 v[34:35], v[34:35], v[38:39]
  v_pk_add_f32 v[64:65], v[64:65], v[66:67]
  v_pk_add_f32 v[24:25], v[24:25], v[32:33]
  v_pk_add_f32 v[26:27], v[26:27], v[34:35]
  v_add_f32 v64, v64, v65
  v_max3_f32 v0, |v24|, |v25|, |v26|
  v_exp_f32 v24, v24
  v_max3_f32 v0, v0, |v27|, |v64|
  v_exp_f32 v25, v25
  v_cmp_lt_f32 vcc, 0x42700000, v0
  v_exp_f32 v26, v26
  v_exp_f32 v27, v27
  v_exp_f32 v64, v64
  s_cbranch_vccnz CH_FB_45
  v_cvt_pk_bf16_f32 v28, v24, v25
  v_cvt_pk_bf16_f32 v30, v26, v27
  v_mov_b32_dpp v65, v64 quad_perm:[2,3,0,1] row_mask:0xf bank_mask:0xf
  v_mov_b32_dpp v29, v28 quad_perm:[2,3,0,1] row_mask:0xf bank_mask:0xf
  v_mov_b32_dpp v31, v30 quad_perm:[2,3,0,1] row_mask:0xf bank_mask:0xf
  v_cvt_pk_bf16_f32 v66, v64, v65
  v_cvt_pk_bf16_f32 v67, v64, v65
CH_FB_45_join:
  s_waitcnt vmcnt(2)
  v_mfma_f32_16x16x32_bf16 v[32:35], v[72:75], v[28:31], 0
  v_mfma_f32_16x16x32_bf16 v[36:39], v[76:79], v[28:31], 0
  v_dot2_f32_bf16 v68, v28, s69, v64
  v_dot2_f32_bf16 v68, v30, s69, v68
  v_add_u32 v0, 131072, v8
  v_smfmac_f32_16x16x64_bf16 v[40:43], v[12:15], a[176:183], v1
  v_smfmac_f32_16x16x64_bf16 v[44:47], v[12:15], a[184:191], v1
  v_add_f32_dpp v68, v68, v68 quad_perm:[2,3,0,1] row_mask:0xf bank_mask:0xf
  ds_read_b128 v[72:75], v0 offset:0
  ds_read_b128 v[76:79], v0 offset:1024
  v_mov_b32 v69, v68
  ds_read_b128 v[24:27], v0 offset:2048
  ds_read_b128 v[28:31], v0 offset:3072
  v_permlane16_swap_b32 v68, v69
  v_add_f32 v68, v68, v69
  s_waitcnt lgkmcnt(5)
  v_smfmac_f32_16x16x64_bf16 v[40:43], v[16:19], a[192:199], v1
  v_mov_b32 v69, v68
  v_smfmac_f32_16x16x64_bf16 v[44:47], v[16:19], a[200:207], v1
  s_nop 0
  v_permlane32_swap_b32 v68, v69
  v_add_f32 v68, v68, v69
  s_waitcnt lgkmcnt(4)
  v_smfmac_f32_16x16x64_bf16 v[40:43], v[20:23], a[208:215], v1
  v_smfmac_f32_16x16x64_bf16 v[44:47], v[20:23], a[216:223], v1
  v_rcp_f32 v68, v68
  s_nop 5
  v_cvt_pk_bf16_f32 v40, v40, v41
  v_cvt_pk_bf16_f32 v41, v42, v43
  v_cvt_pk_bf16_f32 v42, v44, v45
  v_cvt_pk_bf16_f32 v43, v46, v47
  v_lshrrev_b32 v11, 1, v4
  v_mfma_f32_16x16x16_bf16 v[32:35], v[40:41], v[66:67], v[32:35]
  v_mfma_f32_16x16x16_bf16 v[36:39], v[42:43], v[66:67], v[36:39]
  buffer_store_dwordx4 v[40:43], v4, s[20:23], s67 offen sc1
  v_mov_b64 v[20:21], 0
  v_mov_b64 v[22:23], 0
  v_mov_b64 v[44:45], 0
  v_mov_b64 v[46:47], 0
  v_add_u32 v0, s44, v11
  s_mov_b32 vcc_lo, 0x33333333
  s_mov_b32 vcc_hi, 0x33333333
  v_pk_mul_f32 v[32:33], v[32:33], v[68:69] op_sel_hi:[1,0]
  v_pk_mul_f32 v[34:35], v[34:35], v[68:69] op_sel_hi:[1,0]
  v_pk_mul_f32 v[36:37], v[36:37], v[68:69] op_sel_hi:[1,0]
  v_pk_mul_f32 v[38:39], v[38:39], v[68:69] op_sel_hi:[1,0]
  v_cvt_pk_bf16_f32 v32, v32, v33
  v_cvt_pk_bf16_f32 v33, v34, v35
  v_cvt_pk_bf16_f32 v34, v36, v37
  v_cvt_pk_bf16_f32 v35, v38, v39
  s_nop 0
  v_cndmask_b32_dpp v32, v34, v32, vcc quad_perm:[0,1,0,1] row_mask:0xf bank_mask:0xf
  v_cndmask_b32_dpp v33, v35, v33, vcc quad_perm:[0,1,0,1] row_mask:0xf bank_mask:0xf
  s_cmp_eq_u32 s33, 63
  s_cbranch_scc1 CH_LAST
  ds_write_b64 v0, v[32:33]
  v_mov_b64 v[40:41], 0
  v_mov_b64 v[42:43], 0
  v_mov_b64 v[64:65], 0
  v_mov_b64 v[66:67], 0
  v_mov_b64 v[68:69], 0
  v_mov_b64 v[70:71], 0
  v_mov_b64 v[36:37], 0
  v_mov_b64 v[38:39], 0
  s_waitcnt lgkmcnt(0)
  s_barrier
  ds_read2st64_b64 v[12:15], v11 offset0:28 offset1:29
  ds_read2st64_b64 v[16:19], v11 offset0:30 offset1:31
  v_mov_b64 v[32:33], 0
  v_mov_b64 v[34:35], 0
  s_waitcnt lgkmcnt(0)
  v_smfmac_f32_16x16x64_bf16 v[20:23], v[12:15], v[240:247], v1
  v_smfmac_f32_16x16x64_bf16 v[20:23], v[16:19], v[248:255], v1
  v_smfmac_f32_16x16x64_bf16 v[44:47], v[12:15], v[144:151], v1
  v_smfmac_f32_16x16x64_bf16 v[44:47], v[16:19], v[152:159], v1
  v_smfmac_f32_16x16x64_bf16 v[40:43], v[12:15], v[56:63], v1
  v_smfmac_f32_16x16x64_bf16 v[40:43], v[16:19], v[48:55], v1
  v_smfmac_f32_16x16x64_bf16 v[64:67], v[12:15], v[160:167], v1
  s_nop 2
  v_add_f32 v20, v20, v22
  v_add_f32 v21, v21, v23
  v_smfmac_f32_16x16x64_bf16 v[64:67], v[16:19], v[168:175], v1
  v_cvt_pk_bf16_f32 v20, v20, v21
  v_and_b32 v20, -2, v20
  v_smfmac_f32_16x16x64_bf16 v[68:71], v[12:15], v[72:79], v1
  buffer_store_dword v20, v11, s[8:11], s62 offen sc1
  v_mov_b64 v[20:21], 0
  v_smfmac_f32_16x16x64_bf16 v[68:71], v[16:19], v[24:31], v1
  v_mov_b64 v[22:23], 0
  v_smfmac_f32_16x16x64_bf16 v[36:39], v[12:15], v[176:183], v1
  v_add_f32 v44, v44, v46
  v_add_f32 v45, v45, v47
  v_smfmac_f32_16x16x64_bf16 v[36:39], v[16:19], v[184:191], v1
  v_cvt_pk_bf16_f32 v44, v44, v45
  v_and_b32 v44, -2, v44
  v_smfmac_f32_16x16x64_bf16 v[32:35], v[12:15], v[192:199], v1
  v_add_f32 v40, v40, v42
  v_add_f32 v41, v41, v43
  v_smfmac_f32_16x16x64_bf16 v[32:35], v[16:19], v[200:207], v1
  v_cvt_pk_bf16_f32 v45, v40, v41
  buffer_store_dwordx2 v[44:45], v11, s[8:11], s40 offen sc1
  v_smfmac_f32_16x16x64_bf16 v[20:23], v[12:15], v[208:215], v1
  v_mov_b64 v[40:41], 0
  v_mov_b64 v[42:43], 0
  v_smfmac_f32_16x16x64_bf16 v[20:23], v[16:19], v[216:223], v1
  v_add_f32 v64, v64, v66
  v_add_f32 v65, v65, v67
  v_smfmac_f32_16x16x64_bf16 v[40:43], v[12:15], v[224:231], v1
  v_cvt_pk_bf16_f32 v64, v64, v65
  v_and_b32 v64, -2, v64
  v_smfmac_f32_16x16x64_bf16 v[40:43], v[16:19], v[232:239], v1
  v_add_f32 v68, v68, v70
  v_add_f32 v69, v69, v71
  v_cvt_pk_bf16_f32 v65, v68, v69
  buffer_store_dwordx2 v[64:65], v11, s[8:11], s41 offen sc1
  v_add_f32 v36, v36, v38
  v_add_f32 v37, v37, v39
  v_cvt_pk_bf16_f32 v36, v36, v37
  v_and_b32 v36, -2, v36
  v_add_f32 v32, v32, v34
  v_add_f32 v33, v33, v35
  v_cvt_pk_bf16_f32 v37, v32, v33
  buffer_store_dwordx2 v[36:37], v11, s[8:11], s42 offen sc1
  v_add_f32 v20, v20, v22
  v_add_f32 v21, v21, v23
  v_cvt_pk_bf16_f32 v20, v20, v21
  v_and_b32 v20, -2, v20
  v_add_f32 v40, v40, v42
  v_add_f32 v41, v41, v43
  v_cvt_pk_bf16_f32 v21, v40, v41
  buffer_store_dwordx2 v[20:21], v11, s[8:11], s43 offen sc1
  s_load_dword s80, s[84:85], s51 glc
  s_cmp_eq_u32 s61, 0
  s_cbranch_scc1 CH_RED_46_skip
  v_and_b32 v64, 16, v4
  v_lshlrev_b32_e64 v64, v64, s70
  v_cndmask_b32 v60, 0, v64, s[72:73]
  v_cndmask_b32 v61, 0, v64, s[74:75]
  v_cndmask_b32 v62, 0, v64, s[76:77]
  v_cndmask_b32 v63, 0, v64, s[78:79]
  s_cmp_eq_u32 s45, 0
  s_cbranch_scc1 CH_RS_47
  s_cmp_eq_u32 s45, 1
  s_cbranch_scc1 CH_RS_47_1
  s_sleep 5
  s_branch CH_RS_47
CH_RS_47_1:
  s_sleep 4
CH_RS_47:
  s_mov_b32 s96, 0
  s_cmp_eq_u32 s61, 2
  s_cbranch_scc1 CH_RED_46_v1
CH_RED_46_v0:
  buffer_load_dwordx4 v[24:27], v9, s[8:11], s36 offen offset:0 sc1
  buffer_load_dwordx4 v[28:31], v9, s[8:11], s36 offen offset:2048 sc1
  buffer_load_dwordx4 v[32:35], v9, s[8:11], s37 offen offset:0 sc1
  buffer_load_dwordx4 v[36:39], v9, s[8:11], s37 offen offset:2048 sc1
  buffer_load_dwordx4 v[44:47], v9, s[8:11], s38 offen offset:0 sc1
  buffer_load_dwordx4 v[48:51], v9, s[8:11], s38 offen offset:2048 sc1
  buffer_load_dwordx4 v[52:55], v9, s[8:11], s39 offen offset:0 sc1
  buffer_load_dwordx4 v[56:59], v9, s[8:11], s39 offen offset:2048 sc1
  v_mov_b32 v12, 0
  s_waitcnt vmcnt(6)
  v_mfma_f32_16x16x32_bf16 v[64:67], v[24:27], v[60:63], 0
  v_bitop3_b32 v12, v12, v24, v26 bitop3:0xfe
  v_mfma_f32_16x16x32_bf16 v[64:67], v[28:31], v[60:63], v[64:67]
  v_bitop3_b32 v12, v12, v28, v30 bitop3:0xfe
  s_waitcnt vmcnt(4)
  v_mfma_f32_16x16x32_bf16 v[64:67], v[32:35], v[60:63], v[64:67]
  v_bitop3_b32 v12, v12, v32, v34 bitop3:0xfe
  v_mfma_f32_16x16x32_bf16 v[64:67], v[36:39], v[60:63], v[64:67]
  v_bitop3_b32 v12, v12, v36, v38 bitop3:0xfe
  s_waitcnt vmcnt(2)
  v_mfma_f32_16x16x32_bf16 v[64:67], v[44:47], v[60:63], v[64:67]
  v_bitop3_b32 v12, v12, v44, v46 bitop3:0xfe
  v_mfma_f32_16x16x32_bf16 v[64:67], v[48:51], v[60:63], v[64:67]
  v_bitop3_b32 v12, v12, v48, v50 bitop3:0xfe
  s_waitcnt vmcnt(0)
  v_mfma_f32_16x16x32_bf16 v[64:67], v[52:55], v[60:63], v[64:67]
  v_bitop3_b32 v12, v12, v52, v54 bitop3:0xfe
  v_mfma_f32_16x16x32_bf16 v[64:67], v[56:59], v[60:63], v[64:67]
  v_bitop3_b32 v12, v12, v56, v58 bitop3:0xfe
  v_and_b32 v12, 1, v12
  v_cmp_ne_u32 vcc, 0, v12
  s_nop 0
  s_nop 0
  s_cbranch_vccz CH_RED_46_ok
  s_add_u32 s96, s96, 1
  s_cmp_lt_u32 s96, 60000
  s_cbranch_scc1 CH_RED_46_v0
  s_branch CH_FAIL
CH_RED_46_v1:
  buffer_load_dwordx4 v[24:27], v9, s[8:11], s36 offen offset:0 sc1
  buffer_load_dwordx4 v[28:31], v9, s[8:11], s36 offen offset:2048 sc1
  buffer_load_dwordx4 v[32:35], v9, s[8:11], s37 offen offset:0 sc1
  buffer_load_dwordx4 v[36:39], v9, s[8:11], s37 offen offset:2048 sc1
  buffer_load_dwordx4 v[44:47], v9, s[8:11], s38 offen offset:0 sc1
  buffer_load_dwordx4 v[48:51], v9, s[8:11], s38 offen offset:2048 sc1
  buffer_load_dwordx4 v[52:55], v9, s[8:11], s39 offen offset:0 sc1
  buffer_load_dwordx4 v[56:59], v9, s[8:11], s39 offen offset:2048 sc1
  v_mov_b32 v12, 0
  s_waitcnt vmcnt(6)
  v_mfma_f32_16x16x32_bf16 v[64:67], v[24:27], v[60:63], 0
  v_bitop3_b32 v12, v12, v24, v25 bitop3:0xfe
  v_bitop3_b32 v12, v12, v26, v27 bitop3:0xfe
  v_mfma_f32_16x16x32_bf16 v[64:67], v[28:31], v[60:63], v[64:67]
  v_bitop3_b32 v12, v12, v28, v29 bitop3:0xfe
  v_bitop3_b32 v12, v12, v30, v31 bitop3:0xfe
  s_waitcnt vmcnt(4)
  v_mfma_f32_16x16x32_bf16 v[64:67], v[32:35], v[60:63], v[64:67]
  v_bitop3_b32 v12, v12, v32, v33 bitop3:0xfe
  v_bitop3_b32 v12, v12, v34, v35 bitop3:0xfe
  v_mfma_f32_16x16x32_bf16 v[64:67], v[36:39], v[60:63], v[64:67]
  v_bitop3_b32 v12, v12, v36, v37 bitop3:0xfe
  v_bitop3_b32 v12, v12, v38, v39 bitop3:0xfe
  s_waitcnt vmcnt(2)
  v_mfma_f32_16x16x32_bf16 v[64:67], v[44:47], v[60:63], v[64:67]
  v_bitop3_b32 v12, v12, v44, v45 bitop3:0xfe
  v_bitop3_b32 v12, v12, v46, v47 bitop3:0xfe
  v_mfma_f32_16x16x32_bf16 v[64:67], v[48:51], v[60:63], v[64:67]
  v_bitop3_b32 v12, v12, v48, v49 bitop3:0xfe
  v_bitop3_b32 v12, v12, v50, v51 bitop3:0xfe
  s_waitcnt vmcnt(0)
  v_mfma_f32_16x16x32_bf16 v[64:67], v[52:55], v[60:63], v[64:67]
  v_bitop3_b32 v12, v12, v52, v53 bitop3:0xfe
  v_bitop3_b32 v12, v12, v54, v55 bitop3:0xfe
  v_mfma_f32_16x16x32_bf16 v[64:67], v[56:59], v[60:63], v[64:67]
  v_bitop3_b32 v12, v12, v56, v57 bitop3:0xfe
  v_bitop3_b32 v12, v12, v58, v59 bitop3:0xfe
  v_and_b32 v12, 1, v12
  v_cmp_ne_u32 vcc, 0, v12
  s_nop 0
  s_cbranch_vccz CH_RED_46_ok
  s_add_u32 s96, s96, 1
  s_cmp_lt_u32 s96, 60000
  s_cbranch_scc1 CH_RED_46_v1
  s_branch CH_FAIL
CH_RED_46_ok:
  s_mov_b32 exec_lo, 0x00ff00ff
  s_mov_b32 exec_hi, 0x00ff00ff
  v_cvt_pk_bf16_f32 v60, v64, v65
  v_cvt_pk_bf16_f32 v61, v66, v67
  v_and_b32 v60, -2, v60
  buffer_store_dwordx2 v[60:61], v10, s[12:15], s60 offen sc1
  s_mov_b64 exec, -1
CH_RED_46_skip:
  ds_read_b128 v[48:51], v8 offset:0
  ds_read_b128 v[52:55], v8 offset:1024
  ds_read_b128 v[56:59], v8 offset:2048
  ds_read_b128 v[60:63], v8 offset:3072
  ds_read_b128 v[64:67], v8 offset:16384
  ds_read_b128 v[68:71], v8 offset:17408
  ds_read_b128 v[72:75], v8 offset:18432
  ds_read_b128 v[76:79], v8 offset:19456
  ds_read_b128 v[40:43], v8 offset:32768
  ds_read_b128 v[44:47], v8 offset:33792
  v_mov_b64 v[24:25], 0
  v_mov_b64 v[26:27], 0
  v_mov_b64 v[28:29], 0
  v_mov_b64 v[30:31], 0
  v_mov_b64 v[32:33], 0
  v_mov_b64 v[34:35], 0
  v_mov_b64 v[36:37], 0
  v_mov_b64 v[38:39], 0
  s_add_u32 s64, s64, 262144
  s_add_u32 s65, s65, 262144
  s_add_u32 s66, s66, 262144
  s_add_u32 s67, s67, 262144
  s_add_u32 s81, s81, 262144
  s_min_u32 s81, s81, s82
  s_cmp_eq_u32 s61, 0
  s_cbranch_scc0 CH_NW_48
  s_waitcnt vmcnt(0)
CH_NW_48:
  s_barrier
  s_mov_b32 s96, 0
  v_add_u32 v11, s48, v4
CH_GAT_49:
  v_mov_b32 v20, 0
  v_mov_b32 v22, 0
  buffer_load_dwordx4 v[12:15], v4, s[12:15], s48 offen sc1
  buffer_load_dwordx4 v[16:19], v4, s[12:15], s49 offen sc1
  s_mov_b64 exec, 0xffff
  buffer_load_dwordx4 v[20:23], v4, s[12:15], s50 offen sc1
  s_mov_b64 exec, -1
  s_waitcnt vmcnt(0)
  v_bitop3_b32 v0, 0, v12, v14 bitop3:0xfe
  v_bitop3_b32 v0, v0, v16, v18 bitop3:0xfe
  v_bitop3_b32 v0, v0, v20, v22 bitop3:0xfe
  v_and_b32 v0, 1, v0
  v_cmp_ne_u32 vcc, 0, v0
  s_nop 0
  s_cbranch_vccz CH_GAT_49_okA
  s_add_u32 s96, s96, 1
  s_cmp_lt_u32 s96, 60000
  s_cbranch_scc1 CH_GAT_49
  s_branch CH_FAIL
CH_GAT_49_okA:
  ds_write_b128 v11, v[12:15] offset:0
  ds_write_b128 v11, v[16:19] offset:4096
  v_add_u32 v11, s83, v4
  s_mov_b64 exec, 0xffff
  ds_write_b128 v11, v[20:23] offset:8192
  s_mov_b64 exec, -1
  s_cmp_eq_u32 s94, 3
  s_cbranch_scc0 CH_NF_50
  s_mov_b64 exec, 1
  v_mov_b32 v0, 1
  buffer_store_dword v0, off, s[24:27], s68 sc1
  s_mov_b64 exec, -1
CH_NF_50:
  s_waitcnt lgkmcnt(0)
  s_cmp_eq_u32 s80, 1
  s_cbranch_scc1 CH_FK_51
  s_cmp_eq_u32 s94, 3
  s_cbranch_scc0 CH_FK_51
  s_cmp_ge_u32 s33, 62
  s_cbranch_scc1 CH_FK_51
  v_mov_b32 v11, s51
  s_mov_b32 s96, 0
CH_FKV_S0_52:
  buffer_load_dword v0, v11, s[24:27], 0 offen sc1
  s_waitcnt vmcnt(0)
  v_readfirstlane_b32 s3, v0
  s_nop 0
  s_cmp_eq_u32 s3, 1
  s_cbranch_scc1 CH_FKV_S0_52_ok
  s_sleep 1
  s_add_u32 s96, s96, 1
  s_cmp_lt_u32 s96, 60000
  s_cbranch_scc1 CH_FKV_S0_52
  s_branch CH_FAIL
CH_FKV_S0_52_ok:
CH_FK_51:
  s_add_u32 s51, s51, 4
  s_barrier
  ds_read_b128 v[12:15], v4 offset:0
  ds_read_b128 v[16:19], v4 offset:1024
  ds_read_b128 v[20:23], v4 offset:2048
  s_add_u32 s68, s68, 4
  s_add_u32 s33, s33, 1
  s_cmp_lt_u32 s33, 64
  s_cbranch_scc0 CH_DONE
  s_branch CH_STEP_S1
CH_FB_18:
  s_waitcnt lgkmcnt(0)
  ds_read_b128 v[24:27], v4 offset:9216
  ds_read_b128 v[28:31], v4 offset:10240
  ds_read_b128 v[32:35], v4 offset:11264
  ds_read_b128 v[36:39], v4 offset:12288
  ds_read2st64_b32 v[64:65], v7 offset0:0 offset1:1
  ds_read2st64_b32 v[66:67], v7 offset0:2 offset1:3
  s_waitcnt lgkmcnt(0)
  v_add_f32 v24, v24, v28
  v_add_f32 v25, v25, v29
  v_add_f32 v26, v26, v30
  v_add_f32 v27, v27, v31
  v_add_f32 v32, v32, v36
  v_add_f32 v33, v33, v37
  v_add_f32 v34, v34, v38
  v_add_f32 v35, v35, v39
  v_add_f32 v64, v64, v65
  v_add_f32 v66, v66, v67
  v_add_f32 v24, v24, v32
  v_add_f32 v25, v25, v33
  v_add_f32 v26, v26, v34
  v_add_f32 v27, v27, v35
  v_add_f32 v64, v64, v66
  v_max3_f32 v36, v24, v25, v26
  v_max3_f32 v36, v36, v27, v64
  s_nop 1
  v_max_f32_dpp v36, v36, v36 quad_perm:[2,3,0,1] row_mask:0xf bank_mask:0xf
  v_mov_b32 v37, v36
  s_nop 1
  v_permlane16_swap_b32 v36, v37
  v_max_f32 v36, v36, v37
  v_mov_b32 v37, v36
  s_nop 1
  v_permlane32_swap_b32 v36, v37
  v_max_f32 v36, v36, v37
  v_sub_f32 v24, v24, v36
  v_sub_f32 v25, v25, v36
  v_sub_f32 v26, v26, v36
  v_sub_f32 v27, v27, v36
  v_sub_f32 v64, v64, v36
  v_exp_f32 v24, v24
  v_exp_f32 v25, v25
  v_exp_f32 v26, v26
  v_exp_f32 v27, v27
  v_exp_f32 v64, v64
  v_cvt_pk_bf16_f32 v28, v24, v25
  v_cvt_pk_bf16_f32 v30, v26, v27
  v_mov_b32_dpp v65, v64 quad_perm:[2,3,0,1] row_mask:0xf bank_mask:0xf
  v_mov_b32_dpp v29, v28 quad_perm:[2,3,0,1] row_mask:0xf bank_mask:0xf
  v_mov_b32_dpp v31, v30 quad_perm:[2,3,0,1] row_mask:0xf bank_mask:0xf
  v_cvt_pk_bf16_f32 v66, v64, v65
  v_cvt_pk_bf16_f32 v67, v64, v65
  s_nop 1
  s_branch CH_FB_18_join
CH_FB_27:
  s_waitcnt lgkmcnt(0)
  ds_read_b128 v[24:27], v4 offset:9216
  ds_read_b128 v[28:31], v4 offset:10240
  ds_read_b128 v[32:35], v4 offset:11264
  ds_read_b128 v[36:39], v4 offset:12288
  ds_read2st64_b32 v[64:65], v7 offset0:0 offset1:1
  ds_read2st64_b32 v[66:67], v7 offset0:2 offset1:3
  s_waitcnt lgkmcnt(0)
  v_add_f32 v24, v24, v28
  v_add_f32 v25, v25, v29
  v_add_f32 v26, v26, v30
  v_add_f32 v27, v27, v31
  v_add_f32 v32, v32, v36
  v_add_f32 v33, v33, v37
  v_add_f32 v34, v34, v38
  v_add_f32 v35, v35, v39
  v_add_f32 v64, v64, v65
  v_add_f32 v66, v66, v67
  v_add_f32 v24, v24, v32
  v_add_f32 v25, v25, v33
  v_add_f32 v26, v26, v34
  v_add_f32 v27, v27, v35
  v_add_f32 v64, v64, v66
  v_max3_f32 v36, v24, v25, v26
  v_max3_f32 v36, v36, v27, v64
  s_nop 1
  v_max_f32_dpp v36, v36, v36 quad_perm:[2,3,0,1] row_mask:0xf bank_mask:0xf
  v_mov_b32 v37, v36
  s_nop 1
  v_permlane16_swap_b32 v36, v37
  v_max_f32 v36, v36, v37
  v_mov_b32 v37, v36
  s_nop 1
  v_permlane32_swap_b32 v36, v37
  v_max_f32 v36, v36, v37
  v_sub_f32 v24, v24, v36
  v_sub_f32 v25, v25, v36
  v_sub_f32 v26, v26, v36
  v_sub_f32 v27, v27, v36
  v_sub_f32 v64, v64, v36
  v_exp_f32 v24, v24
  v_exp_f32 v25, v25
  v_exp_f32 v26, v26
  v_exp_f32 v27, v27
  v_exp_f32 v64, v64
  v_cvt_pk_bf16_f32 v28, v24, v25
  v_cvt_pk_bf16_f32 v30, v26, v27
  v_mov_b32_dpp v65, v64 quad_perm:[2,3,0,1] row_mask:0xf bank_mask:0xf
  v_mov_b32_dpp v29, v28 quad_perm:[2,3,0,1] row_mask:0xf bank_mask:0xf
  v_mov_b32_dpp v31, v30 quad_perm:[2,3,0,1] row_mask:0xf bank_mask:0xf
  v_cvt_pk_bf16_f32 v66, v64, v65
  v_cvt_pk_bf16_f32 v67, v64, v65
  s_nop 1
  s_branch CH_FB_27_join
CH_FB_36:
  s_waitcnt lgkmcnt(0)
  ds_read_b128 v[24:27], v4 offset:9216
  ds_read_b128 v[28:31], v4 offset:10240
  ds_read_b128 v[32:35], v4 offset:11264
  ds_read_b128 v[36:39], v4 offset:12288
  ds_read2st64_b32 v[64:65], v7 offset0:0 offset1:1
  ds_read2st64_b32 v[66:67], v7 offset0:2 offset1:3
  s_waitcnt lgkmcnt(0)
  v_add_f32 v24, v24, v28
  v_add_f32 v25, v25, v29
  v_add_f32 v26, v26, v30
  v_add_f32 v27, v27, v31
  v_add_f32 v32, v32, v36
  v_add_f32 v33, v33, v37
  v_add_f32 v34, v34, v38
  v_add_f32 v35, v35, v39
  v_add_f32 v64, v64, v65
  v_add_f32 v66, v66, v67
  v_add_f32 v24, v24, v32
  v_add_f32 v25, v25, v33
  v_add_f32 v26, v26, v34
  v_add_f32 v27, v27, v35
  v_add_f32 v64, v64, v66
  v_max3_f32 v36, v24, v25, v26
  v_max3_f32 v36, v36, v27, v64
  s_nop 1
  v_max_f32_dpp v36, v36, v36 quad_perm:[2,3,0,1] row_mask:0xf bank_mask:0xf
  v_mov_b32 v37, v36
  s_nop 1
  v_permlane16_swap_b32 v36, v37
  v_max_f32 v36, v36, v37
  v_mov_b32 v37, v36
  s_nop 1
  v_permlane32_swap_b32 v36, v37
  v_max_f32 v36, v36, v37
  v_sub_f32 v24, v24, v36
  v_sub_f32 v25, v25, v36
  v_sub_f32 v26, v26, v36
  v_sub_f32 v27, v27, v36
  v_sub_f32 v64, v64, v36
  v_exp_f32 v24, v24
  v_exp_f32 v25, v25
  v_exp_f32 v26, v26
  v_exp_f32 v27, v27
  v_exp_f32 v64, v64
  v_cvt_pk_bf16_f32 v28, v24, v25
  v_cvt_pk_bf16_f32 v30, v26, v27
  v_mov_b32_dpp v65, v64 quad_perm:[2,3,0,1] row_mask:0xf bank_mask:0xf
  v_mov_b32_dpp v29, v28 quad_perm:[2,3,0,1] row_mask:0xf bank_mask:0xf
  v_mov_b32_dpp v31, v30 quad_perm:[2,3,0,1] row_mask:0xf bank_mask:0xf
  v_cvt_pk_bf16_f32 v66, v64, v65
  v_cvt_pk_bf16_f32 v67, v64, v65
  s_nop 1
  s_branch CH_FB_36_join
CH_FB_45:
  s_waitcnt lgkmcnt(0)
  ds_read_b128 v[24:27], v4 offset:9216
  ds_read_b128 v[28:31], v4 offset:10240
  ds_read_b128 v[32:35], v4 offset:11264
  ds_read_b128 v[36:39], v4 offset:12288
  ds_read2st64_b32 v[64:65], v7 offset0:0 offset1:1
  ds_read2st64_b32 v[66:67], v7 offset0:2 offset1:3
  s_waitcnt lgkmcnt(0)
  v_add_f32 v24, v24, v28
  v_add_f32 v25, v25, v29
  v_add_f32 v26, v26, v30
  v_add_f32 v27, v27, v31
  v_add_f32 v32, v32, v36
  v_add_f32 v33, v33, v37
  v_add_f32 v34, v34, v38
  v_add_f32 v35, v35, v39
  v_add_f32 v64, v64, v65
  v_add_f32 v66, v66, v67
  v_add_f32 v24, v24, v32
  v_add_f32 v25, v25, v33
  v_add_f32 v26, v26, v34
  v_add_f32 v27, v27, v35
  v_add_f32 v64, v64, v66
  v_max3_f32 v36, v24, v25, v26
  v_max3_f32 v36, v36, v27, v64
  s_nop 1
  v_max_f32_dpp v36, v36, v36 quad_perm:[2,3,0,1] row_mask:0xf bank_mask:0xf
  v_mov_b32 v37, v36
  s_nop 1
  v_permlane16_swap_b32 v36, v37
  v_max_f32 v36, v36, v37
  v_mov_b32 v37, v36
  s_nop 1
  v_permlane32_swap_b32 v36, v37
  v_max_f32 v36, v36, v37
  v_sub_f32 v24, v24, v36
  v_sub_f32 v25, v25, v36
  v_sub_f32 v26, v26, v36
  v_sub_f32 v27, v27, v36
  v_sub_f32 v64, v64, v36
  v_exp_f32 v24, v24
  v_exp_f32 v25, v25
  v_exp_f32 v26, v26
  v_exp_f32 v27, v27
  v_exp_f32 v64, v64
  v_cvt_pk_bf16_f32 v28, v24, v25
  v_cvt_pk_bf16_f32 v30, v26, v27
  v_mov_b32_dpp v65, v64 quad_perm:[2,3,0,1] row_mask:0xf bank_mask:0xf
  v_mov_b32_dpp v29, v28 quad_perm:[2,3,0,1] row_mask:0xf bank_mask:0xf
  v_mov_b32_dpp v31, v30 quad_perm:[2,3,0,1] row_mask:0xf bank_mask:0xf
  v_cvt_pk_bf16_f32 v66, v64, v65
  v_cvt_pk_bf16_f32 v67, v64, v65
  s_nop 1
  s_branch CH_FB_45_join
CH_FAIL:
  s_mov_b64 exec, 1
  v_mov_b32 v1, 0xdead
  v_mov_b32 v2, 28
  buffer_store_dword v1, v2, s[28:31], 0 offen
  s_waitcnt vmcnt(0)
  s_branch END
CH_LAST:
  s_waitcnt vmcnt(0)
  s_barrier
  s_cmp_eq_u32 s94, 3
  s_cbranch_scc0 CH_DONE
  s_mov_b64 exec, 1
  v_mov_b32 v0, 1
  buffer_store_dword v0, off, s[24:27], s68 sc1
  s_mov_b64 exec, -1
CH_DONE:
  s_branch END
END:
  s_endpgm
.section .rodata,"a"
.p2align 6
.amdhsa_kernel parallel_sum__memory_aug_recurrent_mem_tr__mixer_token_mlp__prompt_kernel
  .amdhsa_next_free_vgpr 512
  .amdhsa_next_free_sgpr 102
  .amdhsa_accum_offset 256
  .amdhsa_group_segment_fixed_size 0
  .amdhsa_kernarg_size 120
  .amdhsa_user_sgpr_count 2
  .amdhsa_user_sgpr_kernarg_segment_ptr 1
  .amdhsa_system_sgpr_workgroup_id_x 1
.end_amdhsa_kernel
```
